```python
import torch

def _softmax(x, axis=-1):
    return torch.softmax(x, dim=axis)
def _gelu(x):
    return torch.nn.functional.gelu(x, approximate="tanh")
def _silu(x):
    return torch.nn.functional.silu(x)
def _sigmoid(x):
    return torch.sigmoid(x)
def _layernorm(x, axis=-1, eps=1e-5):
    m = x.mean(dim=axis, keepdim=True)
    v = x.var(dim=axis, keepdim=True, unbiased=False)
    return (x - m) / torch.sqrt(v + eps)
def _scatter_add(tgt, idx, src, axis=0):
    return tgt.clone().index_add_(axis, idx, src)
def _segment_sum(src, seg, n):
    out = torch.zeros((n,) + src.shape[1:], dtype=src.dtype)
    return out.index_add_(0, seg, src)
def _pad(x, pw):
    flat = tuple(v for pair in reversed(pw) for v in pair)
    return torch.nn.functional.pad(x, flat)

kernel_name = 'interleave_layers__linear_kernel_hedgehog__geglu_ffn__prompt'

def setup_inputs():

    _w = (lambda a: (lambda t: t.to(torch.bfloat16) if t.is_floating_point() else t)(torch.as_tensor(a)))
    def _A_setup():
        B, S, D, H = 1, 2048, 640, 32
        Dh = D // H
        return {
            "x": _w((lambda *s: torch.randn(*s, dtype=torch.bfloat16) * 0.05)(B, S, D)),
            "wqkv": _w((lambda *s: torch.randn(*s, dtype=torch.bfloat16) * 0.2)(D, 3 * D)),
            "w_phi": _w((lambda *s: torch.randn(*s, dtype=torch.bfloat16) * 0.2)(H, Dh, Dh) * (Dh ** -0.5)),
            "wo": _w((lambda *s: torch.randn(*s, dtype=torch.bfloat16) * 0.05)(D, D)),
        }
    _A_in = _A_setup()

    def _B_setup():
        B, S, D, F = 1, 2048, 640, 1728
        return {
            "x": _w((lambda *s: torch.randn(*s, dtype=torch.bfloat16) * 0.05)(B, S, D)),
            "w_gate": _w((lambda *s: torch.randn(*s, dtype=torch.bfloat16) * 0.05)(D, F)),
            "w_up": _w((lambda *s: torch.randn(*s, dtype=torch.bfloat16) * 0.05)(D, F)),
            "w_down": _w((lambda *s: torch.randn(*s, dtype=torch.bfloat16) * 0.05)(F, D)),
        }
    _B_in = _B_setup()

    return {
        "A_x": _A_in["x"],
        "A_wqkv": _A_in["wqkv"],
        "A_w_phi": _A_in["w_phi"],
        "A_wo": _A_in["wo"],
        "B_x": _B_in["x"],
        "B_w_gate": _B_in["w_gate"],
        "B_w_up": _B_in["w_up"],
        "B_w_down": _B_in["w_down"],
    }

def reference(A_x, A_wqkv, A_w_phi, A_wo, B_x, B_w_gate, B_w_up, B_w_down):
    def _A_ref(x, wqkv, w_phi, wo):
        B, S, D = x.shape
        H = 32; Dh = D // H
        qkv = (lambda x, *d: x.permute(*d))((x @ wqkv).reshape(B, S, 3, H, Dh), 2, 0, 3, 1, 4)
        q, k, v = qkv[0], qkv[1], qkv[2]
        pq = torch.einsum("bhsd,hdf->bhsf", q, w_phi)
        pk = torch.einsum("bhsd,hdf->bhsf", k, w_phi)
        phi_q = torch.concatenate([_softmax(pq, axis=-1), _softmax(-pq, axis=-1)], axis=-1)
        phi_k = torch.concatenate([_softmax(pk, axis=-1), _softmax(-pk, axis=-1)], axis=-1)
        kv = torch.einsum("bhsf,bhsd->bhfd", phi_k, v)
        z  = torch.einsum("bhsf->bhf", phi_k)
        num = torch.einsum("bhqf,bhfd->bhqd", phi_q, kv)
        den = torch.einsum("bhqf,bhf->bhq", phi_q, z)[..., None] + 1e-6
        o = num / den
        return (lambda x, *d: x.permute(*d))(o, 0, 2, 1, 3).reshape(B, S, D) @ wo

    def _B_ref(x, w_gate, w_up, w_down):
        return (_gelu(x @ w_gate) * (x @ w_up)) @ w_down

    x = A_x
    x = x + _A_ref(_layernorm(x, axis=-1), A_wqkv, A_w_phi, A_wo)
    x = x + _B_ref(_layernorm(x, axis=-1), B_w_gate, B_w_up, B_w_down)
    x = x + _A_ref(_layernorm(x, axis=-1), A_wqkv, A_w_phi, A_wo)
    x = x + _B_ref(_layernorm(x, axis=-1), B_w_gate, B_w_up, B_w_down)
    return x
```

```asm
; @launch grid=(256,1,1) block=(256,1,1) lds=163840
.amdgcn_target "amdgcn-amd-amdhsa--gfx950"
.text
.globl interleave_layers__linear_kernel_hedgehog__geglu_ffn__prompt_kernel
.p2align 8
.type interleave_layers__linear_kernel_hedgehog__geglu_ffn__prompt_kernel,@function
interleave_layers__linear_kernel_hedgehog__geglu_ffn__prompt_kernel:
  s_branch M_BODY
.p2align 6
M_BODY:
  s_cmp_ge_u32 s2, 256
  s_cbranch_scc1 M_END
  s_load_dwordx2 s[8:9], s[0:1], 80
  s_load_dwordx2 s[84:85], s[0:1], 72
  s_load_dwordx2 s[4:5], s[0:1], 64
  s_load_dwordx2 s[88:89], s[0:1], 0
  v_lshrrev_b32 v1, 6, v0
  v_and_b32 v0, 63, v0
  v_readfirstlane_b32 s12, v1
  s_mov_b32 s10, 0x10000000
  s_mov_b32 s11, 0x20000
  v_lshlrev_b32 v1, 4, v0
  s_mov_b32 s86, 256
  s_mov_b32 s87, 0x20000
  s_mov_b64 s[92:93], 1
  s_getreg_b32 s13, hwreg(HW_REG_XCC_ID, 0, 4)
  s_mov_b32 s14, 8
  s_mov_b32 s3, 12582912
  v_mov_b32 v24, 0
  s_waitcnt lgkmcnt(0)
  buffer_load_dword v20, v24, s[8:11], s3 offen sc1
  s_cmp_lg_u32 s12, 0
  s_cbranch_scc1 M_NOTICK
  s_and_b32 s13, s13, 7
  s_lshl_b32 s3, s13, 5
  v_mov_b32 v21, 1
  s_mov_b64 exec, 1
  buffer_atomic_add v21, v1, s[84:87], s3 offen sc0 sc1
  s_mov_b64 exec, -1
M_NOTICK:
  s_cmp_lt_u32 s2, 80
  s_cbranch_scc1 RL_B
  s_waitcnt vmcnt(0)
  s_branch RL_ISSUED
RL_B:
  s_load_dwordx4 s[36:39], s[0:1], 8
  s_mov_b32 s78, 3
  s_mul_i32 s79, s2, 13108
  s_lshr_b32 s79, s79, 16
  s_mul_i32 s80, s79, 5
  s_sub_u32 s80, s2, s80
  s_lshl_b32 s81, s80, 2
  s_add_u32 s81, s81, s12
  v_lshrrev_b32 v24, 4, v0
  v_and_b32 v25, 15, v0
  v_xor_b32 v25, v25, v24
  v_min_u32 v25, 14, v25
  v_mul_u32_u24 v24, 3840, v24
  v_lshl_add_u32 v24, v25, 4, v24
  v_mov_b32 v26, 1280
  v_mov_b32 v27, 2480
  v_cmp_le_u32 vcc, 5, v25
  s_nop 1
  v_cndmask_b32 v26, v26, v27, vcc
  v_mov_b32 v27, -160
  v_cmp_le_u32 vcc, 10, v25
  s_nop 1
  v_cndmask_b32 v26, v26, v27, vcc
  v_add_u32 v26, v24, v26
  s_lshl_b32 s3, s12, 9
  v_lshlrev_b32 v24, 3, v0
  v_add_u32 v24, s3, v24
  s_mul_i32 s44, s79, 1600
  s_mul_i32 s45, s81, 122880
  s_mul_i32 s3, s79, 80
  s_add_u32 s45, s45, s3
  s_mul_i32 s46, s12, 8704
  s_add_u32 s46, s46, 110592
  s_mov_b32 s42, 25600
  s_mov_b32 s43, 0x20000
  s_waitcnt lgkmcnt(0)
  s_mov_b32 s40, s38
  s_mov_b32 s41, s39
  s_mov_b32 s38, 2457600
  s_mov_b32 s39, 0x20000
  buffer_load_dwordx2 v[28:29], v24, s[40:43], s44 offen
  s_add_u32 m0, s46, 0
  s_add_u32 s47, s45, 0
  buffer_load_dwordx4 v26, s[36:39], s47 offen  lds
  s_add_u32 m0, s46, 1088
  s_add_u32 s47, s45, 30720
  buffer_load_dwordx4 v26, s[36:39], s47 offen  lds
  s_add_u32 m0, s46, 2176
  s_add_u32 s47, s45, 15360
  buffer_load_dwordx4 v26, s[36:39], s47 offen  lds
  s_add_u32 m0, s46, 3264
  s_add_u32 s47, s45, 46080
  buffer_load_dwordx4 v26, s[36:39], s47 offen  lds
  s_add_u32 m0, s46, 4352
  s_add_u32 s47, s45, 61440
  buffer_load_dwordx4 v26, s[36:39], s47 offen  lds
  s_add_u32 m0, s46, 5440
  s_add_u32 s47, s45, 92160
  buffer_load_dwordx4 v26, s[36:39], s47 offen  lds
  s_add_u32 m0, s46, 6528
  s_add_u32 s47, s45, 76800
  buffer_load_dwordx4 v26, s[36:39], s47 offen  lds
  s_add_u32 m0, s46, 7616
  s_add_u32 s47, s45, 107520
  buffer_load_dwordx4 v26, s[36:39], s47 offen  lds
  s_waitcnt vmcnt(9)
RL_ISSUED:
  s_cmp_lg_u32 s12, 0
  s_cbranch_scc1 M_TICKED
  s_branch M_SEE
M_TICK:
  s_and_b32 s13, s13, 7
  s_lshl_b32 s3, s13, 5
  v_mov_b32 v21, 1
  s_mov_b64 exec, 1
  buffer_atomic_add v21, v1, s[84:87], s3 offen sc0 sc1
  s_mov_b64 exec, -1
  s_waitcnt vmcnt(0)
M_SEE:
  v_readfirstlane_b32 s15, v21
  s_nop 3
  s_cmp_lt_u32 s15, 32
  s_cbranch_scc1 M_GOT
  s_add_u32 s13, s13, 1
  s_sub_u32 s14, s14, 1
  s_cmp_lg_u32 s14, 0
  s_cbranch_scc1 M_TICK
  s_mov_b32 s13, 8
M_GOT:
  s_lshl_b32 s13, s13, 5
  s_and_b32 s15, s15, 31
  s_or_b32 s13, s13, s15
  v_mov_b32 v21, s13
  s_mov_b64 exec, 1
  ds_write_b32 v1, v21
  s_mov_b64 exec, -1
  s_waitcnt lgkmcnt(0)
M_TICKED:
  s_mov_b32 s6, 2621440
  s_mov_b32 s7, 0x20000
  s_mov_b32 s22, 20721664
  s_mov_b32 s23, 0x20000
  v_add_u32 v2, 0x10000, v1
  v_add_u32 v3, 0x20000, v1
  v_and_b32 v24, 15, v0
  v_lshlrev_b32 v4, 2, v24
  v_bfe_u32 v25, v0, 1, 2
  v_lshlrev_b32 v25, 2, v25
  v_and_b32 v26, 1, v0
  v_lshl_add_u32 v5, v26, 6, v25
  v_lshlrev_b32 v24, 4, v24
  v_bfe_u32 v25, v0, 4, 1
  v_lshrrev_b32 v26, 5, v0
  v_lshl_add_u32 v27, v25, 9, v24
  v_lshl_add_u32 v6, v26, 3, v27
  v_lshl_add_u32 v7, v26, 10, v27
  v_mul_u32_u24 v25, 57344, v25
  v_add_u32 v25, v25, v24
  v_lshl_add_u32 v9, v26, 8, v25
  v_and_b32 v24, 31, v0
  v_lshlrev_b32 v24, 4, v24
  v_lshl_add_u32 v8, v26, 11, v24
  v_and_b32 v24, 15, v0
  v_mul_u32_u24 v24, 1280, v24
  v_bfe_u32 v25, v0, 4, 1
  v_lshl_add_u32 v24, v25, 4, v24
  v_lshl_add_u32 v30, v26, 3, v24
  v_lshl_add_u32 v31, v26, 5, v24
  s_mov_b32 s90, 2621440
  s_mov_b32 s91, 0x20000
  v_mov_b32 v24, 0
  s_waitcnt lgkmcnt(0)
  v_add_u32 v20, 1, v20
  s_nop 0
  v_readfirstlane_b32 s19, v20
  s_mov_b32 s20, s8
  s_mov_b32 s21, s9
  s_barrier
  ds_read_b32 v25, v24
  s_waitcnt lgkmcnt(0)
  v_readfirstlane_b32 s13, v25
  s_barrier
  s_nop 2
  s_cmp_ge_u32 s13, 256
  s_cbranch_scc1 M_END
  s_lshr_b32 s14, s13, 5
  s_getreg_b32 s15, hwreg(HW_REG_XCC_ID, 0, 4)
  s_cmp_eq_u32 s14, s15
  s_cselect_b32 s15, 0, 1
  s_add_u32 s15, s15, s19
  v_mov_b32 v21, s15
  s_lshl_b32 s66, s14, 1
  s_and_b32 s3, s13, 1
  s_add_u32 s66, s66, s3
  s_bfe_u32 s67, s13, 0x40001
  s_lshl_b32 s17, s66, 8
  s_add_u32 s17, s17, 12472320
  s_lshl_b32 s3, s67, 2
  s_add_u32 s3, s3, s17
  s_and_b32 s14, s67, 1
  s_lshl_b32 s69, s66, 1
  s_add_u32 s69, s69, s14
  s_lshr_b32 s76, s67, 1
  s_lshl_b32 s14, s69, 2
  s_add_u32 s14, s14, s12
  s_mul_i32 s62, s14, 20480
  s_mul_i32 s14, s76, 160
  s_add_u32 s62, s62, s14
  buffer_load_dwordx4 v[240:243], v31, s[88:91], s62 offen nt
  buffer_load_dwordx4 v[244:247], v31, s[88:91], s62 offen offset:64 nt
  buffer_load_dwordx2 v[18:19], v30, s[88:91], s62 offen offset:128 nt
  s_mov_b32 s57, s3
  s_getpc_b64 s[64:65]
M_PC:
  s_and_b32 s14, s13, 31
  s_lshl_b32 s14, s14, 2
  s_add_u32 s14, s14, s12
  s_lshl_b32 s14, s14, 9
  v_lshlrev_b32 v24, 7, v0
  v_add_u32 v24, s14, v24
  v_min_u32 v24, M_LAST-M_PC, v24
  s_mov_b64 exec, 15
  global_load_dword v252, v24, s[64:65]
  s_mov_b64 exec, -1
  s_cmp_lt_u32 s2, 80
  s_cbranch_scc1 RE_ISSUED
  s_cmp_lt_u32 s2, 188
  s_cbranch_scc1 RL_E
  s_sub_u32 s41, s2, 188
  s_mul_i32 s41, s41, 6
  s_lshl_b32 s42, s12, 1
  s_add_u32 s43, s12, 2
  s_min_u32 s42, s42, s43
  s_add_u32 s79, s41, s42
  s_cmp_lt_u32 s12, 2
  s_cselect_b32 s80, 2, 1
  s_add_u32 s80, s80, s79
  s_min_u32 s80, s80, 380
  s_cmp_lt_u32 s79, 280
  s_cselect_b32 s78, 1, 2
  s_cselect_b32 s3, 56, 24
  s_load_dwordx2 s[36:37], s[0:1], s3
  s_mov_b32 s38, 819200
  s_cselect_b32 s38, 2211840, s38
  s_mov_b32 s39, 0x20000
  v_lshrrev_b32 v24, 4, v0
  v_lshlrev_b32 v25, 1, v24
  v_and_b32 v26, 15, v0
  v_xor_b32 v25, v25, v26
  v_mul_u32_u24 v24, 1280, v24
  v_lshl_add_u32 v28, v25, 4, v24
  v_xor_b32 v29, 128, v28
  s_lshl_b32 s81, s12, 14
  s_add_u32 s81, s81, 98304
  s_cmp_eq_u32 s78, 2
  s_cbranch_scc1 RL_C
  s_add_u32 s40, s79, 0
  s_mul_i32 s42, s40, 13108
  s_lshr_b32 s42, s42, 16
  s_mul_i32 s43, s42, 5
  s_sub_u32 s43, s40, s43
  s_mul_i32 s52, s42, 4682
  s_lshr_b32 s52, s52, 16
  s_mul_i32 s53, s52, 14
  s_sub_u32 s53, s42, s53
  s_mul_i32 s52, s52, 28
  s_lshl_b32 s54, s53, 1
  s_add_u32 s54, s54, 0
  s_mul_i32 s55, s54, 13108
  s_lshr_b32 s55, s55, 16
  s_lshl_b32 s55, s55, 1
  s_add_u32 s55, s55, s54
  s_mul_i32 s56, s53, 7
  s_sub_u32 s56, s56, 65
  s_cmp_lt_u32 s53, 10
  s_cselect_b32 s55, s55, s56
  s_add_u32 s55, s55, s52
  s_mul_i32 s44, s55, 20480
  s_cmp_lt_u32 s55, 108
  s_cselect_b32 s44, s44, 1073741824
  s_add_u32 s45, s44, 5120
  s_add_u32 s46, s44, 10240
  s_add_u32 s47, s44, 15360
  s_lshl_b32 s54, s53, 1
  s_add_u32 s54, s54, 1
  s_mul_i32 s55, s54, 13108
  s_lshr_b32 s55, s55, 16
  s_lshl_b32 s55, s55, 1
  s_add_u32 s55, s55, s54
  s_mul_i32 s56, s53, 7
  s_sub_u32 s56, s56, 64
  s_cmp_lt_u32 s53, 10
  s_cselect_b32 s55, s55, s56
  s_add_u32 s55, s55, s52
  s_mul_i32 s48, s55, 20480
  s_cmp_lt_u32 s55, 108
  s_cselect_b32 s48, s48, 1073741824
  s_add_u32 s49, s48, 5120
  s_add_u32 s50, s48, 10240
  s_add_u32 s51, s48, 15360
  s_lshl_b32 s53, s43, 8
  s_cmp_lt_u32 s40, s80
  s_cselect_b32 s54, 0, 1073741824
  v_add_u32 v32, s54, v28
  v_add_u32 v33, s54, v29
  s_waitcnt lgkmcnt(0)
  v_add_u32 v24, s44, v32
  s_add_u32 m0, s81, 0
  s_nop 0
  buffer_load_dwordx4 v24, s[36:39], s53 offen nt lds
  v_add_u32 v25, s45, v32
  s_add_u32 m0, s81, 1024
  s_nop 0
  buffer_load_dwordx4 v25, s[36:39], s53 offen nt lds
  v_add_u32 v26, s46, v33
  s_add_u32 m0, s81, 2048
  s_nop 0
  buffer_load_dwordx4 v26, s[36:39], s53 offen nt lds
  v_add_u32 v24, s47, v33
  s_add_u32 m0, s81, 3072
  s_nop 0
  buffer_load_dwordx4 v24, s[36:39], s53 offen nt lds
  v_add_u32 v25, s48, v32
  s_add_u32 m0, s81, 4096
  s_nop 0
  buffer_load_dwordx4 v25, s[36:39], s53 offen nt lds
  v_add_u32 v26, s49, v32
  s_add_u32 m0, s81, 5120
  s_nop 0
  buffer_load_dwordx4 v26, s[36:39], s53 offen nt lds
  v_add_u32 v24, s50, v33
  s_add_u32 m0, s81, 6144
  s_nop 0
  buffer_load_dwordx4 v24, s[36:39], s53 offen nt lds
  v_add_u32 v25, s51, v33
  s_add_u32 m0, s81, 7168
  s_nop 0
  buffer_load_dwordx4 v25, s[36:39], s53 offen nt lds
  s_add_u32 s40, s79, 1
  s_mul_i32 s42, s40, 13108
  s_lshr_b32 s42, s42, 16
  s_mul_i32 s43, s42, 5
  s_sub_u32 s43, s40, s43
  s_mul_i32 s52, s42, 4682
  s_lshr_b32 s52, s52, 16
  s_mul_i32 s53, s52, 14
  s_sub_u32 s53, s42, s53
  s_mul_i32 s52, s52, 28
  s_lshl_b32 s54, s53, 1
  s_add_u32 s54, s54, 0
  s_mul_i32 s55, s54, 13108
  s_lshr_b32 s55, s55, 16
  s_lshl_b32 s55, s55, 1
  s_add_u32 s55, s55, s54
  s_mul_i32 s56, s53, 7
  s_sub_u32 s56, s56, 65
  s_cmp_lt_u32 s53, 10
  s_cselect_b32 s55, s55, s56
  s_add_u32 s55, s55, s52
  s_mul_i32 s44, s55, 20480
  s_cmp_lt_u32 s55, 108
  s_cselect_b32 s44, s44, 1073741824
  s_add_u32 s45, s44, 5120
  s_add_u32 s46, s44, 10240
  s_add_u32 s47, s44, 15360
  s_lshl_b32 s54, s53, 1
  s_add_u32 s54, s54, 1
  s_mul_i32 s55, s54, 13108
  s_lshr_b32 s55, s55, 16
  s_lshl_b32 s55, s55, 1
  s_add_u32 s55, s55, s54
  s_mul_i32 s56, s53, 7
  s_sub_u32 s56, s56, 64
  s_cmp_lt_u32 s53, 10
  s_cselect_b32 s55, s55, s56
  s_add_u32 s55, s55, s52
  s_mul_i32 s48, s55, 20480
  s_cmp_lt_u32 s55, 108
  s_cselect_b32 s48, s48, 1073741824
  s_add_u32 s49, s48, 5120
  s_add_u32 s50, s48, 10240
  s_add_u32 s51, s48, 15360
  s_lshl_b32 s53, s43, 8
  s_cmp_lt_u32 s40, s80
  s_cselect_b32 s54, 0, 1073741824
  v_add_u32 v32, s54, v28
  v_add_u32 v33, s54, v29
  v_add_u32 v24, s44, v32
  s_add_u32 m0, s81, 8192
  s_nop 0
  buffer_load_dwordx4 v24, s[36:39], s53 offen nt lds
  v_add_u32 v25, s45, v32
  s_add_u32 m0, s81, 9216
  s_nop 0
  buffer_load_dwordx4 v25, s[36:39], s53 offen nt lds
  v_add_u32 v26, s46, v33
  s_add_u32 m0, s81, 10240
  s_nop 0
  buffer_load_dwordx4 v26, s[36:39], s53 offen nt lds
  v_add_u32 v24, s47, v33
  s_add_u32 m0, s81, 11264
  s_nop 0
  buffer_load_dwordx4 v24, s[36:39], s53 offen nt lds
  v_add_u32 v25, s48, v32
  s_add_u32 m0, s81, 12288
  s_nop 0
  buffer_load_dwordx4 v25, s[36:39], s53 offen nt lds
  v_add_u32 v26, s49, v32
  s_add_u32 m0, s81, 13312
  s_nop 0
  buffer_load_dwordx4 v26, s[36:39], s53 offen nt lds
  v_add_u32 v24, s50, v33
  s_add_u32 m0, s81, 14336
  s_nop 0
  buffer_load_dwordx4 v24, s[36:39], s53 offen nt lds
  v_add_u32 v25, s51, v33
  s_add_u32 m0, s81, 15360
  s_nop 0
  buffer_load_dwordx4 v25, s[36:39], s53 offen nt lds
  s_branch RE_ISSUED
RL_C:
  s_add_u32 s40, s79, 0
  s_sub_u32 s41, s40, 280
  s_mul_i32 s42, s41, 13108
  s_lshr_b32 s42, s42, 16
  s_mul_i32 s43, s42, 5
  s_sub_u32 s43, s41, s43
  s_mul_i32 s52, s42, 13108
  s_lshr_b32 s52, s52, 16
  s_mul_i32 s53, s52, 5
  s_sub_u32 s53, s42, s53
  s_mul_i32 s52, s52, 204800
  s_mul_i32 s54, s53, 51200
  s_add_u32 s54, s54, s52
  s_cmp_lt_u32 s53, 4
  s_cbranch_scc1 RL_C40
  s_add_u32 s44, s52, 20480
  s_add_u32 s45, s52, 46080
  s_add_u32 s46, s52, 71680
  s_add_u32 s47, s52, 97280
  s_add_u32 s48, s52, 122880
  s_add_u32 s49, s52, 148480
  s_add_u32 s50, s52, 174080
  s_add_u32 s51, s52, 199680
  s_branch RL_C50
RL_C40:
  s_add_u32 s44, s54, 0
  s_add_u32 s45, s54, 5120
  s_add_u32 s46, s54, 10240
  s_add_u32 s47, s54, 15360
  s_add_u32 s48, s54, 25600
  s_add_u32 s49, s54, 30720
  s_add_u32 s50, s54, 35840
  s_add_u32 s51, s54, 40960
RL_C50:
  s_lshl_b32 s53, s43, 8
  s_cmp_lt_u32 s40, s80
  s_cselect_b32 s54, 0, 1073741824
  v_add_u32 v32, s54, v28
  v_add_u32 v33, s54, v29
  s_waitcnt lgkmcnt(0)
  v_add_u32 v24, s44, v32
  s_add_u32 m0, s81, 0
  s_nop 0
  buffer_load_dwordx4 v24, s[36:39], s53 offen nt lds
  v_add_u32 v25, s45, v32
  s_add_u32 m0, s81, 1024
  s_nop 0
  buffer_load_dwordx4 v25, s[36:39], s53 offen nt lds
  v_add_u32 v26, s46, v33
  s_add_u32 m0, s81, 2048
  s_nop 0
  buffer_load_dwordx4 v26, s[36:39], s53 offen nt lds
  v_add_u32 v24, s47, v33
  s_add_u32 m0, s81, 3072
  s_nop 0
  buffer_load_dwordx4 v24, s[36:39], s53 offen nt lds
  v_add_u32 v25, s48, v32
  s_add_u32 m0, s81, 4096
  s_nop 0
  buffer_load_dwordx4 v25, s[36:39], s53 offen nt lds
  v_add_u32 v26, s49, v32
  s_add_u32 m0, s81, 5120
  s_nop 0
  buffer_load_dwordx4 v26, s[36:39], s53 offen nt lds
  v_add_u32 v24, s50, v33
  s_add_u32 m0, s81, 6144
  s_nop 0
  buffer_load_dwordx4 v24, s[36:39], s53 offen nt lds
  v_add_u32 v25, s51, v33
  s_add_u32 m0, s81, 7168
  s_nop 0
  buffer_load_dwordx4 v25, s[36:39], s53 offen nt lds
  s_add_u32 s40, s79, 1
  s_sub_u32 s41, s40, 280
  s_mul_i32 s42, s41, 13108
  s_lshr_b32 s42, s42, 16
  s_mul_i32 s43, s42, 5
  s_sub_u32 s43, s41, s43
  s_mul_i32 s52, s42, 13108
  s_lshr_b32 s52, s52, 16
  s_mul_i32 s53, s52, 5
  s_sub_u32 s53, s42, s53
  s_mul_i32 s52, s52, 204800
  s_mul_i32 s54, s53, 51200
  s_add_u32 s54, s54, s52
  s_cmp_lt_u32 s53, 4
  s_cbranch_scc1 RL_C41
  s_add_u32 s44, s52, 20480
  s_add_u32 s45, s52, 46080
  s_add_u32 s46, s52, 71680
  s_add_u32 s47, s52, 97280
  s_add_u32 s48, s52, 122880
  s_add_u32 s49, s52, 148480
  s_add_u32 s50, s52, 174080
  s_add_u32 s51, s52, 199680
  s_branch RL_C51
RL_C41:
  s_add_u32 s44, s54, 0
  s_add_u32 s45, s54, 5120
  s_add_u32 s46, s54, 10240
  s_add_u32 s47, s54, 15360
  s_add_u32 s48, s54, 25600
  s_add_u32 s49, s54, 30720
  s_add_u32 s50, s54, 35840
  s_add_u32 s51, s54, 40960
RL_C51:
  s_lshl_b32 s53, s43, 8
  s_cmp_lt_u32 s40, s80
  s_cselect_b32 s54, 0, 1073741824
  v_add_u32 v32, s54, v28
  v_add_u32 v33, s54, v29
  v_add_u32 v24, s44, v32
  s_add_u32 m0, s81, 8192
  s_nop 0
  buffer_load_dwordx4 v24, s[36:39], s53 offen nt lds
  v_add_u32 v25, s45, v32
  s_add_u32 m0, s81, 9216
  s_nop 0
  buffer_load_dwordx4 v25, s[36:39], s53 offen nt lds
  v_add_u32 v26, s46, v33
  s_add_u32 m0, s81, 10240
  s_nop 0
  buffer_load_dwordx4 v26, s[36:39], s53 offen nt lds
  v_add_u32 v24, s47, v33
  s_add_u32 m0, s81, 11264
  s_nop 0
  buffer_load_dwordx4 v24, s[36:39], s53 offen nt lds
  v_add_u32 v25, s48, v32
  s_add_u32 m0, s81, 12288
  s_nop 0
  buffer_load_dwordx4 v25, s[36:39], s53 offen nt lds
  v_add_u32 v26, s49, v32
  s_add_u32 m0, s81, 13312
  s_nop 0
  buffer_load_dwordx4 v26, s[36:39], s53 offen nt lds
  v_add_u32 v24, s50, v33
  s_add_u32 m0, s81, 14336
  s_nop 0
  buffer_load_dwordx4 v24, s[36:39], s53 offen nt lds
  v_add_u32 v25, s51, v33
  s_add_u32 m0, s81, 15360
  s_nop 0
  buffer_load_dwordx4 v25, s[36:39], s53 offen nt lds
  s_branch RE_ISSUED
RL_E:
  s_and_b32 s40, s12, 1
  s_lshl_b32 s3, s40, 3
  s_add_u32 s3, s3, 40
  s_load_dwordx2 s[36:37], s[0:1], s3
  s_mov_b32 s38, 2211840
  s_mov_b32 s39, 0x20000
  s_mov_b32 s78, 0
  s_sub_u32 s41, s2, 80
  s_lshl_b32 s41, s41, 1
  s_lshr_b32 s3, s12, 1
  s_add_u32 s41, s41, s3
  s_lshr_b32 s79, s41, 3
  s_and_b32 s80, s41, 7
  s_mul_i32 s81, s3, 20480
  s_add_u32 s81, s81, 98304
  v_lshrrev_b32 v24, 3, v0
  v_mul_u32_u24 v24, 3456, v24
  v_bfe_u32 v25, v0, 4, 1
  v_lshlrev_b32 v25, 1, v25
  v_and_b32 v26, 7, v0
  v_xor_b32 v25, v25, v26
  s_lshl_b32 s3, s40, 2
  v_xor_b32 v25, s3, v25
  v_lshl_add_u32 v28, v25, 4, v24
  s_mul_i32 s44, s80, 276480
  s_lshl_b32 s3, s79, 7
  s_add_u32 s44, s44, s3
  s_mul_i32 s52, s40, 10240
  s_add_u32 s52, s52, s81
  s_waitcnt lgkmcnt(0)
  s_add_u32 m0, s52, 0
  s_nop 0
  buffer_load_dwordx4 v28, s[36:39], s44 offen nt lds
  s_add_u32 s44, s44, 27648
  s_add_u32 m0, s52, 1024
  s_nop 0
  buffer_load_dwordx4 v28, s[36:39], s44 offen nt lds
  s_add_u32 s44, s44, 27648
  s_add_u32 m0, s52, 2048
  s_nop 0
  buffer_load_dwordx4 v28, s[36:39], s44 offen nt lds
  s_add_u32 s44, s44, 27648
  s_add_u32 m0, s52, 3072
  s_nop 0
  buffer_load_dwordx4 v28, s[36:39], s44 offen nt lds
  s_add_u32 s44, s44, 27648
  s_add_u32 m0, s52, 4096
  s_nop 0
  buffer_load_dwordx4 v28, s[36:39], s44 offen nt lds
  s_add_u32 s44, s44, 27648
  s_add_u32 m0, s52, 5120
  s_nop 0
  buffer_load_dwordx4 v28, s[36:39], s44 offen nt lds
  s_add_u32 s44, s44, 27648
  s_add_u32 m0, s52, 6144
  s_nop 0
  buffer_load_dwordx4 v28, s[36:39], s44 offen nt lds
  s_add_u32 s44, s44, 27648
  s_add_u32 m0, s52, 7168
  s_nop 0
  buffer_load_dwordx4 v28, s[36:39], s44 offen nt lds
  s_add_u32 s44, s44, 27648
  s_add_u32 m0, s52, 8192
  s_nop 0
  buffer_load_dwordx4 v28, s[36:39], s44 offen nt lds
  s_add_u32 s44, s44, 27648
  s_add_u32 m0, s52, 9216
  s_nop 0
  buffer_load_dwordx4 v28, s[36:39], s44 offen nt lds
  s_add_u32 s44, s44, 27648
  s_branch RE_ISSUED
RE_ISSUED:
  s_mov_b64 exec, 1
  buffer_store_dword v21, v1, s[8:11], s57 offen sc1
  s_mov_b64 exec, -1
  v_mov_b32 v248, -1
  v_mov_b32 v249, -1
  v_mov_b32 v250, -1
  v_mov_b32 v251, -1
  s_mul_i32 s15, s67, 69632
  s_add_u32 s15, s15, 10223616
  s_lshl_b32 s14, s66, 2
  s_add_u32 s14, s14, s12
  s_lshl_b32 s14, s14, 10
  s_add_u32 s14, s14, s15
  buffer_store_dwordx4 v[248:251], v1, s[8:11], s14 offen sc1
  s_mul_i32 s14, s67, 167936
  s_add_u32 s14, s14, 12648448
  s_mul_i32 s25, s12, 1024
  s_add_u32 s28, s14, s25
  s_mul_i32 s27, s12, 8192
  s_add_u32 s30, s14, s27
  s_mul_i32 s14, s67, 293888
  s_add_u32 s14, s14, 16187392
  s_mul_i32 s26, s12, 7168
  s_add_u32 s31, s14, s25
  s_add_u32 s32, s14, s26
  s_add_u32 s33, s14, s27
  s_lshl_b32 s68, s66, 2
  s_add_u32 s68, s68, s12
  s_and_b32 s3, s67, 1
  s_lshl_b32 s69, s66, 1
  s_add_u32 s69, s69, s3
  s_lshr_b32 s76, s67, 1
  s_mul_i32 s36, s68, 40960
  s_lshl_b32 s37, s68, 12
  s_mul_i32 s39, s67, 69632
  s_add_u32 s39, s39, 10223616
  s_lshl_b32 s3, s66, 12
  s_add_u32 s38, s39, s3
  s_lshr_b32 s14, s67, 2
  s_and_b32 s15, s67, 3
  s_mul_i32 s3, s14, 5120
  s_mul_i32 s40, s68, 114688
  s_add_u32 s40, s40, s3
  s_add_u32 s40, s40, 2883584
  s_lshl_b32 s3, s15, 8
  s_add_u32 s41, s40, s3
  s_add_u32 s41, s41, 4096
  s_lshl_b32 s3, s15, 10
  s_add_u32 s40, s40, s3
  s_mul_i32 s60, s68, 114688
  s_mul_i32 s3, s14, 14336
  s_add_u32 s60, s60, s3
  s_add_u32 s60, s60, 2883584
  s_mul_i32 s3, s15, 1024
  s_add_u32 s61, s60, s3
  s_add_u32 s61, s61, 10240
  s_mul_i32 s3, s15, 2560
  s_add_u32 s60, s60, s3
  s_lshl_b32 s44, s68, 6
  s_lshl_b32 s3, s67, 2
  s_add_u32 s42, s44, s3
  s_lshl_b32 s14, s69, 2
  s_add_u32 s14, s14, s12
  s_lshl_b32 s43, s14, 5
  s_lshl_b32 s3, s76, 2
  s_add_u32 s43, s43, s3
  s_mul_i32 s62, s14, 20480
  s_mul_i32 s3, s76, 160
  s_add_u32 s62, s62, s3
  s_lshl_b32 s45, s69, 7
  s_lshl_b32 s3, s12, 4
  s_add_u32 s45, s45, s3
  s_lshr_b32 s15, s14, 1
  s_and_b32 s14, s14, 1
  s_lshl_b32 s14, s14, 8
  s_mul_i32 s58, s15, 40960
  s_mul_i32 s3, s76, 5120
  s_add_u32 s58, s58, s3
  s_add_u32 s58, s58, s14
  s_lshl_b32 s59, s15, 12
  s_add_u32 s59, s59, s14
  s_lshl_b32 s3, s76, 9
  s_add_u32 s59, s59, s3
  s_mul_i32 s55, s76, 102400
  s_mul_i32 s3, s12, 25600
  s_add_u32 s55, s55, s3
  s_add_u32 s55, s55, 15335424
  s_mul_i32 s56, s76, 286720
  s_mul_i32 s3, s12, 71680
  s_add_u32 s56, s56, s3
  s_add_u32 s56, s56, 20905984
  s_add_u32 s3, s12, 1
  s_and_b32 s3, s3, 3
  s_lshl_b32 s14, s69, 2
  s_add_u32 s3, s3, s14
  s_mul_i32 s46, s3, 57344
  s_mul_i32 s14, s12, 5120
  s_add_u32 s46, s46, s14
  s_add_u32 s46, s46, 2883584
  s_mul_i32 s50, s3, 57344
  s_mul_i32 s14, s12, 14336
  s_add_u32 s50, s50, s14
  s_add_u32 s50, s50, 2883584
  s_add_u32 s3, s12, 2
  s_and_b32 s3, s3, 3
  s_lshl_b32 s14, s69, 2
  s_add_u32 s3, s3, s14
  s_mul_i32 s47, s3, 57344
  s_mul_i32 s14, s12, 5120
  s_add_u32 s47, s47, s14
  s_add_u32 s47, s47, 2883584
  s_mul_i32 s51, s3, 57344
  s_mul_i32 s14, s12, 14336
  s_add_u32 s51, s51, s14
  s_add_u32 s51, s51, 2883584
  s_add_u32 s3, s12, 3
  s_and_b32 s3, s3, 3
  s_lshl_b32 s14, s69, 2
  s_add_u32 s3, s3, s14
  s_mul_i32 s48, s3, 57344
  s_mul_i32 s14, s12, 5120
  s_add_u32 s48, s48, s14
  s_add_u32 s48, s48, 2883584
  s_mul_i32 s52, s3, 57344
  s_mul_i32 s14, s12, 14336
  s_add_u32 s52, s52, s14
  s_add_u32 s52, s52, 2883584
  s_add_u32 s3, s12, 4
  s_and_b32 s3, s3, 3
  s_lshl_b32 s14, s69, 2
  s_add_u32 s3, s3, s14
  s_mul_i32 s49, s3, 57344
  s_mul_i32 s14, s12, 5120
  s_add_u32 s49, s49, s14
  s_add_u32 s49, s49, 2883584
  s_mul_i32 s53, s3, 57344
  s_mul_i32 s14, s12, 14336
  s_add_u32 s53, s53, s14
  s_add_u32 s53, s53, 2883584
  s_cmp_eq_u32 s78, 3
  s_cbranch_scc1 M_FOLD
  s_cmp_eq_u32 s78, 0
  s_cbranch_scc1 RP_E
  s_waitcnt vmcnt(21)
  v_mov_b32 v10, v240
  v_mov_b32 v11, v241
  v_mov_b32 v12, v242
  v_mov_b32 v13, v243
  s_waitcnt vmcnt(20)
  v_mov_b32 v14, v244
  v_mov_b32 v15, v245
  v_mov_b32 v16, v246
  v_mov_b32 v17, v247
  v_permlane32_swap_b32 v10, v12
  v_permlane32_swap_b32 v11, v13
  v_permlane32_swap_b32 v14, v16
  v_permlane32_swap_b32 v15, v17
  s_add_u32 s3, s58, 0
  buffer_store_dwordx4 v[240:243], v7, s[8:11], s3 offen sc1
  buffer_store_dwordx4 v[244:247], v7, s[8:11], s3 offen offset:2048 sc1
  s_addk_i32 s3, 4096
  s_waitcnt vmcnt(21)
  buffer_store_dwordx2 v[18:19], v6, s[8:11], s3 offen sc1
  s_mov_b32 s3, 0x3f803f80
  v_mov_b32 v208, 0
  v_mov_b32 v209, 0
  v_dot2_f32_bf16 v208, v10, s3, v208
  v_dot2_f32_bf16 v209, v10, v10, v209
  v_dot2_f32_bf16 v208, v11, s3, v208
  v_dot2_f32_bf16 v209, v11, v11, v209
  v_dot2_f32_bf16 v208, v12, s3, v208
  v_dot2_f32_bf16 v209, v12, v12, v209
  v_dot2_f32_bf16 v208, v13, s3, v208
  v_dot2_f32_bf16 v209, v13, v13, v209
  v_dot2_f32_bf16 v208, v14, s3, v208
  v_dot2_f32_bf16 v209, v14, v14, v209
  v_dot2_f32_bf16 v208, v15, s3, v208
  v_dot2_f32_bf16 v209, v15, v15, v209
  v_dot2_f32_bf16 v208, v16, s3, v208
  v_dot2_f32_bf16 v209, v16, v16, v209
  v_dot2_f32_bf16 v208, v17, s3, v208
  v_dot2_f32_bf16 v209, v17, v17, v209
  v_dot2_f32_bf16 v208, v18, s3, v208
  v_dot2_f32_bf16 v209, v18, v18, v209
  v_dot2_f32_bf16 v208, v19, s3, v208
  v_dot2_f32_bf16 v209, v19, v19, v209
  v_mov_b32 v210, v20
  v_mov_b32 v211, v20
  v_mov_b32 v212, v208
  v_mov_b32 v213, v209
  s_nop 0
  v_permlane16_swap_b32 v208, v212
  v_permlane16_swap_b32 v209, v213
  v_add_f32 v208, v208, v212
  v_add_f32 v209, v209, v213
  v_mov_b32 v212, v208
  v_mov_b32 v213, v209
  s_nop 0
  v_permlane32_swap_b32 v208, v212
  v_permlane32_swap_b32 v209, v213
  v_add_f32 v208, v208, v212
  v_add_f32 v209, v209, v213
  s_add_u32 s3, s59, 2621440
  v_lshrrev_b32 v68, 4, v0
  v_bfe_u32 v69, v0, 2, 2
  v_lshl_add_u32 v68, v68, 3, v69
  v_lshlrev_b32 v68, 8, v68
  v_bfe_u32 v69, v0, 2, 3
  v_lshl_add_u32 v68, v69, 5, v68
  v_and_b32 v69, 1, v0
  v_lshl_add_u32 v68, v69, 4, v68
  v_bfe_u32 v69, v0, 1, 1
  v_lshl_add_u32 v68, v69, 3, v68
  v_add_u32 v72, s81, v68
  v_xor_b32 v73, 32, v72
  v_xor_b32 v74, 64, v72
  v_xor_b32 v75, 96, v72
  v_xor_b32 v76, 128, v72
  v_xor_b32 v77, 160, v72
  v_xor_b32 v78, 192, v72
  v_xor_b32 v79, 224, v72
  s_cmp_eq_u32 s78, 1
  s_mov_b32 s82, 102400
  s_cselect_b32 s82, 286720, s82
  s_mov_b32 s83, 15335424
  s_cselect_b32 s83, 20905984, s83
  s_add_u32 s84, s79, 0
  s_cmp_ge_u32 s84, s80
  s_cselect_b32 s89, 1073741824, 0
  s_waitcnt vmcnt(13)
  ds_read_b64_tr_b16 v[80:81], v72 offset:0
  ds_read_b64_tr_b16 v[82:83], v72 offset:1024
  ds_read_b64_tr_b16 v[84:85], v73 offset:0
  ds_read_b64_tr_b16 v[86:87], v73 offset:1024
  ds_read_b64_tr_b16 v[88:89], v74 offset:0
  ds_read_b64_tr_b16 v[90:91], v74 offset:1024
  ds_read_b64_tr_b16 v[92:93], v75 offset:0
  ds_read_b64_tr_b16 v[94:95], v75 offset:1024
  ds_read_b64_tr_b16 v[96:97], v76 offset:0
  ds_read_b64_tr_b16 v[98:99], v76 offset:1024
  ds_read_b64_tr_b16 v[100:101], v77 offset:0
  ds_read_b64_tr_b16 v[102:103], v77 offset:1024
  ds_read_b64_tr_b16 v[104:105], v78 offset:0
  ds_read_b64_tr_b16 v[106:107], v78 offset:1024
  ds_read_b64_tr_b16 v[108:109], v79 offset:0
  s_waitcnt lgkmcnt(14)
  ds_read_b64_tr_b16 v[110:111], v79 offset:1024
  s_sub_u32 s85, s84, 280
  s_cselect_b32 s84, s84, s85
  s_mul_i32 s87, s84, 13108
  s_lshr_b32 s87, s87, 16
  s_mul_i32 s88, s87, 5
  s_sub_u32 s88, s84, s88
  s_mul_i32 s87, s87, 5120
  s_add_u32 s87, s87, s83
  s_add_u32 s87, s87, s89
  s_lshl_b32 s84, s88, 3
  s_add_u32 s84, s84, 0
  s_mul_i32 s85, s84, 13108
  s_lshr_b32 s85, s85, 16
  s_mul_i32 s86, s85, 5
  s_sub_u32 s86, s84, s86
  s_mul_i32 s85, s85, s82
  s_lshl_b32 s86, s86, 10
  s_add_u32 s85, s85, s86
  s_add_u32 s85, s85, s87
  s_waitcnt lgkmcnt(14)
  buffer_store_dwordx4 v[80:83], v1, s[8:11], s85 offen sc1
  s_lshl_b32 s84, s88, 3
  s_add_u32 s84, s84, 1
  s_mul_i32 s85, s84, 13108
  s_lshr_b32 s85, s85, 16
  s_mul_i32 s86, s85, 5
  s_sub_u32 s86, s84, s86
  s_mul_i32 s85, s85, s82
  s_lshl_b32 s86, s86, 10
  s_add_u32 s85, s85, s86
  s_add_u32 s85, s85, s87
  s_waitcnt lgkmcnt(12)
  buffer_store_dwordx4 v[84:87], v1, s[8:11], s85 offen sc1
  s_lshl_b32 s84, s88, 3
  s_add_u32 s84, s84, 2
  s_mul_i32 s85, s84, 13108
  s_lshr_b32 s85, s85, 16
  s_mul_i32 s86, s85, 5
  s_sub_u32 s86, s84, s86
  s_mul_i32 s85, s85, s82
  s_lshl_b32 s86, s86, 10
  s_add_u32 s85, s85, s86
  s_add_u32 s85, s85, s87
  s_waitcnt lgkmcnt(10)
  buffer_store_dwordx4 v[88:91], v1, s[8:11], s85 offen sc1
  s_lshl_b32 s84, s88, 3
  s_add_u32 s84, s84, 3
  s_mul_i32 s85, s84, 13108
  s_lshr_b32 s85, s85, 16
  s_mul_i32 s86, s85, 5
  s_sub_u32 s86, s84, s86
  s_mul_i32 s85, s85, s82
  s_lshl_b32 s86, s86, 10
  s_add_u32 s85, s85, s86
  s_add_u32 s85, s85, s87
  s_waitcnt lgkmcnt(8)
  buffer_store_dwordx4 v[92:95], v1, s[8:11], s85 offen sc1
  s_lshl_b32 s84, s88, 3
  s_add_u32 s84, s84, 4
  s_mul_i32 s85, s84, 13108
  s_lshr_b32 s85, s85, 16
  s_mul_i32 s86, s85, 5
  s_sub_u32 s86, s84, s86
  s_mul_i32 s85, s85, s82
  s_lshl_b32 s86, s86, 10
  s_add_u32 s85, s85, s86
  s_add_u32 s85, s85, s87
  s_waitcnt lgkmcnt(6)
  buffer_store_dwordx4 v[96:99], v1, s[8:11], s85 offen sc1
  s_lshl_b32 s84, s88, 3
  s_add_u32 s84, s84, 5
  s_mul_i32 s85, s84, 13108
  s_lshr_b32 s85, s85, 16
  s_mul_i32 s86, s85, 5
  s_sub_u32 s86, s84, s86
  s_mul_i32 s85, s85, s82
  s_lshl_b32 s86, s86, 10
  s_add_u32 s85, s85, s86
  s_add_u32 s85, s85, s87
  s_waitcnt lgkmcnt(4)
  buffer_store_dwordx4 v[100:103], v1, s[8:11], s85 offen sc1
  s_lshl_b32 s84, s88, 3
  s_add_u32 s84, s84, 6
  s_mul_i32 s85, s84, 13108
  s_lshr_b32 s85, s85, 16
  s_mul_i32 s86, s85, 5
  s_sub_u32 s86, s84, s86
  s_mul_i32 s85, s85, s82
  s_lshl_b32 s86, s86, 10
  s_add_u32 s85, s85, s86
  s_add_u32 s85, s85, s87
  s_waitcnt lgkmcnt(2)
  buffer_store_dwordx4 v[104:107], v1, s[8:11], s85 offen sc1
  s_lshl_b32 s84, s88, 3
  s_add_u32 s84, s84, 7
  s_mul_i32 s85, s84, 13108
  s_lshr_b32 s85, s85, 16
  s_mul_i32 s86, s85, 5
  s_sub_u32 s86, s84, s86
  s_mul_i32 s85, s85, s82
  s_lshl_b32 s86, s86, 10
  s_add_u32 s85, s85, s86
  s_add_u32 s85, s85, s87
  s_waitcnt lgkmcnt(0)
  buffer_store_dwordx4 v[108:111], v1, s[8:11], s85 offen sc1
  s_add_u32 s84, s79, 1
  s_cmp_ge_u32 s84, s80
  s_cselect_b32 s89, 1073741824, 0
  s_waitcnt vmcnt(13)
  ds_read_b64_tr_b16 v[80:81], v72 offset:8192
  ds_read_b64_tr_b16 v[82:83], v72 offset:9216
  ds_read_b64_tr_b16 v[84:85], v73 offset:8192
  ds_read_b64_tr_b16 v[86:87], v73 offset:9216
  ds_read_b64_tr_b16 v[88:89], v74 offset:8192
  ds_read_b64_tr_b16 v[90:91], v74 offset:9216
  ds_read_b64_tr_b16 v[92:93], v75 offset:8192
  ds_read_b64_tr_b16 v[94:95], v75 offset:9216
  ds_read_b64_tr_b16 v[96:97], v76 offset:8192
  ds_read_b64_tr_b16 v[98:99], v76 offset:9216
  ds_read_b64_tr_b16 v[100:101], v77 offset:8192
  ds_read_b64_tr_b16 v[102:103], v77 offset:9216
  ds_read_b64_tr_b16 v[104:105], v78 offset:8192
  ds_read_b64_tr_b16 v[106:107], v78 offset:9216
  ds_read_b64_tr_b16 v[108:109], v79 offset:8192
  s_waitcnt lgkmcnt(14)
  ds_read_b64_tr_b16 v[110:111], v79 offset:9216
  s_sub_u32 s85, s84, 280
  s_cselect_b32 s84, s84, s85
  s_mul_i32 s87, s84, 13108
  s_lshr_b32 s87, s87, 16
  s_mul_i32 s88, s87, 5
  s_sub_u32 s88, s84, s88
  s_mul_i32 s87, s87, 5120
  s_add_u32 s87, s87, s83
  s_add_u32 s87, s87, s89
  s_lshl_b32 s84, s88, 3
  s_add_u32 s84, s84, 0
  s_mul_i32 s85, s84, 13108
  s_lshr_b32 s85, s85, 16
  s_mul_i32 s86, s85, 5
  s_sub_u32 s86, s84, s86
  s_mul_i32 s85, s85, s82
  s_lshl_b32 s86, s86, 10
  s_add_u32 s85, s85, s86
  s_add_u32 s85, s85, s87
  s_waitcnt lgkmcnt(14)
  buffer_store_dwordx4 v[80:83], v1, s[8:11], s85 offen sc1
  s_lshl_b32 s84, s88, 3
  s_add_u32 s84, s84, 1
  s_mul_i32 s85, s84, 13108
  s_lshr_b32 s85, s85, 16
  s_mul_i32 s86, s85, 5
  s_sub_u32 s86, s84, s86
  s_mul_i32 s85, s85, s82
  s_lshl_b32 s86, s86, 10
  s_add_u32 s85, s85, s86
  s_add_u32 s85, s85, s87
  s_waitcnt lgkmcnt(12)
  buffer_store_dwordx4 v[84:87], v1, s[8:11], s85 offen sc1
  s_lshl_b32 s84, s88, 3
  s_add_u32 s84, s84, 2
  s_mul_i32 s85, s84, 13108
  s_lshr_b32 s85, s85, 16
  s_mul_i32 s86, s85, 5
  s_sub_u32 s86, s84, s86
  s_mul_i32 s85, s85, s82
  s_lshl_b32 s86, s86, 10
  s_add_u32 s85, s85, s86
  s_add_u32 s85, s85, s87
  s_waitcnt lgkmcnt(10)
  buffer_store_dwordx4 v[88:91], v1, s[8:11], s85 offen sc1
  s_lshl_b32 s84, s88, 3
  s_add_u32 s84, s84, 3
  s_mul_i32 s85, s84, 13108
  s_lshr_b32 s85, s85, 16
  s_mul_i32 s86, s85, 5
  s_sub_u32 s86, s84, s86
  s_mul_i32 s85, s85, s82
  s_lshl_b32 s86, s86, 10
  s_add_u32 s85, s85, s86
  s_add_u32 s85, s85, s87
  s_waitcnt lgkmcnt(8)
  buffer_store_dwordx4 v[92:95], v1, s[8:11], s85 offen sc1
  s_lshl_b32 s84, s88, 3
  s_add_u32 s84, s84, 4
  s_mul_i32 s85, s84, 13108
  s_lshr_b32 s85, s85, 16
  s_mul_i32 s86, s85, 5
  s_sub_u32 s86, s84, s86
  s_mul_i32 s85, s85, s82
  s_lshl_b32 s86, s86, 10
  s_add_u32 s85, s85, s86
  s_add_u32 s85, s85, s87
  s_waitcnt lgkmcnt(6)
  buffer_store_dwordx4 v[96:99], v1, s[8:11], s85 offen sc1
  s_lshl_b32 s84, s88, 3
  s_add_u32 s84, s84, 5
  s_mul_i32 s85, s84, 13108
  s_lshr_b32 s85, s85, 16
  s_mul_i32 s86, s85, 5
  s_sub_u32 s86, s84, s86
  s_mul_i32 s85, s85, s82
  s_lshl_b32 s86, s86, 10
  s_add_u32 s85, s85, s86
  s_add_u32 s85, s85, s87
  s_waitcnt lgkmcnt(4)
  buffer_store_dwordx4 v[100:103], v1, s[8:11], s85 offen sc1
  s_lshl_b32 s84, s88, 3
  s_add_u32 s84, s84, 6
  s_mul_i32 s85, s84, 13108
  s_lshr_b32 s85, s85, 16
  s_mul_i32 s86, s85, 5
  s_sub_u32 s86, s84, s86
  s_mul_i32 s85, s85, s82
  s_lshl_b32 s86, s86, 10
  s_add_u32 s85, s85, s86
  s_add_u32 s85, s85, s87
  s_waitcnt lgkmcnt(2)
  buffer_store_dwordx4 v[104:107], v1, s[8:11], s85 offen sc1
  s_lshl_b32 s84, s88, 3
  s_add_u32 s84, s84, 7
  s_mul_i32 s85, s84, 13108
  s_lshr_b32 s85, s85, 16
  s_mul_i32 s86, s85, 5
  s_sub_u32 s86, s84, s86
  s_mul_i32 s85, s85, s82
  s_lshl_b32 s86, s86, 10
  s_add_u32 s85, s85, s86
  s_add_u32 s85, s85, s87
  s_waitcnt lgkmcnt(0)
  buffer_store_dwordx4 v[108:111], v1, s[8:11], s85 offen sc1
  s_branch M_ROLED
RP_E:
  v_lshrrev_b32 v68, 5, v0
  v_bfe_u32 v69, v0, 2, 2
  v_lshl_add_u32 v68, v68, 3, v69
  v_lshlrev_b32 v68, 7, v68
  v_bfe_u32 v69, v0, 3, 2
  v_lshl_add_u32 v68, v69, 5, v68
  v_bfe_u32 v69, v0, 4, 1
  v_mul_u32_u24 v69, 10240, v69
  v_add_u32 v68, v68, v69
  v_and_b32 v69, 1, v0
  v_lshl_add_u32 v68, v69, 4, v68
  v_bfe_u32 v69, v0, 1, 1
  v_lshl_add_u32 v68, v69, 3, v68
  v_add_u32 v68, s81, v68
  s_and_b32 s90, s12, 1
  s_lshl_b32 s91, s90, 6
  v_xor_b32 v72, s91, v68
  v_xor_b32 v73, 32, v72
  s_lshl_b32 s90, s90, 1
  s_lshl_b32 s91, s79, 2
  s_add_u32 s90, s90, s91
  s_lshr_b32 s91, s80, 2
  s_lshl_b32 s91, s91, 9
  s_and_b32 s87, s80, 3
  s_lshl_b32 s87, s87, 2
  s_add_u32 s87, s87, s91
  s_add_u32 s82, s90, 0
  s_mul_i32 s83, s82, 9363
  s_lshr_b32 s83, s83, 16
  s_mul_i32 s84, s83, 7
  s_sub_u32 s84, s82, s84
  s_mul_i32 s83, s83, 293888
  s_add_u32 s83, s83, 16187392
  s_mul_i32 s85, s84, 41
  s_cmp_lt_u32 s84, 3
  s_cselect_b32 s85, s84, s85
  s_cselect_b32 s86, 3, 1
  s_lshl_b32 s86, s86, 10
  s_lshl_b32 s85, s85, 10
  s_add_u32 s83, s83, s85
  s_mul_i32 s85, s86, 40
  s_add_u32 s88, s83, s85
  s_add_u32 s88, s88, s87
  s_mul_i32 s85, s80, 5
  s_mul_i32 s85, s85, s86
  s_add_u32 s14, s83, s85
  s_mov_b32 s64, s86
  s_mov_b32 s91, 0x3f803f80
  v_mov_b32 v120, 0
  s_add_u32 s82, s90, 1
  s_mul_i32 s83, s82, 9363
  s_lshr_b32 s83, s83, 16
  s_mul_i32 s84, s83, 7
  s_sub_u32 s84, s82, s84
  s_mul_i32 s83, s83, 293888
  s_add_u32 s83, s83, 16187392
  s_mul_i32 s85, s84, 41
  s_cmp_lt_u32 s84, 3
  s_cselect_b32 s85, s84, s85
  s_cselect_b32 s86, 3, 1
  s_lshl_b32 s86, s86, 10
  s_lshl_b32 s85, s85, 10
  s_add_u32 s83, s83, s85
  s_mul_i32 s85, s86, 40
  s_add_u32 s89, s83, s85
  s_add_u32 s89, s89, s87
  s_mul_i32 s85, s80, 5
  s_mul_i32 s85, s85, s86
  s_add_u32 s15, s83, s85
  s_mov_b32 s65, s86
  s_mov_b32 s91, 0x3f803f80
  v_mov_b32 v121, 0
  s_waitcnt vmcnt(15)
  v_mov_b32 v10, v240
  v_mov_b32 v11, v241
  v_mov_b32 v12, v242
  v_mov_b32 v13, v243
  s_waitcnt vmcnt(14)
  v_mov_b32 v14, v244
  v_mov_b32 v15, v245
  v_mov_b32 v16, v246
  v_mov_b32 v17, v247
  v_permlane32_swap_b32 v10, v12
  v_permlane32_swap_b32 v11, v13
  v_permlane32_swap_b32 v14, v16
  v_permlane32_swap_b32 v15, v17
  s_add_u32 s3, s58, 0
  buffer_store_dwordx4 v[240:243], v7, s[8:11], s3 offen sc1
  buffer_store_dwordx4 v[244:247], v7, s[8:11], s3 offen offset:2048 sc1
  s_addk_i32 s3, 4096
  s_waitcnt vmcnt(15)
  buffer_store_dwordx2 v[18:19], v6, s[8:11], s3 offen sc1
  s_mov_b32 s3, 0x3f803f80
  v_mov_b32 v208, 0
  v_mov_b32 v209, 0
  v_dot2_f32_bf16 v208, v10, s3, v208
  v_dot2_f32_bf16 v209, v10, v10, v209
  v_dot2_f32_bf16 v208, v11, s3, v208
  v_dot2_f32_bf16 v209, v11, v11, v209
  v_dot2_f32_bf16 v208, v12, s3, v208
  v_dot2_f32_bf16 v209, v12, v12, v209
  v_dot2_f32_bf16 v208, v13, s3, v208
  v_dot2_f32_bf16 v209, v13, v13, v209
  v_dot2_f32_bf16 v208, v14, s3, v208
  v_dot2_f32_bf16 v209, v14, v14, v209
  v_dot2_f32_bf16 v208, v15, s3, v208
  v_dot2_f32_bf16 v209, v15, v15, v209
  v_dot2_f32_bf16 v208, v16, s3, v208
  v_dot2_f32_bf16 v209, v16, v16, v209
  v_dot2_f32_bf16 v208, v17, s3, v208
  v_dot2_f32_bf16 v209, v17, v17, v209
  v_dot2_f32_bf16 v208, v18, s3, v208
  v_dot2_f32_bf16 v209, v18, v18, v209
  v_dot2_f32_bf16 v208, v19, s3, v208
  v_dot2_f32_bf16 v209, v19, v19, v209
  v_mov_b32 v210, v20
  v_mov_b32 v211, v20
  v_mov_b32 v212, v208
  v_mov_b32 v213, v209
  s_nop 0
  v_permlane16_swap_b32 v208, v212
  v_permlane16_swap_b32 v209, v213
  v_add_f32 v208, v208, v212
  v_add_f32 v209, v209, v213
  v_mov_b32 v212, v208
  v_mov_b32 v213, v209
  s_nop 0
  v_permlane32_swap_b32 v208, v212
  v_permlane32_swap_b32 v209, v213
  v_add_f32 v208, v208, v212
  v_add_f32 v209, v209, v213
  s_add_u32 s3, s59, 2621440
  s_waitcnt vmcnt(13)
  s_barrier
  ds_read_b64_tr_b16 v[80:81], v72 offset:0
  ds_read_b64_tr_b16 v[82:83], v72 offset:512
  ds_read_b64_tr_b16 v[100:101], v73 offset:0
  ds_read_b64_tr_b16 v[102:103], v73 offset:512
  s_waitcnt lgkmcnt(2)
  buffer_store_dwordx4 v[80:83], v1, s[8:11], s14 offen sc1
  s_add_u32 s14, s14, s64
  s_waitcnt lgkmcnt(0)
  buffer_store_dwordx4 v[100:103], v1, s[8:11], s15 offen sc1
  s_add_u32 s15, s15, s65
  v_dot2_f32_bf16 v120, v80, s91, v120
  v_dot2_f32_bf16 v121, v100, s91, v121
  v_dot2_f32_bf16 v120, v81, s91, v120
  v_dot2_f32_bf16 v121, v101, s91, v121
  v_dot2_f32_bf16 v120, v82, s91, v120
  v_dot2_f32_bf16 v121, v102, s91, v121
  v_dot2_f32_bf16 v120, v83, s91, v120
  v_dot2_f32_bf16 v121, v103, s91, v121
  s_waitcnt vmcnt(13)
  s_barrier
  ds_read_b64_tr_b16 v[84:85], v72 offset:2048
  ds_read_b64_tr_b16 v[86:87], v72 offset:2560
  ds_read_b64_tr_b16 v[104:105], v73 offset:2048
  ds_read_b64_tr_b16 v[106:107], v73 offset:2560
  s_waitcnt lgkmcnt(2)
  buffer_store_dwordx4 v[84:87], v1, s[8:11], s14 offen sc1
  s_add_u32 s14, s14, s64
  s_waitcnt lgkmcnt(0)
  buffer_store_dwordx4 v[104:107], v1, s[8:11], s15 offen sc1
  s_add_u32 s15, s15, s65
  v_dot2_f32_bf16 v120, v84, s91, v120
  v_dot2_f32_bf16 v121, v104, s91, v121
  v_dot2_f32_bf16 v120, v85, s91, v120
  v_dot2_f32_bf16 v121, v105, s91, v121
  v_dot2_f32_bf16 v120, v86, s91, v120
  v_dot2_f32_bf16 v121, v106, s91, v121
  v_dot2_f32_bf16 v120, v87, s91, v120
  v_dot2_f32_bf16 v121, v107, s91, v121
  s_waitcnt vmcnt(13)
  s_barrier
  ds_read_b64_tr_b16 v[88:89], v72 offset:4096
  ds_read_b64_tr_b16 v[90:91], v72 offset:4608
  ds_read_b64_tr_b16 v[108:109], v73 offset:4096
  ds_read_b64_tr_b16 v[110:111], v73 offset:4608
  s_waitcnt lgkmcnt(2)
  buffer_store_dwordx4 v[88:91], v1, s[8:11], s14 offen sc1
  s_add_u32 s14, s14, s64
  s_waitcnt lgkmcnt(0)
  buffer_store_dwordx4 v[108:111], v1, s[8:11], s15 offen sc1
  s_add_u32 s15, s15, s65
  v_dot2_f32_bf16 v120, v88, s91, v120
  v_dot2_f32_bf16 v121, v108, s91, v121
  v_dot2_f32_bf16 v120, v89, s91, v120
  v_dot2_f32_bf16 v121, v109, s91, v121
  v_dot2_f32_bf16 v120, v90, s91, v120
  v_dot2_f32_bf16 v121, v110, s91, v121
  v_dot2_f32_bf16 v120, v91, s91, v120
  v_dot2_f32_bf16 v121, v111, s91, v121
  s_waitcnt vmcnt(13)
  s_barrier
  ds_read_b64_tr_b16 v[92:93], v72 offset:6144
  ds_read_b64_tr_b16 v[94:95], v72 offset:6656
  ds_read_b64_tr_b16 v[112:113], v73 offset:6144
  ds_read_b64_tr_b16 v[114:115], v73 offset:6656
  s_waitcnt lgkmcnt(2)
  buffer_store_dwordx4 v[92:95], v1, s[8:11], s14 offen sc1
  s_add_u32 s14, s14, s64
  s_waitcnt lgkmcnt(0)
  buffer_store_dwordx4 v[112:115], v1, s[8:11], s15 offen sc1
  s_add_u32 s15, s15, s65
  v_dot2_f32_bf16 v120, v92, s91, v120
  v_dot2_f32_bf16 v121, v112, s91, v121
  v_dot2_f32_bf16 v120, v93, s91, v120
  v_dot2_f32_bf16 v121, v113, s91, v121
  v_dot2_f32_bf16 v120, v94, s91, v120
  v_dot2_f32_bf16 v121, v114, s91, v121
  v_dot2_f32_bf16 v120, v95, s91, v120
  v_dot2_f32_bf16 v121, v115, s91, v121
  s_waitcnt vmcnt(13)
  s_barrier
  ds_read_b64_tr_b16 v[96:97], v72 offset:8192
  ds_read_b64_tr_b16 v[98:99], v72 offset:8704
  ds_read_b64_tr_b16 v[116:117], v73 offset:8192
  ds_read_b64_tr_b16 v[118:119], v73 offset:8704
  s_waitcnt lgkmcnt(2)
  buffer_store_dwordx4 v[96:99], v1, s[8:11], s14 offen sc1
  s_add_u32 s14, s14, s64
  s_waitcnt lgkmcnt(0)
  buffer_store_dwordx4 v[116:119], v1, s[8:11], s15 offen sc1
  s_add_u32 s15, s15, s65
  v_dot2_f32_bf16 v120, v96, s91, v120
  v_dot2_f32_bf16 v121, v116, s91, v121
  v_dot2_f32_bf16 v120, v97, s91, v120
  v_dot2_f32_bf16 v121, v117, s91, v121
  v_dot2_f32_bf16 v120, v98, s91, v120
  v_dot2_f32_bf16 v121, v118, s91, v121
  v_dot2_f32_bf16 v120, v99, s91, v120
  v_dot2_f32_bf16 v121, v119, s91, v121
  s_nop 1
  v_mov_b32 v68, v120
  s_nop 1
  v_permlane32_swap_b32 v120, v68
  v_add_f32 v120, v120, v68
  v_cvt_pk_bf16_f32 v68, v120, v120
  v_lshlrev_b32 v68, 16, v68
  v_sub_f32 v68, v120, v68
  v_cvt_pk_bf16_f32 v120, v120, v68
  v_mov_b32 v68, v121
  s_nop 1
  v_permlane32_swap_b32 v121, v68
  v_add_f32 v121, v121, v68
  v_cvt_pk_bf16_f32 v68, v121, v121
  v_lshlrev_b32 v68, 16, v68
  v_sub_f32 v68, v121, v68
  v_cvt_pk_bf16_f32 v121, v121, v68
  s_mov_b32 exec_hi, 0
  buffer_store_dword v120, v1, s[8:11], s88 offen sc1
  buffer_store_dword v121, v1, s[8:11], s89 offen sc1
  s_mov_b64 exec, -1
  s_branch M_ROLED
M_FOLD:
  s_lshl_b32 s3, s12, 6
  v_add_u32 v36, s3, v0
  v_mov_b32 v40, 0
  v_mov_b32 v41, 0
  v_mov_b32 v42, 0
  v_mov_b32 v43, 0
  v_lshlrev_b32 v32, 4, v36
  v_add_u32 v32, 98304, v32
  ds_write_b128 v32, v[40:43] offset:0
  ds_write_b128 v32, v[40:43] offset:4096
  ds_write_b128 v32, v[40:43] offset:8192
  v_cmp_le_u32 vcc, 100, v36
  s_nop 1
  v_cndmask_b32 v32, 0, 1, vcc
  v_mul_u32_u24 v33, 100, v32
  v_sub_u32 v33, v36, v33
  v_mul_u32_u24 v34, 52429, v33
  v_lshrrev_b32 v34, 18, v34
  v_mul_u32_u24 v35, 5, v34
  v_sub_u32 v33, v33, v35
  v_mul_u32_u24 v34, 88, v34
  v_lshl_add_u32 v34, v33, 3, v34
  v_mul_u32_u24 v32, 1800, v32
  v_add_u32 v34, v34, v32
  v_add_u32 v34, 98304, v34
  v_mul_u32_u24 v35, 90, v36
  v_add_u32 v35, 98304, v35
  v_mov_b32 v33, 0x3f80
  s_waitcnt lgkmcnt(0)
  s_barrier
  v_cmp_gt_u32 vcc, 200, v36
  s_nop 3
  s_and_saveexec_b64 s[64:65], vcc
  s_waitcnt vmcnt(14)
  ds_write_b64 v34, v[28:29] offset:0
  s_mov_b64 exec, -1
  v_cmp_gt_u32 vcc, 40, v36
  s_nop 3
  s_and_saveexec_b64 s[64:65], vcc
  ds_write_b16 v35, v33 offset:4224
  s_mov_b64 exec, -1
  v_lshrrev_b32 v32, 5, v0
  v_bfe_u32 v33, v0, 2, 2
  v_lshl_add_u32 v32, v32, 3, v33
  v_mul_u32_u24 v32, 88, v32
  v_add_u32 v32, 98304, v32
  v_bfe_u32 v33, v0, 4, 1
  v_bfe_u32 v34, v0, 1, 1
  v_lshl_add_u32 v33, v33, 1, v34
  v_lshlrev_b32 v38, 2, v33
  v_and_b32 v33, 1, v0
  v_mul_u32_u24 v39, 40, v33
  v_mov_b32 v35, 80
  v_add_u32 v33, 0, v38
  v_cmp_gt_u32 vcc, 20, v33
  v_lshl_add_u32 v33, v33, 1, v39
  s_nop 0
  v_cndmask_b32 v33, v35, v33, vcc
  v_add_u32 v44, v32, v33
  v_add_u32 v33, 16, v38
  v_cmp_gt_u32 vcc, 20, v33
  v_lshl_add_u32 v33, v33, 1, v39
  s_nop 0
  v_cndmask_b32 v33, v35, v33, vcc
  v_add_u32 v45, v32, v33
  v_add_u32 v33, -4, v38
  v_cmp_gt_u32 vcc, 20, v33
  v_lshl_add_u32 v33, v33, 1, v39
  s_nop 0
  v_cndmask_b32 v33, v35, v33, vcc
  v_add_u32 v46, v32, v33
  v_add_u32 v33, 12, v38
  v_cmp_gt_u32 vcc, 20, v33
  v_lshl_add_u32 v33, v33, 1, v39
  s_nop 0
  v_cndmask_b32 v33, v35, v33, vcc
  v_add_u32 v47, v32, v33
  v_add_u32 v33, -8, v38
  v_cmp_gt_u32 vcc, 20, v33
  v_lshl_add_u32 v33, v33, 1, v39
  s_nop 0
  v_cndmask_b32 v33, v35, v33, vcc
  v_add_u32 v48, v32, v33
  v_add_u32 v33, 8, v38
  v_cmp_gt_u32 vcc, 20, v33
  v_lshl_add_u32 v33, v33, 1, v39
  s_nop 0
  v_cndmask_b32 v33, v35, v33, vcc
  v_add_u32 v49, v32, v33
  s_waitcnt lgkmcnt(0)
  s_barrier
  ds_read_b64_tr_b16 v[52:53], v44 offset:0
  ds_read_b64_tr_b16 v[54:55], v44 offset:352
  ds_read_b64_tr_b16 v[56:57], v44 offset:1408
  ds_read_b64_tr_b16 v[58:59], v44 offset:1760
  ds_read_b64_tr_b16 v[60:61], v44 offset:2816
  ds_read_b64_tr_b16 v[62:63], v44 offset:3168
  ds_read_b64_tr_b16 v[64:65], v45 offset:0
  ds_read_b64_tr_b16 v[66:67], v45 offset:352
  ds_read_b64_tr_b16 v[68:69], v45 offset:1408
  ds_read_b64_tr_b16 v[70:71], v45 offset:1760
  ds_read_b64_tr_b16 v[72:73], v45 offset:2816
  ds_read_b64_tr_b16 v[74:75], v45 offset:3168
  ds_read_b64_tr_b16 v[76:77], v46 offset:4224
  ds_read_b64_tr_b16 v[78:79], v46 offset:4576
  ds_read_b64_tr_b16 v[80:81], v46 offset:5632
  s_waitcnt lgkmcnt(14)
  ds_read_b64_tr_b16 v[82:83], v46 offset:5984
  s_waitcnt lgkmcnt(14)
  ds_read_b64_tr_b16 v[84:85], v46 offset:7040
  s_waitcnt lgkmcnt(14)
  ds_read_b64_tr_b16 v[86:87], v46 offset:7392
  s_waitcnt lgkmcnt(14)
  ds_read_b64_tr_b16 v[88:89], v47 offset:4224
  s_waitcnt lgkmcnt(14)
  ds_read_b64_tr_b16 v[90:91], v47 offset:4576
  s_waitcnt lgkmcnt(14)
  ds_read_b64_tr_b16 v[92:93], v47 offset:5632
  s_waitcnt lgkmcnt(14)
  ds_read_b64_tr_b16 v[94:95], v47 offset:5984
  s_waitcnt lgkmcnt(14)
  ds_read_b64_tr_b16 v[96:97], v47 offset:7040
  s_waitcnt lgkmcnt(14)
  ds_read_b64_tr_b16 v[98:99], v47 offset:7392
  s_waitcnt lgkmcnt(14)
  ds_read_b64_tr_b16 v[100:101], v48 offset:0
  s_waitcnt lgkmcnt(14)
  ds_read_b64_tr_b16 v[102:103], v48 offset:352
  s_waitcnt lgkmcnt(14)
  ds_read_b64_tr_b16 v[104:105], v48 offset:1408
  s_waitcnt lgkmcnt(14)
  ds_read_b64_tr_b16 v[106:107], v48 offset:1760
  s_waitcnt lgkmcnt(14)
  ds_read_b64_tr_b16 v[108:109], v48 offset:2816
  s_waitcnt lgkmcnt(14)
  ds_read_b64_tr_b16 v[110:111], v48 offset:3168
  s_waitcnt lgkmcnt(14)
  ds_read_b64_tr_b16 v[112:113], v49 offset:0
  s_waitcnt lgkmcnt(14)
  ds_read_b64_tr_b16 v[114:115], v49 offset:352
  s_waitcnt lgkmcnt(14)
  ds_read_b64_tr_b16 v[116:117], v49 offset:1408
  s_waitcnt lgkmcnt(14)
  ds_read_b64_tr_b16 v[118:119], v49 offset:1760
  s_waitcnt lgkmcnt(14)
  ds_read_b64_tr_b16 v[120:121], v49 offset:2816
  s_waitcnt lgkmcnt(14)
  ds_read_b64_tr_b16 v[122:123], v49 offset:3168
  v_bfe_u32 v32, v0, 2, 3
  v_mul_u32_u24 v32, 1088, v32
  v_and_b32 v33, 3, v0
  v_lshl_add_u32 v32, v33, 8, v32
  s_mul_i32 s3, s12, 8704
  s_add_u32 s3, s3, 110592
  v_add_u32 v32, s3, v32
  v_lshrrev_b32 v34, 5, v0
  v_add_u32 v35, 0, v34
  v_xor_b32 v35, v35, v33
  v_lshl_add_u32 v188, v35, 4, v32
  v_add_u32 v35, 2, v34
  v_xor_b32 v35, v35, v33
  v_lshl_add_u32 v189, v35, 4, v32
  v_xor_b32 v35, 4, v33
  v_lshl_add_u32 v190, v35, 4, v32
  v_add_u32 v35, 5, v34
  v_xor_b32 v35, v35, v33
  v_lshl_add_u32 v191, v35, 4, v32
  v_add_u32 v35, 7, v34
  v_xor_b32 v35, v35, v33
  v_lshl_add_u32 v192, v35, 4, v32
  v_xor_b32 v35, 9, v33
  v_lshl_add_u32 v193, v35, 4, v32
  v_add_u32 v35, 10, v34
  v_xor_b32 v35, v35, v33
  v_lshl_add_u32 v194, v35, 4, v32
  v_add_u32 v35, 12, v34
  v_xor_b32 v35, v35, v33
  v_lshl_add_u32 v195, v35, 4, v32
  v_xor_b32 v35, 14, v33
  v_lshl_add_u32 v196, v35, 4, v32
  s_waitcnt vmcnt(6) lgkmcnt(14)
  ds_read_b128 a[0:3], v188
  s_waitcnt lgkmcnt(14)
  ds_read_b128 a[4:7], v189
  s_waitcnt lgkmcnt(14)
  ds_read_b128 a[8:11], v190
  s_waitcnt lgkmcnt(14)
  ds_read_b128 a[12:15], v191
  s_waitcnt lgkmcnt(14)
  ds_read_b128 a[16:19], v192
  s_waitcnt lgkmcnt(14)
  ds_read_b128 a[20:23], v193
  s_waitcnt lgkmcnt(14)
  ds_read_b128 a[24:27], v194
  s_waitcnt lgkmcnt(14)
  ds_read_b128 a[28:31], v195
  s_waitcnt lgkmcnt(14)
  ds_read_b128 a[32:35], v196
  s_waitcnt lgkmcnt(8)
  v_mfma_f32_32x32x16_bf16 v[124:139], a[0:3], v[52:55], 0
  s_waitcnt lgkmcnt(7)
  v_mfma_f32_32x32x16_bf16 v[124:139], a[4:7], v[56:59], v[124:139]
  s_waitcnt lgkmcnt(6)
  v_mfma_f32_32x32x16_bf16 v[124:139], a[8:11], v[60:63], v[124:139]
  v_mfma_f32_32x32x16_bf16 v[140:155], a[0:3], v[64:67], 0
  v_mfma_f32_32x32x16_bf16 v[140:155], a[4:7], v[68:71], v[140:155]
  v_mfma_f32_32x32x16_bf16 v[140:155], a[8:11], v[72:75], v[140:155]
  s_waitcnt lgkmcnt(5)
  v_mfma_f32_32x32x16_bf16 v[140:155], a[12:15], v[76:79], v[140:155]
  s_waitcnt lgkmcnt(4)
  v_mfma_f32_32x32x16_bf16 v[140:155], a[16:19], v[80:83], v[140:155]
  s_waitcnt lgkmcnt(3)
  v_mfma_f32_32x32x16_bf16 v[140:155], a[20:23], v[84:87], v[140:155]
  v_mfma_f32_32x32x16_bf16 v[156:171], a[12:15], v[88:91], 0
  v_mfma_f32_32x32x16_bf16 v[156:171], a[16:19], v[92:95], v[156:171]
  v_mfma_f32_32x32x16_bf16 v[156:171], a[20:23], v[96:99], v[156:171]
  s_waitcnt lgkmcnt(2)
  v_mfma_f32_32x32x16_bf16 v[156:171], a[24:27], v[100:103], v[156:171]
  s_waitcnt lgkmcnt(1)
  v_mfma_f32_32x32x16_bf16 v[156:171], a[28:31], v[104:107], v[156:171]
  s_waitcnt lgkmcnt(0)
  v_mfma_f32_32x32x16_bf16 v[156:171], a[32:35], v[108:111], v[156:171]
  v_mfma_f32_32x32x16_bf16 v[172:187], a[24:27], v[112:115], 0
  v_mfma_f32_32x32x16_bf16 v[172:187], a[28:31], v[116:119], v[172:187]
  v_mfma_f32_32x32x16_bf16 v[172:187], a[32:35], v[120:123], v[172:187]
  s_mov_b32 s82, 0x3f803f80
  s_mul_i32 s83, s79, 167936
  s_add_u32 s83, s83, 12648448
  s_mul_i32 s3, s81, 4096
  s_add_u32 s3, s3, s83
  s_add_u32 s3, s3, 0
  v_mov_b32 v198, 0
  v_cvt_pk_bf16_f32 v52, v124, v125
  v_cvt_pk_bf16_f32 v53, v126, v127
  v_cvt_pk_bf16_f32 v54, v128, v129
  v_cvt_pk_bf16_f32 v55, v130, v131
  buffer_store_dwordx4 v[52:55], v1, s[8:11], s3 offen offset:0 sc1
  v_cvt_pk_bf16_f32 v56, v132, v133
  v_cvt_pk_bf16_f32 v57, v134, v135
  v_cvt_pk_bf16_f32 v58, v136, v137
  v_cvt_pk_bf16_f32 v59, v138, v139
  buffer_store_dwordx4 v[56:59], v1, s[8:11], s3 offen offset:2048 sc1
  v_dot2_f32_bf16 v198, v52, s82, v198
  v_dot2_f32_bf16 v198, v53, s82, v198
  v_dot2_f32_bf16 v198, v54, s82, v198
  v_dot2_f32_bf16 v198, v55, s82, v198
  v_dot2_f32_bf16 v198, v56, s82, v198
  v_dot2_f32_bf16 v198, v57, s82, v198
  v_dot2_f32_bf16 v198, v58, s82, v198
  v_dot2_f32_bf16 v198, v59, s82, v198
  s_mul_i32 s3, s81, 4096
  s_add_u32 s3, s3, s83
  s_add_u32 s3, s3, 1024
  v_mov_b32 v199, 0
  v_cvt_pk_bf16_f32 v64, v140, v141
  v_cvt_pk_bf16_f32 v65, v142, v143
  v_cvt_pk_bf16_f32 v66, v144, v145
  v_cvt_pk_bf16_f32 v67, v146, v147
  buffer_store_dwordx4 v[64:67], v1, s[8:11], s3 offen offset:0 sc1
  v_cvt_pk_bf16_f32 v68, v148, v149
  v_cvt_pk_bf16_f32 v69, v150, v151
  v_cvt_pk_bf16_f32 v70, v152, v153
  v_cvt_pk_bf16_f32 v71, v154, v155
  buffer_store_dwordx4 v[68:71], v1, s[8:11], s3 offen offset:2048 sc1
  v_dot2_f32_bf16 v199, v64, s82, v199
  v_dot2_f32_bf16 v199, v65, s82, v199
  v_dot2_f32_bf16 v199, v66, s82, v199
  v_dot2_f32_bf16 v199, v67, s82, v199
  v_dot2_f32_bf16 v199, v68, s82, v199
  v_dot2_f32_bf16 v199, v69, s82, v199
  v_dot2_f32_bf16 v199, v70, s82, v199
  v_dot2_f32_bf16 v199, v71, s82, v199
  s_mul_i32 s3, s81, 2048
  s_add_u32 s3, s3, s83
  s_add_u32 s3, s3, 83968
  v_mov_b32 v200, 0
  v_cvt_pk_bf16_f32 v76, v156, v157
  v_cvt_pk_bf16_f32 v77, v158, v159
  v_cvt_pk_bf16_f32 v78, v160, v161
  v_cvt_pk_bf16_f32 v79, v162, v163
  buffer_store_dwordx4 v[76:79], v1, s[8:11], s3 offen offset:0 sc1
  v_cvt_pk_bf16_f32 v80, v164, v165
  v_cvt_pk_bf16_f32 v81, v166, v167
  v_cvt_pk_bf16_f32 v82, v168, v169
  v_cvt_pk_bf16_f32 v83, v170, v171
  buffer_store_dwordx4 v[80:83], v1, s[8:11], s3 offen offset:1024 sc1
  v_dot2_f32_bf16 v200, v76, s82, v200
  v_dot2_f32_bf16 v200, v77, s82, v200
  v_dot2_f32_bf16 v200, v78, s82, v200
  v_dot2_f32_bf16 v200, v79, s82, v200
  v_dot2_f32_bf16 v200, v80, s82, v200
  v_dot2_f32_bf16 v200, v81, s82, v200
  v_dot2_f32_bf16 v200, v82, s82, v200
  v_dot2_f32_bf16 v200, v83, s82, v200
  s_mul_i32 s3, s81, 2048
  s_add_u32 s3, s3, s83
  s_add_u32 s3, s3, 125952
  v_mov_b32 v201, 0
  v_cvt_pk_bf16_f32 v88, v172, v173
  v_cvt_pk_bf16_f32 v89, v174, v175
  v_cvt_pk_bf16_f32 v90, v176, v177
  v_cvt_pk_bf16_f32 v91, v178, v179
  buffer_store_dwordx4 v[88:91], v1, s[8:11], s3 offen offset:0 sc1
  v_cvt_pk_bf16_f32 v92, v180, v181
  v_cvt_pk_bf16_f32 v93, v182, v183
  v_cvt_pk_bf16_f32 v94, v184, v185
  v_cvt_pk_bf16_f32 v95, v186, v187
  buffer_store_dwordx4 v[92:95], v1, s[8:11], s3 offen offset:1024 sc1
  v_dot2_f32_bf16 v201, v88, s82, v201
  v_dot2_f32_bf16 v201, v89, s82, v201
  v_dot2_f32_bf16 v201, v90, s82, v201
  v_dot2_f32_bf16 v201, v91, s82, v201
  v_dot2_f32_bf16 v201, v92, s82, v201
  v_dot2_f32_bf16 v201, v93, s82, v201
  v_dot2_f32_bf16 v201, v94, s82, v201
  v_dot2_f32_bf16 v201, v95, s82, v201
  v_and_b32 v32, 31, v0
  v_lshlrev_b32 v32, 2, v32
  v_add_u32 v32, 98304, v32
  s_lshl_b32 s3, s12, 9
  v_add_u32 v33, s3, v32
  s_lshl_b32 s3, s12, 7
  v_add_u32 v34, s3, v32
  v_mov_b32 v35, v198
  s_nop 1
  v_permlane32_swap_b32 v198, v35
  v_add_f32 v198, v198, v35
  ds_write_b32 v33, v198 offset:8448
  v_mov_b32 v35, v199
  s_nop 1
  v_permlane32_swap_b32 v199, v35
  v_add_f32 v199, v199, v35
  ds_write_b32 v33, v199 offset:8576
  v_mov_b32 v35, v200
  s_nop 1
  v_permlane32_swap_b32 v200, v35
  v_add_f32 v200, v200, v35
  ds_write_b32 v33, v200 offset:8704
  v_mov_b32 v35, v201
  s_nop 1
  v_permlane32_swap_b32 v201, v35
  v_add_f32 v201, v201, v35
  ds_write_b32 v33, v201 offset:8832
  s_waitcnt lgkmcnt(0)
  s_barrier
  ds_read_b32 v198, v34 offset:8448
  ds_read_b32 v199, v34 offset:8960
  ds_read_b32 v200, v34 offset:9472
  ds_read_b32 v201, v34 offset:9984
  s_waitcnt lgkmcnt(2)
  v_add_f32 v198, v198, v199
  s_waitcnt lgkmcnt(0)
  v_add_f32 v200, v200, v201
  v_add_f32 v198, v198, v200
  v_cvt_pk_bf16_f32 v32, v198, v198
  v_lshlrev_b32 v32, 16, v32
  v_sub_f32 v32, v198, v32
  v_cvt_pk_bf16_f32 v40, v198, v32
  s_mul_i32 s3, s12, 41
  s_add_u32 s3, s3, 40
  s_add_u32 s84, s12, 80
  s_cmp_lt_u32 s12, 2
  s_cselect_b32 s3, s84, s3
  s_lshl_b32 s3, s3, 10
  s_add_u32 s83, s83, s3
  s_lshl_b32 s3, s80, 2
  s_add_u32 s84, s83, s3
  s_cmp_eq_u32 s80, 4
  s_cselect_b32 s84, 1073741824, s84
  s_cselect_b32 s83, s83, 1073741824
  s_mov_b32 exec_hi, 0
  buffer_store_dword v40, v1, s[8:11], s84 offen sc1
  buffer_store_dwordx4 v[40:43], v1, s[8:11], s83 offen offset:512 sc1
  s_mov_b64 exec, -1
  s_waitcnt vmcnt(15)
  v_mov_b32 v10, v240
  v_mov_b32 v11, v241
  v_mov_b32 v12, v242
  v_mov_b32 v13, v243
  s_waitcnt vmcnt(14)
  v_mov_b32 v14, v244
  v_mov_b32 v15, v245
  v_mov_b32 v16, v246
  v_mov_b32 v17, v247
  v_permlane32_swap_b32 v10, v12
  v_permlane32_swap_b32 v11, v13
  v_permlane32_swap_b32 v14, v16
  v_permlane32_swap_b32 v15, v17
  s_add_u32 s3, s58, 0
  buffer_store_dwordx4 v[240:243], v7, s[8:11], s3 offen sc1
  buffer_store_dwordx4 v[244:247], v7, s[8:11], s3 offen offset:2048 sc1
  s_addk_i32 s3, 4096
  s_waitcnt vmcnt(15)
  buffer_store_dwordx2 v[18:19], v6, s[8:11], s3 offen sc1
  s_mov_b32 s3, 0x3f803f80
  v_mov_b32 v208, 0
  v_mov_b32 v209, 0
  v_dot2_f32_bf16 v208, v10, s3, v208
  v_dot2_f32_bf16 v209, v10, v10, v209
  v_dot2_f32_bf16 v208, v11, s3, v208
  v_dot2_f32_bf16 v209, v11, v11, v209
  v_dot2_f32_bf16 v208, v12, s3, v208
  v_dot2_f32_bf16 v209, v12, v12, v209
  v_dot2_f32_bf16 v208, v13, s3, v208
  v_dot2_f32_bf16 v209, v13, v13, v209
  v_dot2_f32_bf16 v208, v14, s3, v208
  v_dot2_f32_bf16 v209, v14, v14, v209
  v_dot2_f32_bf16 v208, v15, s3, v208
  v_dot2_f32_bf16 v209, v15, v15, v209
  v_dot2_f32_bf16 v208, v16, s3, v208
  v_dot2_f32_bf16 v209, v16, v16, v209
  v_dot2_f32_bf16 v208, v17, s3, v208
  v_dot2_f32_bf16 v209, v17, v17, v209
  v_dot2_f32_bf16 v208, v18, s3, v208
  v_dot2_f32_bf16 v209, v18, v18, v209
  v_dot2_f32_bf16 v208, v19, s3, v208
  v_dot2_f32_bf16 v209, v19, v19, v209
  v_mov_b32 v210, v20
  v_mov_b32 v211, v20
  v_mov_b32 v212, v208
  v_mov_b32 v213, v209
  s_nop 0
  v_permlane16_swap_b32 v208, v212
  v_permlane16_swap_b32 v209, v213
  v_add_f32 v208, v208, v212
  v_add_f32 v209, v209, v213
  v_mov_b32 v212, v208
  v_mov_b32 v213, v209
  s_nop 0
  v_permlane32_swap_b32 v208, v212
  v_permlane32_swap_b32 v209, v213
  v_add_f32 v208, v208, v212
  v_add_f32 v209, v209, v213
  s_add_u32 s3, s59, 2621440
M_ROLED:
  s_add_u32 s3, s59, 2621440
  s_lshl_b32 s14, s2, 7
  s_add_u32 s14, s14, 12517376
  s_cmp_eq_u32 s12, 0
  s_cselect_b32 s14, s14, 1073741824
  v_lshlrev_b32 v24, 7, v0
  s_mov_b64 exec, 0xffff
  s_waitcnt vmcnt(0)
  buffer_store_dwordx4 v[208:211], v1, s[8:11], s3 offen sc1
  s_mov_b64 exec, 1
  s_barrier
  buffer_store_dword v20, v1, s[8:11], s14 offen sc1
  s_mov_b64 exec, -1
  s_mul_i32 s14, s67, 640
  s_add_u32 s70, s14, 12517376
  s_mov_b64 exec, 0x1f
  buffer_load_dword v21, v24, s[8:11], s70 offen sc1
  s_mov_b64 exec, -1
  s_waitcnt vmcnt(0)
  v_cmp_ne_u32 vcc, v20, v21
  s_nop 3
  s_and_b64 vcc, vcc, 0x1f
  s_cbranch_vccnz PW1_SPIN
PW1_OK:
  s_sub_u32 s14, s28, s25
  s_mul_i32 s82, s12, 2048
  s_add_u32 s29, s14, s82
  s_mul_i32 s84, s12, 4096
  s_add_u32 s83, s14, s84
  s_add_u32 m0, s27, 0
  s_add_u32 s34, s30, 0
  buffer_load_dwordx4 v1, s[8:11], s34 offen offset:0 sc1 lds
  buffer_load_dwordx4 v1, s[8:11], s34 offen offset:1024 sc1 lds
  buffer_load_dwordx4 v1, s[8:11], s34 offen offset:2048 sc1 lds
  buffer_load_dwordx4 v1, s[8:11], s34 offen offset:3072 sc1 lds
  s_add_u32 m0, s27, 4096
  s_add_u32 s34, s30, 4096
  buffer_load_dwordx4 v1, s[8:11], s34 offen offset:0 sc1 lds
  buffer_load_dwordx4 v1, s[8:11], s34 offen offset:1024 sc1 lds
  buffer_load_dwordx4 v1, s[8:11], s34 offen offset:2048 sc1 lds
  buffer_load_dwordx4 v1, s[8:11], s34 offen offset:3072 sc1 lds
  s_add_u32 m0, s27, 32768
  s_add_u32 s34, s30, 32768
  buffer_load_dwordx4 v1, s[8:11], s34 offen offset:0 sc1 lds
  buffer_load_dwordx4 v1, s[8:11], s34 offen offset:1024 sc1 lds
  buffer_load_dwordx4 v1, s[8:11], s34 offen offset:2048 sc1 lds
  buffer_load_dwordx4 v1, s[8:11], s34 offen offset:3072 sc1 lds
  s_add_u32 m0, s27, 36864
  s_add_u32 s34, s30, 36864
  buffer_load_dwordx4 v1, s[8:11], s34 offen offset:0 sc1 lds
  buffer_load_dwordx4 v1, s[8:11], s34 offen offset:1024 sc1 lds
  buffer_load_dwordx4 v1, s[8:11], s34 offen offset:2048 sc1 lds
  buffer_load_dwordx4 v1, s[8:11], s34 offen offset:3072 sc1 lds
  s_add_u32 m0, s27, 65536
  s_add_u32 s34, s30, 65536
  buffer_load_dwordx4 v1, s[8:11], s34 offen offset:0 sc1 lds
  buffer_load_dwordx4 v1, s[8:11], s34 offen offset:1024 sc1 lds
  buffer_load_dwordx4 v1, s[8:11], s34 offen offset:2048 sc1 lds
  buffer_load_dwordx4 v1, s[8:11], s34 offen offset:3072 sc1 lds
  s_add_u32 m0, s27, 69632
  s_add_u32 s34, s30, 69632
  buffer_load_dwordx4 v1, s[8:11], s34 offen offset:0 sc1 lds
  buffer_load_dwordx4 v1, s[8:11], s34 offen offset:1024 sc1 lds
  buffer_load_dwordx4 v1, s[8:11], s34 offen offset:2048 sc1 lds
  buffer_load_dwordx4 v1, s[8:11], s34 offen offset:3072 sc1 lds
  s_add_u32 s70, s37, 2621440
  buffer_load_dwordx4 v[24:27], v8, s[8:11], s70 offen offset:0 sc1
  buffer_load_dwordx4 v[28:31], v8, s[8:11], s70 offen offset:512 sc1
  buffer_load_dwordx4 v[32:35], v8, s[8:11], s70 offen offset:1024 sc1
  buffer_load_dwordx4 v[36:39], v8, s[8:11], s70 offen offset:1536 sc1
  s_waitcnt vmcnt(1)
  v_max3_u32 v40, v26, v30, v34
  v_min3_u32 v41, v26, v30, v34
  s_waitcnt vmcnt(0)
  v_max_u32 v40, v40, v38
  v_min_u32 v41, v41, v38
  v_cmp_ne_u32 vcc, v20, v40
  v_cmp_ne_u32 s[64:65], v20, v41
  s_nop 3
  s_or_b64 vcc, vcc, s[64:65]
  s_cbranch_vccnz PXI_SPIN
PXI_OK:
  s_add_u32 s71, s36, 0
  buffer_load_dwordx4 a[0:3], v1, s[8:11], s71 offen offset:0 sc1
  buffer_load_dwordx4 a[4:7], v1, s[8:11], s71 offen offset:1024 sc1
  buffer_load_dwordx4 a[8:11], v1, s[8:11], s71 offen offset:2048 sc1
  buffer_load_dwordx4 a[12:15], v1, s[8:11], s71 offen offset:3072 sc1
  s_add_u32 s35, s71, 4096
  buffer_load_dwordx4 a[16:19], v1, s[8:11], s35 offen offset:0 sc1
  buffer_load_dwordx4 a[20:23], v1, s[8:11], s35 offen offset:1024 sc1
  buffer_load_dwordx4 a[24:27], v1, s[8:11], s35 offen offset:2048 sc1
  buffer_load_dwordx4 a[28:31], v1, s[8:11], s35 offen offset:3072 sc1
  s_add_u32 s35, s71, 8192
  buffer_load_dwordx4 a[32:35], v1, s[8:11], s35 offen offset:0 sc1
  s_barrier
  ds_read_b128 a[160:163], v1 offset:0
  buffer_load_dwordx4 a[36:39], v1, s[8:11], s35 offen offset:1024 sc1
  buffer_load_dwordx4 a[40:43], v1, s[8:11], s35 offen offset:2048 sc1
  ds_read_b128 a[164:167], v1 offset:1024
  buffer_load_dwordx4 a[44:47], v1, s[8:11], s35 offen offset:3072 sc1
  ds_read_b128 a[168:171], v1 offset:2048
  ds_read_b128 a[172:175], v1 offset:3072
  s_add_u32 s35, s71, 12288
  buffer_load_dwordx4 a[48:51], v1, s[8:11], s35 offen offset:0 sc1
  ds_read_b128 a[176:179], v1 offset:4096
  ds_read_b128 a[180:183], v1 offset:5120
  buffer_load_dwordx4 a[52:55], v1, s[8:11], s35 offen offset:1024 sc1
  ds_read_b128 a[184:187], v1 offset:6144
  s_waitcnt vmcnt(13) lgkmcnt(4)
  v_mfma_f32_32x32x16_bf16 v[40:55], a[160:163], a[0:3], 0
  ds_read_b128 a[188:191], v1 offset:7168
  buffer_load_dwordx4 a[56:59], v1, s[8:11], s35 offen offset:2048 sc1
  v_and_b32 v109, 24, v0
  v_cmp_eq_u32 vcc, 24, v109
  v_mfma_f32_32x32x16_bf16 v[56:71], a[164:167], a[0:3], 0
  ds_read_b128 a[160:163], v1 offset:8192
  v_mov_b32 v109, 1073741824
  v_cndmask_b32 v109, v1, v109, vcc
  s_waitcnt vmcnt(13)
  v_mfma_f32_32x32x16_bf16 v[40:55], a[168:171], a[4:7], v[40:55]
  ds_read_b128 a[164:167], v1 offset:9216
  buffer_load_dwordx4 a[60:63], v1, s[8:11], s35 offen offset:3072 sc1
  s_waitcnt lgkmcnt(4)
  v_mfma_f32_32x32x16_bf16 v[56:71], a[172:175], a[4:7], v[56:71]
  ds_read_b128 a[168:171], v1 offset:10240
  s_waitcnt vmcnt(13)
  v_mfma_f32_32x32x16_bf16 v[40:55], a[176:179], a[8:11], v[40:55]
  ds_read_b128 a[172:175], v1 offset:11264
  s_add_u32 s35, s71, 16384
  buffer_load_dwordx4 a[64:67], v1, s[8:11], s35 offen offset:0 sc1
  v_mfma_f32_32x32x16_bf16 v[56:71], a[180:183], a[8:11], v[56:71]
  ds_read_b128 a[176:179], v1 offset:12288
  s_waitcnt vmcnt(13) lgkmcnt(4)
  v_mfma_f32_32x32x16_bf16 v[40:55], a[184:187], a[12:15], v[40:55]
  ds_read_b128 a[180:183], v1 offset:13312
  buffer_load_dwordx4 a[68:71], v1, s[8:11], s35 offen offset:1024 sc1
  v_mfma_f32_32x32x16_bf16 v[56:71], a[188:191], a[12:15], v[56:71]
  ds_read_b128 a[184:187], v1 offset:14336
  s_waitcnt vmcnt(13)
  v_mfma_f32_32x32x16_bf16 v[40:55], a[160:163], a[16:19], v[40:55]
  ds_read_b128 a[188:191], v1 offset:15360
  buffer_load_dwordx4 a[72:75], v1, s[8:11], s35 offen offset:2048 sc1
  s_waitcnt lgkmcnt(4)
  v_mfma_f32_32x32x16_bf16 v[56:71], a[164:167], a[16:19], v[56:71]
  ds_read_b128 a[160:163], v1 offset:16384
  s_waitcnt vmcnt(13)
  v_mfma_f32_32x32x16_bf16 v[40:55], a[168:171], a[20:23], v[40:55]
  ds_read_b128 a[164:167], v1 offset:17408
  buffer_load_dwordx4 a[76:79], v1, s[8:11], s35 offen offset:3072 sc1
  v_mfma_f32_32x32x16_bf16 v[56:71], a[172:175], a[20:23], v[56:71]
  ds_read_b128 a[168:171], v1 offset:18432
  s_waitcnt vmcnt(13) lgkmcnt(4)
  v_mfma_f32_32x32x16_bf16 v[40:55], a[176:179], a[24:27], v[40:55]
  ds_read_b128 a[172:175], v1 offset:19456
  s_add_u32 s35, s71, 20480
  buffer_load_dwordx4 a[80:83], v1, s[8:11], s35 offen offset:0 sc1
  v_add_f32 v24, v24, v28
  v_mfma_f32_32x32x16_bf16 v[56:71], a[180:183], a[24:27], v[56:71]
  ds_read_b128 a[176:179], v1 offset:20480
  v_add_f32 v25, v25, v29
  v_add_f32 v32, v32, v36
  v_add_f32 v33, v33, v37
  v_add_f32 v24, v24, v32
  v_add_f32 v25, v25, v33
  s_waitcnt vmcnt(13)
  v_mfma_f32_32x32x16_bf16 v[40:55], a[184:187], a[28:31], v[40:55]
  ds_read_b128 a[180:183], v1 offset:21504
  buffer_load_dwordx4 a[84:87], v1, s[8:11], s35 offen offset:1024 sc1
  v_mov_b32 v26, v24
  s_waitcnt lgkmcnt(4)
  v_mfma_f32_32x32x16_bf16 v[56:71], a[188:191], a[28:31], v[56:71]
  ds_read_b128 a[184:187], v1 offset:22528
  v_mov_b32 v27, v25
  v_permlane32_swap_b32 v24, v26
  s_nop 0
  v_permlane32_swap_b32 v25, v27
  v_add_f32 v24, v24, v26
  v_add_f32 v25, v25, v27
  s_waitcnt vmcnt(13)
  v_mfma_f32_32x32x16_bf16 v[40:55], a[160:163], a[32:35], v[40:55]
  ds_read_b128 a[188:191], v1 offset:23552
  buffer_load_dwordx4 a[88:91], v1, s[8:11], s35 offen offset:2048 sc1
  v_mul_f32 v24, 0xbacccccd, v24
  v_mul_f32 v25, 0x3acccccd, v25
  v_mfma_f32_32x32x16_bf16 v[56:71], a[164:167], a[32:35], v[56:71]
  ds_read_b128 a[160:163], v1 offset:24576
  v_cvt_pk_bf16_f32 v104, v24, v24
  v_fma_f32 v25, -v24, v24, v25
  v_cvt_pk_bf16_f32 v105, v24, v24
  v_max_f32 v25, 0, v25
  s_waitcnt vmcnt(13) lgkmcnt(4)
  v_mfma_f32_32x32x16_bf16 v[40:55], a[168:171], a[36:39], v[40:55]
  ds_read_b128 a[164:167], v1 offset:25600
  buffer_load_dwordx4 a[92:95], v1, s[8:11], s35 offen offset:3072 sc1
  v_cvt_pk_bf16_f32 v106, v24, v24
  v_add_f32 v108, 0x3727c5ac, v25
  v_mfma_f32_32x32x16_bf16 v[56:71], a[172:175], a[36:39], v[56:71]
  ds_read_b128 a[168:171], v1 offset:26624
  v_cvt_pk_bf16_f32 v107, v24, v24
  v_rsq_f32 v111, v108
  s_nop 0
  v_mul_f32 v110, 0x3fb8aa3b, v111
  s_waitcnt vmcnt(13)
  v_mfma_f32_32x32x16_bf16 v[40:55], a[176:179], a[40:43], v[40:55]
  ds_read_b128 a[172:175], v1 offset:27648
  s_add_u32 s35, s71, 24576
  buffer_load_dwordx4 a[96:99], v1, s[8:11], s35 offen offset:0 sc1
  s_waitcnt lgkmcnt(4)
  v_mfma_f32_32x32x16_bf16 v[56:71], a[180:183], a[40:43], v[56:71]
  ds_read_b128 a[176:179], v1 offset:28672
  v_lshrrev_b32 v112, 5, v0
  v_and_b32 v113, 31, v0
  s_lshl_b32 s3, s12, 5
  v_add_u32 v114, s3, v113
  v_mul_u32_u24 v114, 144, v114
  s_waitcnt vmcnt(13)
  v_mfma_f32_32x32x16_bf16 v[40:55], a[184:187], a[44:47], v[40:55]
  ds_read_b128 a[180:183], v1 offset:29696
  buffer_load_dwordx4 a[100:103], v1, s[8:11], s35 offen offset:1024 sc1
  v_mul_u32_u24 v115, 18432, v112
  v_add_u32 v114, 4096, v114
  v_mfma_f32_32x32x16_bf16 v[56:71], a[188:191], a[44:47], v[56:71]
  ds_read_b128 a[184:187], v1 offset:30720
  v_add_u32 v24, v114, v115
  v_bfe_u32 v114, v0, 2, 2
  v_lshlrev_b32 v114, 1, v114
  v_add_u32 v114, v114, v112
  s_waitcnt vmcnt(13) lgkmcnt(4)
  v_mfma_f32_32x32x16_bf16 v[40:55], a[160:163], a[48:51], v[40:55]
  ds_read_b128 a[188:191], v1 offset:31744
  buffer_load_dwordx4 a[104:107], v1, s[8:11], s35 offen offset:2048 sc1
  v_mul_u32_u24 v114, 288, v114
  s_lshr_b32 s14, s12, 1
  v_mfma_f32_32x32x16_bf16 v[56:71], a[164:167], a[48:51], v[56:71]
  ds_read_b128 a[160:163], v1 offset:32768
  s_mul_i32 s3, s14, 18432
  s_add_u32 s3, s3, 4096
  v_add_u32 v114, s3, v114
  v_bfe_u32 v115, v0, 4, 1
  v_and_b32 v116, 3, v0
  s_waitcnt vmcnt(13)
  v_mfma_f32_32x32x16_bf16 v[40:55], a[168:171], a[52:55], v[40:55]
  ds_read_b128 a[164:167], v1 offset:33792
  buffer_load_dwordx4 a[108:111], v1, s[8:11], s35 offen offset:3072 sc1
  v_lshl_add_u32 v115, v115, 2, v116
  s_waitcnt lgkmcnt(4)
  v_mfma_f32_32x32x16_bf16 v[56:71], a[172:175], a[52:55], v[56:71]
  ds_read_b128 a[168:171], v1 offset:34816
  v_min_u32 v116, 4, v115
  v_min_u32 v115, 5, v115
  v_lshl_add_u32 v25, v116, 3, v114
  v_lshl_add_u32 v26, v115, 3, v114
  s_and_b32 s15, s12, 1
  s_waitcnt vmcnt(13)
  v_mfma_f32_32x32x16_bf16 v[40:55], a[176:179], a[56:59], v[40:55]
  ds_read_b128 a[172:175], v1 offset:35840
  s_add_u32 s35, s71, 28672
  buffer_load_dwordx4 a[112:115], v1, s[8:11], s35 offen offset:0 sc1
  s_mul_i32 s15, s15, 40
  v_mfma_f32_32x32x16_bf16 v[56:71], a[180:183], a[56:59], v[56:71]
  ds_read_b128 a[176:179], v1 offset:36864
  v_add_u32 v25, s15, v25
  v_add_u32 v26, 80, v26
  s_mul_i32 s3, s14, 1680
  s_add_u32 s3, s3, s15
  s_waitcnt vmcnt(13) lgkmcnt(4)
  v_mfma_f32_32x32x16_bf16 v[40:55], a[184:187], a[60:63], v[40:55]
  ds_read_b128 a[180:183], v1 offset:37888
  buffer_load_dwordx4 a[116:119], v1, s[8:11], s35 offen offset:1024 sc1
  s_add_u32 s3, s3, 40960
  v_mul_u32_u24 v114, 80, v113
  v_mfma_f32_32x32x16_bf16 v[56:71], a[188:191], a[60:63], v[56:71]
  ds_read_b128 a[184:187], v1 offset:38912
  v_lshl_add_u32 v114, v112, 3, v114
  v_add_u32 v27, s3, v114
  v_add_u32 v29, s25, v1
  v_add_u32 v28, 40960, v29
  v_mov_b32 v114, 1073741824
  s_waitcnt vmcnt(13)
  v_mfma_f32_32x32x16_bf16 v[40:55], a[160:163], a[64:67], v[40:55]
  ds_read_b128 a[188:191], v1 offset:39936
  buffer_load_dwordx4 a[120:123], v1, s[8:11], s35 offen offset:2048 sc1
  v_cmp_gt_u32 vcc, 3360, v29
  s_waitcnt lgkmcnt(4)
  v_mfma_f32_32x32x16_bf16 v[56:71], a[164:167], a[64:67], v[56:71]
  ds_read_b128 a[160:163], v1 offset:40960
  v_cndmask_b32 v29, v114, v29, vcc
  v_bfe_u32 v114, v0, 2, 1
  v_cmp_eq_u32 s[64:65], v114, v112
  v_lshrrev_b32 v114, 3, v113
  v_and_b32 v115, 3, v0
  s_waitcnt vmcnt(13)
  v_mfma_f32_32x32x16_bf16 v[40:55], a[168:171], a[68:71], v[40:55]
  ds_read_b128 a[164:167], v1 offset:41984
  buffer_load_dwordx4 a[124:127], v1, s[8:11], s35 offen offset:3072 sc1
  v_lshl_add_u32 v114, v114, 2, v115
  v_mul_u32_u24 v115, 21, v112
  v_mfma_f32_32x32x16_bf16 v[56:71], a[172:175], a[68:71], v[56:71]
  ds_read_b128 a[168:171], v1 offset:43008
  v_add_u32 v115, v115, v114
  v_mul_u32_u24 v115, 80, v115
  v_add_u32 v115, 40960, v115
  v_mov_b32 v116, 44320
  s_waitcnt vmcnt(13) lgkmcnt(4)
  v_mfma_f32_32x32x16_bf16 v[40:55], a[176:179], a[72:75], v[40:55]
  ds_read_b128 a[172:175], v1 offset:44032
  s_add_u32 s35, s71, 32768
  buffer_load_dwordx4 a[128:131], v1, s[8:11], s35 offen offset:0 sc1
  v_cndmask_b32 v32, v116, v115, s[64:65]
  v_mfma_f32_32x32x16_bf16 v[56:71], a[180:183], a[72:75], v[56:71]
  ds_read_b128 a[176:179], v1 offset:45056
  v_add_u32 v115, 1280, v32
  v_cmp_gt_u32 vcc, 5, v114
  s_nop 3
  s_and_b64 vcc, vcc, s[64:65]
  v_cndmask_b32 v33, v116, v115, vcc
  v_and_b32 v115, 1, v114
  s_waitcnt vmcnt(13)
  v_mfma_f32_32x32x16_bf16 v[40:55], a[184:187], a[76:79], v[40:55]
  ds_read_b128 a[180:183], v1 offset:46080
  buffer_load_dwordx4 a[132:135], v1, s[8:11], s35 offen offset:1024 sc1
  v_lshlrev_b32 v115, 4, v115
  s_waitcnt lgkmcnt(4)
  v_mfma_f32_32x32x16_bf16 v[56:71], a[188:191], a[76:79], v[56:71]
  ds_read_b128 a[184:187], v1 offset:47104
  v_mov_b32 v116, 0x3f80
  v_lshlrev_b32 v115, v115, v116
  v_cndmask_b32 v115, 0, v115, s[64:65]
  v_lshrrev_b32 v114, 1, v114
  v_cmp_eq_u32 vcc, 0, v114
  s_waitcnt vmcnt(13)
  v_mfma_f32_32x32x16_bf16 v[40:55], a[160:163], a[80:83], v[40:55]
  ds_read_b128 a[188:191], v1 offset:48128
  buffer_load_dwordx4 a[136:139], v1, s[8:11], s35 offen offset:2048 sc1
  v_cndmask_b32 v36, 0, v115, vcc
  v_cmp_eq_u32 vcc, 1, v114
  v_mfma_f32_32x32x16_bf16 v[56:71], a[164:167], a[80:83], v[56:71]
  ds_read_b128 a[160:163], v1 offset:49152
  v_cndmask_b32 v37, 0, v115, vcc
  v_cmp_eq_u32 vcc, 2, v114
  s_nop 1
  v_cndmask_b32 v38, 0, v115, vcc
  v_cmp_eq_u32 vcc, 3, v114
  s_waitcnt vmcnt(13) lgkmcnt(4)
  v_mfma_f32_32x32x16_bf16 v[40:55], a[168:171], a[84:87], v[40:55]
  ds_read_b128 a[164:167], v1 offset:50176
  buffer_load_dwordx4 a[140:143], v1, s[8:11], s35 offen offset:3072 sc1
  v_cndmask_b32 v39, 0, v115, vcc
  v_bfe_u32 v114, v0, 4, 1
  v_mfma_f32_32x32x16_bf16 v[56:71], a[172:175], a[84:87], v[56:71]
  ds_read_b128 a[168:171], v1 offset:51200
  v_mul_u32_u24 v114, 57344, v114
  v_and_b32 v115, 15, v0
  v_lshl_add_u32 v114, v115, 4, v114
  v_lshl_add_u32 v30, v112, 9, v114
  v_lshl_add_u32 v31, v112, 3, v114
  s_waitcnt vmcnt(13)
  v_mfma_f32_32x32x16_bf16 v[40:55], a[176:179], a[88:91], v[40:55]
  ds_read_b128 a[172:175], v1 offset:52224
  s_add_u32 s35, s71, 36864
  buffer_load_dwordx4 a[144:147], v1, s[8:11], s35 offen offset:0 sc1
  s_waitcnt lgkmcnt(4)
  v_mfma_f32_32x32x16_bf16 v[56:71], a[180:183], a[88:91], v[56:71]
  ds_read_b128 a[176:179], v1 offset:53248
  s_waitcnt vmcnt(13)
  v_mfma_f32_32x32x16_bf16 v[40:55], a[184:187], a[92:95], v[40:55]
  ds_read_b128 a[180:183], v1 offset:54272
  buffer_load_dwordx4 a[148:151], v1, s[8:11], s35 offen offset:1024 sc1
  v_mfma_f32_32x32x16_bf16 v[56:71], a[188:191], a[92:95], v[56:71]
  ds_read_b128 a[184:187], v1 offset:55296
  s_add_u32 m0, s27, 98304
  s_add_u32 s34, s30, 98304
  buffer_load_dwordx4 v1, s[8:11], s34 offen offset:0 sc1 lds
  s_waitcnt vmcnt(14) lgkmcnt(4)
  v_mfma_f32_32x32x16_bf16 v[40:55], a[160:163], a[96:99], v[40:55]
  ds_read_b128 a[188:191], v1 offset:56320
  buffer_load_dwordx4 a[152:155], v1, s[8:11], s35 offen offset:2048 sc1
  v_mfma_f32_32x32x16_bf16 v[56:71], a[164:167], a[96:99], v[56:71]
  ds_read_b128 a[160:163], v1 offset:57344
  buffer_load_dwordx4 v1, s[8:11], s34 offen offset:1024 sc1 lds
  s_waitcnt vmcnt(15)
  v_mfma_f32_32x32x16_bf16 v[40:55], a[168:171], a[100:103], v[40:55]
  ds_read_b128 a[164:167], v1 offset:58368
  buffer_load_dwordx4 a[156:159], v1, s[8:11], s35 offen offset:3072 sc1
  s_waitcnt lgkmcnt(4)
  v_mfma_f32_32x32x16_bf16 v[56:71], a[172:175], a[100:103], v[56:71]
  ds_read_b128 a[168:171], v1 offset:59392
  buffer_load_dwordx4 v1, s[8:11], s34 offen offset:2048 sc1 lds
  s_waitcnt vmcnt(16)
  v_mfma_f32_32x32x16_bf16 v[40:55], a[176:179], a[104:107], v[40:55]
  ds_read_b128 a[172:175], v1 offset:60416
  v_mfma_f32_32x32x16_bf16 v[56:71], a[180:183], a[104:107], v[56:71]
  ds_read_b128 a[176:179], v1 offset:61440
  buffer_load_dwordx4 v1, s[8:11], s34 offen offset:3072 sc1 lds
  s_waitcnt vmcnt(16) lgkmcnt(4)
  v_mfma_f32_32x32x16_bf16 v[40:55], a[184:187], a[108:111], v[40:55]
  ds_read_b128 a[180:183], v1 offset:62464
  v_mfma_f32_32x32x16_bf16 v[56:71], a[188:191], a[108:111], v[56:71]
  ds_read_b128 a[184:187], v1 offset:63488
  s_add_u32 m0, s27, 102400
  s_add_u32 s34, s30, 102400
  buffer_load_dwordx4 v1, s[8:11], s34 offen offset:0 sc1 lds
  s_waitcnt vmcnt(16)
  v_mfma_f32_32x32x16_bf16 v[40:55], a[160:163], a[112:115], v[40:55]
  ds_read_b128 a[188:191], v1 offset:64512
  s_waitcnt lgkmcnt(4)
  v_mfma_f32_32x32x16_bf16 v[56:71], a[164:167], a[112:115], v[56:71]
  ds_read_b128 a[160:163], v2 offset:0
  buffer_load_dwordx4 v1, s[8:11], s34 offen offset:1024 sc1 lds
  s_waitcnt vmcnt(16)
  v_mfma_f32_32x32x16_bf16 v[40:55], a[168:171], a[116:119], v[40:55]
  ds_read_b128 a[164:167], v2 offset:1024
  v_mfma_f32_32x32x16_bf16 v[56:71], a[172:175], a[116:119], v[56:71]
  ds_read_b128 a[168:171], v2 offset:2048
  buffer_load_dwordx4 v1, s[8:11], s34 offen offset:2048 sc1 lds
  s_waitcnt vmcnt(16) lgkmcnt(4)
  v_mfma_f32_32x32x16_bf16 v[40:55], a[176:179], a[120:123], v[40:55]
  ds_read_b128 a[172:175], v2 offset:3072
  v_mfma_f32_32x32x16_bf16 v[56:71], a[180:183], a[120:123], v[56:71]
  ds_read_b128 a[176:179], v2 offset:4096
  buffer_load_dwordx4 v1, s[8:11], s34 offen offset:3072 sc1 lds
  s_waitcnt vmcnt(16)
  v_mfma_f32_32x32x16_bf16 v[40:55], a[184:187], a[124:127], v[40:55]
  ds_read_b128 a[180:183], v2 offset:5120
  s_waitcnt lgkmcnt(4)
  v_mfma_f32_32x32x16_bf16 v[56:71], a[188:191], a[124:127], v[56:71]
  ds_read_b128 a[184:187], v2 offset:6144
  s_waitcnt vmcnt(15)
  v_mfma_f32_32x32x16_bf16 v[40:55], a[160:163], a[128:131], v[40:55]
  ds_read_b128 a[188:191], v2 offset:7168
  v_mfma_f32_32x32x16_bf16 v[56:71], a[164:167], a[128:131], v[56:71]
  ds_read_b128 a[160:163], v2 offset:8192
  s_waitcnt vmcnt(14) lgkmcnt(4)
  v_mfma_f32_32x32x16_bf16 v[40:55], a[168:171], a[132:135], v[40:55]
  ds_read_b128 a[164:167], v2 offset:9216
  v_mfma_f32_32x32x16_bf16 v[56:71], a[172:175], a[132:135], v[56:71]
  ds_read_b128 a[168:171], v2 offset:10240
  s_waitcnt vmcnt(13)
  v_mfma_f32_32x32x16_bf16 v[40:55], a[176:179], a[136:139], v[40:55]
  ds_read_b128 a[172:175], v2 offset:11264
  s_waitcnt lgkmcnt(4)
  v_mfma_f32_32x32x16_bf16 v[56:71], a[180:183], a[136:139], v[56:71]
  ds_read_b128 a[176:179], v2 offset:12288
  s_waitcnt vmcnt(12)
  v_mfma_f32_32x32x16_bf16 v[40:55], a[184:187], a[140:143], v[40:55]
  ds_read_b128 a[180:183], v2 offset:13312
  v_mfma_f32_32x32x16_bf16 v[56:71], a[188:191], a[140:143], v[56:71]
  ds_read_b128 a[184:187], v2 offset:14336
  s_waitcnt vmcnt(11) lgkmcnt(4)
  v_mfma_f32_32x32x16_bf16 v[40:55], a[160:163], a[144:147], v[40:55]
  ds_read_b128 a[188:191], v2 offset:15360
  v_mfma_f32_32x32x16_bf16 v[56:71], a[164:167], a[144:147], v[56:71]
  ds_read_b128 a[160:163], v2 offset:16384
  s_waitcnt vmcnt(10)
  v_mfma_f32_32x32x16_bf16 v[40:55], a[168:171], a[148:151], v[40:55]
  ds_read_b128 a[164:167], v2 offset:17408
  v_lshlrev_b32 v34, 7, v0
  s_lshl_b32 s70, s12, 13
  s_add_u32 s70, s70, 12517376
  buffer_load_dword v35, v34, s[8:11], s70 offen sc1
  s_waitcnt lgkmcnt(4)
  v_mfma_f32_32x32x16_bf16 v[56:71], a[172:175], a[148:151], v[56:71]
  ds_read_b128 a[168:171], v2 offset:18432
  s_waitcnt vmcnt(9)
  v_mfma_f32_32x32x16_bf16 v[40:55], a[176:179], a[152:155], v[40:55]
  ds_read_b128 a[172:175], v2 offset:19456
  v_mfma_f32_32x32x16_bf16 v[56:71], a[180:183], a[152:155], v[56:71]
  ds_read_b128 a[176:179], v2 offset:20480
  s_waitcnt vmcnt(7) lgkmcnt(4)
  v_mfma_f32_32x32x16_bf16 v[40:55], a[184:187], a[156:159], v[40:55]
  ds_read_b128 a[180:183], v2 offset:21504
  v_mfma_f32_32x32x16_bf16 v[56:71], a[188:191], a[156:159], v[56:71]
  ds_read_b128 a[184:187], v2 offset:22528
  s_add_u32 m0, s27, 131072
  s_add_u32 s34, s30, 131072
  buffer_load_dwordx4 v109, s[8:11], s34 offen offset:0 sc1 lds
  v_mfma_f32_32x32x16_bf16 v[40:55], a[160:163], v[104:107], v[40:55]
  ds_read_b128 a[188:191], v2 offset:23552
  s_waitcnt lgkmcnt(4)
  v_mfma_f32_32x32x16_bf16 v[56:71], a[164:167], v[104:107], v[56:71]
  ds_read_b128 a[160:163], v2 offset:24576
  buffer_load_dwordx4 v109, s[8:11], s34 offen offset:1024 sc1 lds
  v_mfma_f32_32x32x16_bf16 v[72:87], a[168:171], a[0:3], 0
  ds_read_b128 a[164:167], v2 offset:25600
  v_mfma_f32_32x32x16_bf16 v[72:87], a[172:175], a[4:7], v[72:87]
  ds_read_b128 a[168:171], v2 offset:26624
  buffer_load_dwordx4 v109, s[8:11], s34 offen offset:2048 sc1 lds
  s_waitcnt lgkmcnt(4)
  v_mfma_f32_32x32x16_bf16 v[72:87], a[176:179], a[8:11], v[72:87]
  ds_read_b128 a[172:175], v2 offset:27648
  v_max3_f32 v112, v40, v41, v42
  v_min3_f32 v113, v40, v41, v42
  v_max3_f32 v112, v112, v43, v44
  v_min3_f32 v113, v113, v43, v44
  v_max3_f32 v112, v112, v45, v46
  v_mfma_f32_32x32x16_bf16 v[72:87], a[180:183], a[12:15], v[72:87]
  ds_read_b128 a[176:179], v2 offset:28672
  buffer_load_dwordx4 v109, s[8:11], s34 offen offset:3072 sc1 lds
  v_min3_f32 v113, v113, v45, v46
  v_max3_f32 v112, v112, v47, v48
  v_mfma_f32_32x32x16_bf16 v[72:87], a[184:187], a[16:19], v[72:87]
  ds_read_b128 a[180:183], v2 offset:29696
  v_min3_f32 v113, v113, v47, v48
  v_max3_f32 v112, v112, v49, v50
  v_min3_f32 v113, v113, v49, v50
  v_max3_f32 v112, v112, v51, v52
  s_waitcnt lgkmcnt(4)
  v_mfma_f32_32x32x16_bf16 v[72:87], a[188:191], a[20:23], v[72:87]
  ds_read_b128 a[184:187], v2 offset:30720
  s_add_u32 m0, s27, 135168
  s_add_u32 s34, s30, 135168
  buffer_load_dwordx4 v109, s[8:11], s34 offen offset:0 sc1 lds
  s_waitcnt vmcnt(5)
  v_cmp_ne_u32 vcc, s19, v35
  s_nop 3
  s_cbranch_vccnz RL_SPIN
RL_OK:
  v_mfma_f32_32x32x16_bf16 v[72:87], a[160:163], a[24:27], v[72:87]
  ds_read_b128 a[188:191], v2 offset:31744
  v_min3_f32 v113, v113, v51, v52
  v_max3_f32 v112, v112, v53, v54
  v_min3_f32 v113, v113, v53, v54
  s_barrier
  v_mfma_f32_32x32x16_bf16 v[72:87], a[164:167], a[28:31], v[72:87]
  ds_read_b128 a[160:163], v2 offset:32768
  buffer_load_dwordx4 v109, s[8:11], s34 offen offset:1024 sc1 lds
  s_or_b32 s91, s13, s12
  s_cbranch_scc0 EP_SET
EP_BACK:
  s_mov_b64 exec, 0xffff
  buffer_load_dword v21, v4, s[8:11], s17 offen sc1
  s_mov_b64 exec, -1
  v_max3_f32 v112, v112, v55, v56
  s_waitcnt lgkmcnt(4)
  v_mfma_f32_32x32x16_bf16 v[72:87], a[168:171], a[32:35], v[72:87]
  ds_read_b128 a[164:167], v2 offset:33792
  buffer_load_dwordx4 v[192:195], v1, s[8:11], s56 offen offset:0 sc1
  v_mov_b32 v156, -1
  v_mov_b32 v157, -1
  v_mov_b32 v158, -1
  v_mov_b32 v159, -1
  s_add_u32 s91, s38, s25
  s_add_u32 s91, s91, 1114112
  buffer_store_dwordx4 v[156:159], v1, s[8:11], s91 offen sc1
  v_min3_f32 v113, v113, v55, v56
  v_max3_f32 v112, v112, v57, v58
  v_mfma_f32_32x32x16_bf16 v[72:87], a[172:175], a[36:39], v[72:87]
  ds_read_b128 a[168:171], v2 offset:34816
  buffer_load_dwordx4 v109, s[8:11], s34 offen offset:2048 sc1 lds
  v_min3_f32 v113, v113, v57, v58
  v_max_f32 v112, v112, v59
  v_mfma_f32_32x32x16_bf16 v[72:87], a[176:179], a[40:43], v[72:87]
  ds_read_b128 a[172:175], v2 offset:35840
  buffer_load_dwordx4 v[196:199], v1, s[8:11], s56 offen offset:1024 sc1
  v_min_f32 v113, v113, v59
  s_waitcnt lgkmcnt(4)
  v_mfma_f32_32x32x16_bf16 v[72:87], a[180:183], a[44:47], v[72:87]
  ds_read_b128 a[176:179], v2 offset:36864
  buffer_load_dwordx4 v109, s[8:11], s34 offen offset:3072 sc1 lds
  v_mul_f32 v112, v112, v110
  v_mul_f32 v113, v113, v110
  v_mfma_f32_32x32x16_bf16 v[72:87], a[184:187], a[48:51], v[72:87]
  ds_read_b128 a[180:183], v2 offset:37888
  buffer_load_dwordx4 v[200:203], v1, s[8:11], s56 offen offset:2048 sc1
  v_fma_f32 v118, v40, v110, -v112
  v_fma_f32 v119, v41, v110, -v112
  v_mfma_f32_32x32x16_bf16 v[72:87], a[188:191], a[52:55], v[72:87]
  ds_read_b128 a[184:187], v2 offset:38912
  v_fma_f32 v40, -v40, v110, v113
  v_fma_f32 v41, -v41, v110, v113
  v_exp_f32 v118, v118
  s_waitcnt lgkmcnt(4)
  v_mfma_f32_32x32x16_bf16 v[72:87], a[160:163], a[56:59], v[72:87]
  ds_read_b128 a[188:191], v2 offset:39936
  buffer_load_dwordx4 v[204:207], v1, s[8:11], s56 offen offset:3072 sc1
  v_exp_f32 v119, v119
  v_mfma_f32_32x32x16_bf16 v[72:87], a[164:167], a[60:63], v[72:87]
  ds_read_b128 a[160:163], v2 offset:40960
  v_exp_f32 v40, v40
  v_exp_f32 v41, v41
  v_fma_f32 v120, v42, v110, -v112
  v_mfma_f32_32x32x16_bf16 v[72:87], a[168:171], a[64:67], v[72:87]
  ds_read_b128 a[164:167], v2 offset:41984
  s_add_u32 s77, s56, 4096
  buffer_load_dwordx4 v[208:211], v1, s[8:11], s77 offen offset:0 sc1
  s_waitcnt lgkmcnt(4)
  v_mfma_f32_32x32x16_bf16 v[72:87], a[172:175], a[68:71], v[72:87]
  ds_read_b128 a[168:171], v2 offset:43008
  v_fma_f32 v121, v43, v110, -v112
  v_fma_f32 v42, -v42, v110, v113
  v_fma_f32 v43, -v43, v110, v113
  v_exp_f32 v120, v120
  v_mfma_f32_32x32x16_bf16 v[72:87], a[176:179], a[72:75], v[72:87]
  ds_read_b128 a[172:175], v2 offset:44032
  buffer_load_dwordx4 v[212:215], v1, s[8:11], s77 offen offset:1024 sc1
  v_exp_f32 v121, v121
  v_mfma_f32_32x32x16_bf16 v[72:87], a[180:183], a[76:79], v[72:87]
  ds_read_b128 a[176:179], v2 offset:45056
  v_exp_f32 v42, v42
  v_exp_f32 v43, v43
  s_waitcnt lgkmcnt(4)
  v_mfma_f32_32x32x16_bf16 v[72:87], a[184:187], a[80:83], v[72:87]
  ds_read_b128 a[180:183], v2 offset:46080
  buffer_load_dwordx4 v[216:219], v1, s[8:11], s77 offen offset:2048 sc1
  v_add_f32 v114, v118, v119
  v_add_f32 v115, v40, v41
  v_mfma_f32_32x32x16_bf16 v[72:87], a[188:191], a[84:87], v[72:87]
  ds_read_b128 a[184:187], v2 offset:47104
  v_fma_f32 v122, v44, v110, -v112
  v_fma_f32 v123, v45, v110, -v112
  v_fma_f32 v44, -v44, v110, v113
  v_fma_f32 v45, -v45, v110, v113
  v_mfma_f32_32x32x16_bf16 v[72:87], a[160:163], a[88:91], v[72:87]
  ds_read_b128 a[188:191], v2 offset:48128
  buffer_load_dwordx4 v[220:223], v1, s[8:11], s77 offen offset:3072 sc1
  s_waitcnt lgkmcnt(4)
  v_mfma_f32_32x32x16_bf16 v[72:87], a[164:167], a[92:95], v[72:87]
  ds_read_b128 a[160:163], v2 offset:49152
  v_exp_f32 v122, v122
  v_exp_f32 v123, v123
  v_mfma_f32_32x32x16_bf16 v[72:87], a[168:171], a[96:99], v[72:87]
  ds_read_b128 a[164:167], v2 offset:50176
  s_add_u32 s77, s56, 8192
  buffer_load_dwordx4 v[224:227], v1, s[8:11], s77 offen offset:0 sc1
  v_mfma_f32_32x32x16_bf16 v[72:87], a[172:175], a[100:103], v[72:87]
  ds_read_b128 a[168:171], v2 offset:51200
  v_exp_f32 v44, v44
  v_exp_f32 v45, v45
  s_waitcnt lgkmcnt(4)
  v_mfma_f32_32x32x16_bf16 v[72:87], a[176:179], a[104:107], v[72:87]
  ds_read_b128 a[172:175], v2 offset:52224
  buffer_load_dwordx4 v[228:231], v1, s[8:11], s77 offen offset:1024 sc1
  v_add_f32 v114, v114, v120
  v_add_f32 v115, v115, v42
  v_mfma_f32_32x32x16_bf16 v[72:87], a[180:183], a[108:111], v[72:87]
  ds_read_b128 a[176:179], v2 offset:53248
  s_waitcnt vmcnt(13)
  v_cmp_ne_u32 vcc, s19, v21
  s_cmp_eq_u32 s12, 3
  s_cselect_b32 s91, 1073741824, 0
  v_add_u32 v4, s91, v1
  s_nop 0
  s_and_b32 s16, vcc_lo, 0xffff
  v_add_f32 v114, v114, v121
  v_add_f32 v115, v115, v43
  v_fma_f32 v124, v46, v110, -v112
  v_fma_f32 v125, v47, v110, -v112
  v_fma_f32 v46, -v46, v110, v113
  v_mfma_f32_32x32x16_bf16 v[72:87], a[184:187], a[112:115], v[72:87]
  ds_read_b128 a[180:183], v2 offset:54272
  buffer_load_dwordx4 v[232:235], v1, s[8:11], s77 offen offset:2048 sc1
  v_fma_f32 v47, -v47, v110, v113
  s_waitcnt lgkmcnt(4)
  v_mfma_f32_32x32x16_bf16 v[72:87], a[188:191], a[116:119], v[72:87]
  ds_read_b128 a[184:187], v2 offset:55296
  v_exp_f32 v124, v124
  v_exp_f32 v125, v125
  v_mfma_f32_32x32x16_bf16 v[72:87], a[160:163], a[120:123], v[72:87]
  ds_read_b128 a[188:191], v2 offset:56320
  buffer_load_dwordx4 v[236:239], v1, s[8:11], s77 offen offset:3072 sc1
  v_exp_f32 v46, v46
  v_mfma_f32_32x32x16_bf16 v[72:87], a[164:167], a[124:127], v[72:87]
  ds_read_b128 a[160:163], v2 offset:57344
  v_exp_f32 v47, v47
  v_add_f32 v114, v114, v122
  v_add_f32 v115, v115, v44
  s_waitcnt lgkmcnt(4)
  v_mfma_f32_32x32x16_bf16 v[72:87], a[168:171], a[128:131], v[72:87]
  ds_read_b128 a[164:167], v2 offset:58368
  s_add_u32 s77, s56, 12288
  buffer_load_dwordx4 v[240:243], v1, s[8:11], s77 offen offset:0 sc1
  v_add_f32 v114, v114, v123
  v_mfma_f32_32x32x16_bf16 v[72:87], a[172:175], a[132:135], v[72:87]
  ds_read_b128 a[168:171], v2 offset:59392
  v_add_f32 v115, v115, v45
  v_fma_f32 v126, v48, v110, -v112
  v_fma_f32 v127, v49, v110, -v112
  v_fma_f32 v48, -v48, v110, v113
  v_fma_f32 v49, -v49, v110, v113
  v_mfma_f32_32x32x16_bf16 v[72:87], a[176:179], a[136:139], v[72:87]
  ds_read_b128 a[172:175], v2 offset:60416
  buffer_load_dwordx4 v[244:247], v1, s[8:11], s77 offen offset:1024 sc1
  s_waitcnt lgkmcnt(4)
  v_mfma_f32_32x32x16_bf16 v[72:87], a[180:183], a[140:143], v[72:87]
  ds_read_b128 a[176:179], v2 offset:61440
  v_exp_f32 v126, v126
  v_exp_f32 v127, v127
  v_mfma_f32_32x32x16_bf16 v[72:87], a[184:187], a[144:147], v[72:87]
  ds_read_b128 a[180:183], v2 offset:62464
  buffer_load_dwordx4 v[248:251], v1, s[8:11], s77 offen offset:2048 sc1
  v_exp_f32 v48, v48
  v_mfma_f32_32x32x16_bf16 v[72:87], a[188:191], a[148:151], v[72:87]
  ds_read_b128 a[184:187], v2 offset:63488
  v_exp_f32 v49, v49
  v_add_f32 v114, v114, v124
  v_add_f32 v115, v115, v46
  s_waitcnt lgkmcnt(4)
  v_mfma_f32_32x32x16_bf16 v[72:87], a[160:163], a[152:155], v[72:87]
  ds_read_b128 a[188:191], v2 offset:64512
  buffer_load_dwordx4 v[252:255], v1, s[8:11], s77 offen offset:3072 sc1
  s_waitcnt vmcnt(14)
  s_barrier
  v_mfma_f32_32x32x16_bf16 v[72:87], a[164:167], a[156:159], v[72:87]
  ds_read_b128 a[160:163], v3 offset:0
  v_add_f32 v114, v114, v125
  v_add_f32 v115, v115, v47
  v_fma_f32 v128, v50, v110, -v112
  v_fma_f32 v129, v51, v110, -v112
  v_fma_f32 v50, -v50, v110, v113
  v_mfma_f32_32x32x16_bf16 v[72:87], a[168:171], v[104:107], v[72:87]
  ds_read_b128 a[164:167], v3 offset:1024
  s_add_u32 s77, s56, 16384
  buffer_load_dwordx4 a[192:195], v1, s[8:11], s77 offen offset:0 sc1
  s_waitcnt lgkmcnt(4)
  v_mfma_f32_32x32x16_bf16 v[88:103], a[172:175], a[0:3], 0
  ds_read_b128 a[168:171], v3 offset:2048
  v_fma_f32 v51, -v51, v110, v113
  v_exp_f32 v128, v128
  v_exp_f32 v129, v129
  v_mfma_f32_32x32x16_bf16 v[88:103], a[176:179], a[4:7], v[88:103]
  ds_read_b128 a[172:175], v3 offset:3072
  buffer_load_dwordx4 a[196:199], v1, s[8:11], s77 offen offset:1024 sc1
  v_exp_f32 v50, v50
  v_mfma_f32_32x32x16_bf16 v[88:103], a[180:183], a[8:11], v[88:103]
  ds_read_b128 a[176:179], v3 offset:4096
  s_add_u32 m0, s25, 0
  s_add_u32 s34, s28, 163840
  buffer_load_dwordx4 v109, s[8:11], s34 offen offset:0 sc1 lds
  s_waitcnt lgkmcnt(4)
  v_mfma_f32_32x32x16_bf16 v[88:103], a[184:187], a[12:15], v[88:103]
  ds_read_b128 a[180:183], v3 offset:5120
  buffer_load_dwordx4 a[200:203], v1, s[8:11], s77 offen offset:2048 sc1
  v_exp_f32 v51, v51
  v_mfma_f32_32x32x16_bf16 v[88:103], a[188:191], a[16:19], v[88:103]
  ds_read_b128 a[184:187], v3 offset:6144
  v_add_f32 v114, v114, v126
  v_add_f32 v115, v115, v48
  v_add_f32 v114, v114, v127
  v_add_f32 v115, v115, v49
  v_fma_f32 v130, v52, v110, -v112
  v_mfma_f32_32x32x16_bf16 v[88:103], a[160:163], a[20:23], v[88:103]
  ds_read_b128 a[188:191], v3 offset:7168
  buffer_load_dwordx4 a[204:207], v1, s[8:11], s77 offen offset:3072 sc1
  v_fma_f32 v131, v53, v110, -v112
  s_waitcnt lgkmcnt(4)
  v_mfma_f32_32x32x16_bf16 v[88:103], a[164:167], a[24:27], v[88:103]
  ds_read_b128 a[160:163], v3 offset:8192
  v_fma_f32 v52, -v52, v110, v113
  v_fma_f32 v53, -v53, v110, v113
  v_exp_f32 v130, v130
  v_mfma_f32_32x32x16_bf16 v[88:103], a[168:171], a[28:31], v[88:103]
  ds_read_b128 a[164:167], v3 offset:9216
  s_add_u32 s77, s56, 20480
  buffer_load_dwordx4 a[208:211], v1, s[8:11], s77 offen offset:0 sc1
  v_mfma_f32_32x32x16_bf16 v[88:103], a[172:175], a[32:35], v[88:103]
  ds_read_b128 a[168:171], v3 offset:10240
  v_exp_f32 v131, v131
  v_exp_f32 v52, v52
  s_waitcnt lgkmcnt(4)
  v_mfma_f32_32x32x16_bf16 v[88:103], a[176:179], a[36:39], v[88:103]
  ds_read_b128 a[172:175], v3 offset:11264
  buffer_load_dwordx4 a[212:215], v1, s[8:11], s77 offen offset:1024 sc1
  v_exp_f32 v53, v53
  v_mfma_f32_32x32x16_bf16 v[88:103], a[180:183], a[40:43], v[88:103]
  ds_read_b128 a[176:179], v3 offset:12288
  v_add_f32 v114, v114, v128
  v_add_f32 v115, v115, v50
  v_add_f32 v114, v114, v129
  v_add_f32 v115, v115, v51
  v_fma_f32 v132, v54, v110, -v112
  v_mfma_f32_32x32x16_bf16 v[88:103], a[184:187], a[44:47], v[88:103]
  ds_read_b128 a[180:183], v3 offset:13312
  buffer_load_dwordx4 a[216:219], v1, s[8:11], s77 offen offset:2048 sc1
  v_fma_f32 v133, v55, v110, -v112
  s_waitcnt lgkmcnt(4)
  v_mfma_f32_32x32x16_bf16 v[88:103], a[188:191], a[48:51], v[88:103]
  ds_read_b128 a[184:187], v3 offset:14336
  v_fma_f32 v54, -v54, v110, v113
  v_fma_f32 v55, -v55, v110, v113
  v_exp_f32 v132, v132
  v_mfma_f32_32x32x16_bf16 v[88:103], a[160:163], a[52:55], v[88:103]
  ds_read_b128 a[188:191], v3 offset:15360
  buffer_load_dwordx4 a[220:223], v1, s[8:11], s77 offen offset:3072 sc1
  v_exp_f32 v133, v133
  v_mfma_f32_32x32x16_bf16 v[88:103], a[164:167], a[56:59], v[88:103]
  ds_read_b128 a[160:163], v3 offset:16384
  v_exp_f32 v54, v54
  v_exp_f32 v55, v55
  s_waitcnt lgkmcnt(4)
  v_mfma_f32_32x32x16_bf16 v[88:103], a[168:171], a[60:63], v[88:103]
  ds_read_b128 a[164:167], v3 offset:17408
  s_add_u32 s77, s56, 24576
  buffer_load_dwordx4 a[224:227], v1, s[8:11], s77 offen offset:0 sc1
  v_add_f32 v114, v114, v130
  v_mfma_f32_32x32x16_bf16 v[88:103], a[172:175], a[64:67], v[88:103]
  ds_read_b128 a[168:171], v3 offset:18432
  v_add_f32 v115, v115, v52
  v_add_f32 v114, v114, v131
  v_add_f32 v115, v115, v53
  v_fma_f32 v134, v56, v110, -v112
  v_fma_f32 v135, v57, v110, -v112
  v_mfma_f32_32x32x16_bf16 v[88:103], a[176:179], a[68:71], v[88:103]
  ds_read_b128 a[172:175], v3 offset:19456
  buffer_load_dwordx4 a[228:231], v1, s[8:11], s77 offen offset:1024 sc1
  v_fma_f32 v56, -v56, v110, v113
  s_waitcnt lgkmcnt(4)
  v_mfma_f32_32x32x16_bf16 v[88:103], a[180:183], a[72:75], v[88:103]
  ds_read_b128 a[176:179], v3 offset:20480
  v_fma_f32 v57, -v57, v110, v113
  v_exp_f32 v134, v134
  v_exp_f32 v135, v135
  v_mfma_f32_32x32x16_bf16 v[88:103], a[184:187], a[76:79], v[88:103]
  ds_read_b128 a[180:183], v3 offset:21504
  buffer_load_dwordx4 a[232:235], v1, s[8:11], s77 offen offset:2048 sc1
  v_exp_f32 v56, v56
  v_mfma_f32_32x32x16_bf16 v[88:103], a[188:191], a[80:83], v[88:103]
  ds_read_b128 a[184:187], v3 offset:22528
  v_exp_f32 v57, v57
  v_add_f32 v114, v114, v132
  v_add_f32 v115, v115, v54
  s_waitcnt lgkmcnt(4)
  v_mfma_f32_32x32x16_bf16 v[88:103], a[160:163], a[84:87], v[88:103]
  ds_read_b128 a[188:191], v3 offset:23552
  buffer_load_dwordx4 a[236:239], v1, s[8:11], s77 offen offset:3072 sc1
  v_add_f32 v114, v114, v133
  v_add_f32 v115, v115, v55
  v_mfma_f32_32x32x16_bf16 v[88:103], a[164:167], a[88:91], v[88:103]
  ds_read_b128 a[160:163], v3 offset:24576
  v_fma_f32 v136, v58, v110, -v112
  v_fma_f32 v137, v59, v110, -v112
  v_fma_f32 v58, -v58, v110, v113
  v_fma_f32 v59, -v59, v110, v113
  v_mfma_f32_32x32x16_bf16 v[88:103], a[168:171], a[92:95], v[88:103]
  ds_read_b128 a[164:167], v3 offset:25600
  s_add_u32 s77, s56, 28672
  buffer_load_dwordx4 a[240:243], v1, s[8:11], s77 offen offset:0 sc1
  s_waitcnt lgkmcnt(4)
  v_mfma_f32_32x32x16_bf16 v[88:103], a[172:175], a[96:99], v[88:103]
  ds_read_b128 a[168:171], v3 offset:26624
  v_exp_f32 v136, v136
  v_exp_f32 v137, v137
  v_mfma_f32_32x32x16_bf16 v[88:103], a[176:179], a[100:103], v[88:103]
  ds_read_b128 a[172:175], v3 offset:27648
  buffer_load_dwordx4 a[244:247], v1, s[8:11], s77 offen offset:1024 sc1
  v_exp_f32 v58, v58
  v_mfma_f32_32x32x16_bf16 v[88:103], a[180:183], a[104:107], v[88:103]
  ds_read_b128 a[176:179], v3 offset:28672
  v_exp_f32 v59, v59
  v_add_f32 v114, v114, v134
  v_add_f32 v115, v115, v56
  s_waitcnt lgkmcnt(4)
  v_mfma_f32_32x32x16_bf16 v[88:103], a[184:187], a[108:111], v[88:103]
  ds_read_b128 a[180:183], v3 offset:29696
  buffer_load_dwordx4 a[248:251], v1, s[8:11], s77 offen offset:2048 sc1
  v_add_f32 v114, v114, v135
  v_add_f32 v115, v115, v57
  v_mfma_f32_32x32x16_bf16 v[88:103], a[188:191], a[112:115], v[88:103]
  ds_read_b128 a[184:187], v3 offset:30720
  v_add_f32 v114, v114, v136
  v_add_f32 v115, v115, v58
  v_add_f32 v114, v114, v137
  v_add_f32 v115, v115, v59
  v_mfma_f32_32x32x16_bf16 v[88:103], a[160:163], a[116:119], v[88:103]
  ds_read_b128 a[188:191], v3 offset:31744
  buffer_load_dwordx4 a[252:255], v1, s[8:11], s77 offen offset:3072 sc1
  s_waitcnt vmcnt(14)
  s_barrier
  s_waitcnt lgkmcnt(4)
  v_mfma_f32_32x32x16_bf16 v[88:103], a[164:167], a[120:123], v[88:103]
  ds_read_b128 a[160:163], v1 offset:0
  v_rcp_f32 v114, v114
  v_rcp_f32 v115, v115
  v_mul_f32 v118, v118, v114
  v_mfma_f32_32x32x16_bf16 v[88:103], a[168:171], a[124:127], v[88:103]
  ds_read_b128 a[164:167], v1 offset:1024
  buffer_load_dwordx4 a[0:3], v1, s[8:11], s55 offen offset:0 sc1
  v_mul_f32 v119, v119, v114
  v_mul_f32 v120, v120, v114
  v_mfma_f32_32x32x16_bf16 v[88:103], a[172:175], a[128:131], v[88:103]
  ds_read_b128 a[168:171], v1 offset:2048
  v_mul_f32 v121, v121, v114
  v_cvt_pk_bf16_f32 v140, v118, v119
  v_cvt_pk_bf16_f32 v141, v120, v121
  v_mul_f32 v122, v122, v114
  s_waitcnt lgkmcnt(4)
  v_mfma_f32_32x32x16_bf16 v[88:103], a[176:179], a[132:135], v[88:103]
  ds_read_b128 a[172:175], v1 offset:3072
  buffer_load_dwordx4 a[4:7], v1, s[8:11], s55 offen offset:1024 sc1
  v_mul_f32 v123, v123, v114
  v_mul_f32 v124, v124, v114
  v_mfma_f32_32x32x16_bf16 v[88:103], a[180:183], a[136:139], v[88:103]
  v_mul_f32 v125, v125, v114
  v_cvt_pk_bf16_f32 v142, v122, v123
  v_cvt_pk_bf16_f32 v143, v124, v125
  v_mul_f32 v126, v126, v114
  v_mul_f32 v127, v127, v114
  v_mul_f32 v128, v128, v114
  v_mfma_f32_32x32x16_bf16 v[88:103], a[184:187], a[140:143], v[88:103]
  buffer_load_dwordx4 a[8:11], v1, s[8:11], s55 offen offset:2048 sc1
  v_mul_f32 v129, v129, v114
  v_cvt_pk_bf16_f32 v144, v126, v127
  s_waitcnt lgkmcnt(2)
  v_mfma_f32_32x32x16_bf16 v[88:103], a[188:191], a[144:147], v[88:103]
  v_cvt_pk_bf16_f32 v145, v128, v129
  v_mul_f32 v130, v130, v114
  v_mul_f32 v131, v131, v114
  v_mul_f32 v132, v132, v114
  v_mul_f32 v133, v133, v114
  v_cvt_pk_bf16_f32 v146, v130, v131
  v_mfma_f32_32x32x16_bf16 v[88:103], a[160:163], a[148:151], v[88:103]
  buffer_load_dwordx4 a[12:15], v1, s[8:11], s55 offen offset:3072 sc1
  v_cvt_pk_bf16_f32 v147, v132, v133
  v_mul_f32 v134, v134, v114
  v_mul_f32 v135, v135, v114
  v_mfma_f32_32x32x16_bf16 v[88:103], a[164:167], a[152:155], v[88:103]
  v_mul_f32 v136, v136, v114
  v_mul_f32 v137, v137, v114
  v_cvt_pk_bf16_f32 v148, v134, v135
  v_cvt_pk_bf16_f32 v149, v136, v137
  v_mul_f32 v40, v40, v115
  s_waitcnt lgkmcnt(0)
  v_mfma_f32_32x32x16_bf16 v[88:103], a[168:171], a[156:159], v[88:103]
  s_add_u32 s57, s55, 4096
  buffer_load_dwordx4 a[16:19], v1, s[8:11], s57 offen offset:0 sc1
  v_mul_f32 v41, v41, v115
  v_mul_f32 v42, v42, v115
  v_mfma_f32_32x32x16_bf16 v[88:103], a[172:175], v[104:107], v[88:103]
  v_mul_f32 v43, v43, v115
  v_cvt_pk_bf16_f32 v150, v40, v41
  v_cvt_pk_bf16_f32 v151, v42, v43
  v_mul_f32 v44, v44, v115
  v_mul_f32 v45, v45, v115
  v_mul_f32 v46, v46, v115
  v_mul_f32 v47, v47, v115
  v_cvt_pk_bf16_f32 v152, v44, v45
  v_cvt_pk_bf16_f32 v153, v46, v47
  v_mul_f32 v48, v48, v115
  v_mul_f32 v49, v49, v115
  v_mul_f32 v50, v50, v115
  v_mul_f32 v51, v51, v115
  v_cvt_pk_bf16_f32 v154, v48, v49
  v_cvt_pk_bf16_f32 v155, v50, v51
  v_mul_f32 v52, v52, v115
  v_mul_f32 v53, v53, v115
  v_mul_f32 v54, v54, v115
  v_mul_f32 v55, v55, v115
  v_cvt_pk_bf16_f32 v156, v52, v53
  v_cvt_pk_bf16_f32 v157, v54, v55
  v_mul_f32 v56, v56, v115
  v_mul_f32 v57, v57, v115
  v_mul_f32 v58, v58, v115
  v_mul_f32 v59, v59, v115
  v_cvt_pk_bf16_f32 v158, v56, v57
  v_cvt_pk_bf16_f32 v159, v58, v59
  ds_write_b128 v24, v[140:143] offset:0
  ds_write_b128 v24, v[144:147] offset:16
  ds_write_b128 v24, v[148:151] offset:32
  ds_write_b128 v24, v[152:155] offset:48
  ds_write_b128 v24, v[156:159] offset:64
  v_mul_f32 v60, v60, v111
  v_mul_f32 v61, v61, v111
  v_mul_f32 v62, v62, v111
  v_mul_f32 v63, v63, v111
  v_cvt_pk_bf16_f32 v40, v60, v61
  v_cvt_pk_bf16_f32 v41, v62, v63
  v_mul_f32 v64, v64, v111
  v_mul_f32 v65, v65, v111
  v_mul_f32 v66, v66, v111
  v_mul_f32 v67, v67, v111
  v_cvt_pk_bf16_f32 v42, v64, v65
  v_cvt_pk_bf16_f32 v43, v66, v67
  v_mul_f32 v68, v68, v111
  v_mul_f32 v69, v69, v111
  v_mul_f32 v70, v70, v111
  v_mul_f32 v71, v71, v111
  v_cvt_pk_bf16_f32 v44, v68, v69
  v_cvt_pk_bf16_f32 v45, v70, v71
  v_mul_f32 v72, v72, v111
  v_mul_f32 v73, v73, v111
  v_mul_f32 v74, v74, v111
  v_mul_f32 v75, v75, v111
  v_cvt_pk_bf16_f32 v46, v72, v73
  v_cvt_pk_bf16_f32 v47, v74, v75
  v_mul_f32 v76, v76, v111
  v_mul_f32 v77, v77, v111
  v_mul_f32 v78, v78, v111
  v_mul_f32 v79, v79, v111
  v_cvt_pk_bf16_f32 v48, v76, v77
  v_cvt_pk_bf16_f32 v49, v78, v79
  v_mov_b32 v50, 0x3f80
  v_mov_b32 v51, 0
  ds_write_b128 v24, v[40:43] offset:80
  ds_write_b128 v24, v[44:47] offset:96
  ds_write_b128 v24, v[48:51] offset:112
  buffer_load_dwordx4 a[20:23], v1, s[8:11], s57 offen offset:1024 sc1
  buffer_load_dwordx4 a[24:27], v1, s[8:11], s57 offen offset:2048 sc1
  buffer_load_dwordx4 a[28:31], v1, s[8:11], s57 offen offset:3072 sc1
  s_waitcnt lgkmcnt(0)
  s_barrier
  ds_read_b64_tr_b16 a[100:101], v25 offset:0
  ds_read_b64_tr_b16 a[132:133], v26 offset:0
  ds_read_b64_tr_b16 a[102:103], v25 offset:144
  ds_read_b64_tr_b16 a[134:135], v26 offset:144
  ds_read_b64_tr_b16 a[104:105], v25 offset:2304
  ds_read_b64_tr_b16 a[136:137], v26 offset:2304
  ds_read_b64_tr_b16 a[106:107], v25 offset:2448
  ds_read_b64_tr_b16 a[138:139], v26 offset:2448
  ds_read_b64_tr_b16 a[108:109], v25 offset:4608
  ds_read_b64_tr_b16 a[140:141], v26 offset:4608
  ds_read_b64_tr_b16 a[110:111], v25 offset:4752
  ds_read_b64_tr_b16 a[142:143], v26 offset:4752
  s_waitcnt lgkmcnt(8)
  v_mfma_f32_32x32x16_bf16 v[40:55], a[100:103], a[132:135], 0
  ds_read_b64_tr_b16 a[112:113], v25 offset:6912
  ds_read_b64_tr_b16 a[144:145], v26 offset:6912
  ds_read_b64_tr_b16 a[114:115], v25 offset:7056
  ds_read_b64_tr_b16 a[146:147], v26 offset:7056
  s_add_u32 s57, s55, 8192
  buffer_load_dwordx4 a[32:35], v1, s[8:11], s57 offen offset:0 sc1
  s_waitcnt lgkmcnt(8)
  v_mfma_f32_32x32x16_bf16 v[40:55], a[104:107], a[136:139], v[40:55]
  ds_read_b64_tr_b16 a[116:117], v25 offset:9216
  ds_read_b64_tr_b16 a[148:149], v26 offset:9216
  ds_read_b64_tr_b16 a[118:119], v25 offset:9360
  ds_read_b64_tr_b16 a[150:151], v26 offset:9360
  buffer_load_dwordx4 a[36:39], v1, s[8:11], s57 offen offset:1024 sc1
  s_waitcnt lgkmcnt(8)
  v_mfma_f32_32x32x16_bf16 v[40:55], a[108:111], a[140:143], v[40:55]
  ds_read_b64_tr_b16 a[120:121], v25 offset:11520
  ds_read_b64_tr_b16 a[152:153], v26 offset:11520
  ds_read_b64_tr_b16 a[122:123], v25 offset:11664
  ds_read_b64_tr_b16 a[154:155], v26 offset:11664
  buffer_load_dwordx4 a[40:43], v1, s[8:11], s57 offen offset:2048 sc1
  s_waitcnt lgkmcnt(8)
  v_mfma_f32_32x32x16_bf16 v[40:55], a[112:115], a[144:147], v[40:55]
  ds_read_b64_tr_b16 a[124:125], v25 offset:13824
  ds_read_b64_tr_b16 a[156:157], v26 offset:13824
  ds_read_b64_tr_b16 a[126:127], v25 offset:13968
  ds_read_b64_tr_b16 a[158:159], v26 offset:13968
  buffer_load_dwordx4 a[44:47], v1, s[8:11], s57 offen offset:3072 sc1
  s_waitcnt lgkmcnt(8)
  v_mfma_f32_32x32x16_bf16 v[40:55], a[116:119], a[148:151], v[40:55]
  ds_read_b64_tr_b16 a[128:129], v25 offset:16128
  ds_read_b64_tr_b16 a[160:161], v26 offset:16128
  ds_read_b64_tr_b16 a[130:131], v25 offset:16272
  ds_read_b64_tr_b16 a[162:163], v26 offset:16272
  s_add_u32 s57, s55, 12288
  buffer_load_dwordx4 a[48:51], v1, s[8:11], s57 offen offset:0 sc1
  s_waitcnt lgkmcnt(8)
  v_mfma_f32_32x32x16_bf16 v[40:55], a[120:123], a[152:155], v[40:55]
  buffer_load_dwordx4 a[52:55], v1, s[8:11], s57 offen offset:1024 sc1
  s_waitcnt lgkmcnt(4)
  v_mfma_f32_32x32x16_bf16 v[40:55], a[124:127], a[156:159], v[40:55]
  buffer_load_dwordx4 a[56:59], v1, s[8:11], s57 offen offset:2048 sc1
  s_waitcnt lgkmcnt(0)
  v_mfma_f32_32x32x16_bf16 v[40:55], a[128:131], a[160:163], v[40:55]
  buffer_load_dwordx4 a[60:63], v1, s[8:11], s57 offen offset:3072 sc1
  v_max3_f32 v112, v80, v81, v82
  v_min3_f32 v113, v80, v81, v82
  v_max3_f32 v112, v112, v83, v84
  v_min3_f32 v113, v113, v83, v84
  v_max3_f32 v112, v112, v85, v86
  v_min3_f32 v113, v113, v85, v86
  v_max3_f32 v112, v112, v87, v88
  v_min3_f32 v113, v113, v87, v88
  v_max3_f32 v112, v112, v89, v90
  v_min3_f32 v113, v113, v89, v90
  v_max3_f32 v112, v112, v91, v92
  v_min3_f32 v113, v113, v91, v92
  v_cvt_pk_bf16_f32 v60, v40, v41
  v_cvt_pk_bf16_f32 v61, v42, v43
  v_cvt_pk_bf16_f32 v62, v44, v45
  v_cvt_pk_bf16_f32 v63, v46, v47
  v_cvt_pk_bf16_f32 v64, v48, v49
  v_cvt_pk_bf16_f32 v65, v50, v51
  s_mov_b32 exec_lo, 0x1fffff
  s_mov_b32 exec_hi, 0x1fffff
  ds_write_b64 v27, v[60:61]
  ds_write_b64 v27, v[62:63] offset:16
  s_mov_b32 exec_hi, 0
  ds_write_b64 v27, v[64:65] offset:32
  s_mov_b64 exec, -1
  v_max3_f32 v112, v112, v93, v94
  v_min3_f32 v113, v113, v93, v94
  v_max3_f32 v112, v112, v95, v96
  v_min3_f32 v113, v113, v95, v96
  v_max3_f32 v112, v112, v97, v98
  v_min3_f32 v113, v113, v97, v98
  v_max_f32 v112, v112, v99
  v_min_f32 v113, v113, v99
  v_mul_f32 v112, v112, v110
  v_mul_f32 v113, v113, v110
  s_waitcnt lgkmcnt(0)
  s_barrier
  ds_read_b128 v[68:71], v28
  v_pk_fma_f32 v[118:119], v[80:81], v[110:111], v[112:113] op_sel:[0,0,0] op_sel_hi:[1,0,0] neg_lo:[0,0,1] neg_hi:[0,0,1]
  v_pk_fma_f32 v[80:81], v[80:81], v[110:111], v[112:113] op_sel:[0,0,1] op_sel_hi:[1,0,1] neg_lo:[1,0,0] neg_hi:[1,0,0]
  v_pk_fma_f32 v[120:121], v[82:83], v[110:111], v[112:113] op_sel:[0,0,0] op_sel_hi:[1,0,0] neg_lo:[0,0,1] neg_hi:[0,0,1]
  v_pk_fma_f32 v[82:83], v[82:83], v[110:111], v[112:113] op_sel:[0,0,1] op_sel_hi:[1,0,1] neg_lo:[1,0,0] neg_hi:[1,0,0]
  v_pk_fma_f32 v[122:123], v[84:85], v[110:111], v[112:113] op_sel:[0,0,0] op_sel_hi:[1,0,0] neg_lo:[0,0,1] neg_hi:[0,0,1]
  v_pk_fma_f32 v[84:85], v[84:85], v[110:111], v[112:113] op_sel:[0,0,1] op_sel_hi:[1,0,1] neg_lo:[1,0,0] neg_hi:[1,0,0]
  v_pk_fma_f32 v[124:125], v[86:87], v[110:111], v[112:113] op_sel:[0,0,0] op_sel_hi:[1,0,0] neg_lo:[0,0,1] neg_hi:[0,0,1]
  v_pk_fma_f32 v[86:87], v[86:87], v[110:111], v[112:113] op_sel:[0,0,1] op_sel_hi:[1,0,1] neg_lo:[1,0,0] neg_hi:[1,0,0]
  v_pk_fma_f32 v[126:127], v[88:89], v[110:111], v[112:113] op_sel:[0,0,0] op_sel_hi:[1,0,0] neg_lo:[0,0,1] neg_hi:[0,0,1]
  v_pk_fma_f32 v[88:89], v[88:89], v[110:111], v[112:113] op_sel:[0,0,1] op_sel_hi:[1,0,1] neg_lo:[1,0,0] neg_hi:[1,0,0]
  v_pk_fma_f32 v[128:129], v[90:91], v[110:111], v[112:113] op_sel:[0,0,0] op_sel_hi:[1,0,0] neg_lo:[0,0,1] neg_hi:[0,0,1]
  v_pk_fma_f32 v[90:91], v[90:91], v[110:111], v[112:113] op_sel:[0,0,1] op_sel_hi:[1,0,1] neg_lo:[1,0,0] neg_hi:[1,0,0]
  v_pk_fma_f32 v[130:131], v[92:93], v[110:111], v[112:113] op_sel:[0,0,0] op_sel_hi:[1,0,0] neg_lo:[0,0,1] neg_hi:[0,0,1]
  v_pk_fma_f32 v[92:93], v[92:93], v[110:111], v[112:113] op_sel:[0,0,1] op_sel_hi:[1,0,1] neg_lo:[1,0,0] neg_hi:[1,0,0]
  v_pk_fma_f32 v[132:133], v[94:95], v[110:111], v[112:113] op_sel:[0,0,0] op_sel_hi:[1,0,0] neg_lo:[0,0,1] neg_hi:[0,0,1]
  v_pk_fma_f32 v[94:95], v[94:95], v[110:111], v[112:113] op_sel:[0,0,1] op_sel_hi:[1,0,1] neg_lo:[1,0,0] neg_hi:[1,0,0]
  v_pk_fma_f32 v[134:135], v[96:97], v[110:111], v[112:113] op_sel:[0,0,0] op_sel_hi:[1,0,0] neg_lo:[0,0,1] neg_hi:[0,0,1]
  v_pk_fma_f32 v[96:97], v[96:97], v[110:111], v[112:113] op_sel:[0,0,1] op_sel_hi:[1,0,1] neg_lo:[1,0,0] neg_hi:[1,0,0]
  v_pk_fma_f32 v[136:137], v[98:99], v[110:111], v[112:113] op_sel:[0,0,0] op_sel_hi:[1,0,0] neg_lo:[0,0,1] neg_hi:[0,0,1]
  v_pk_fma_f32 v[98:99], v[98:99], v[110:111], v[112:113] op_sel:[0,0,1] op_sel_hi:[1,0,1] neg_lo:[1,0,0] neg_hi:[1,0,0]
  s_waitcnt lgkmcnt(0)
  buffer_store_dwordx4 v[68:71], v29, s[8:11], s38 offen sc1
  s_add_u32 s57, s55, 16384
  buffer_load_dwordx4 a[64:67], v1, s[8:11], s57 offen offset:0 sc1
  v_exp_f32 v118, v118
  v_exp_f32 v119, v119
  v_exp_f32 v80, v80
  v_exp_f32 v81, v81
  v_cvt_pk_bf16_f32 v140, v118, v119
  v_exp_f32 v120, v120
  v_exp_f32 v121, v121
  v_exp_f32 v82, v82
  v_exp_f32 v83, v83
  buffer_load_dwordx4 a[68:71], v1, s[8:11], s57 offen offset:1024 sc1
  v_pk_add_f32 v[114:115], v[118:119], v[120:121]
  v_cvt_pk_bf16_f32 v141, v120, v121
  v_exp_f32 v122, v122
  v_exp_f32 v123, v123
  v_exp_f32 v84, v84
  v_exp_f32 v85, v85
  v_pk_add_f32 v[116:117], v[80:81], v[82:83]
  v_pk_add_f32 v[114:115], v[114:115], v[122:123]
  v_cvt_pk_bf16_f32 v142, v122, v123
  buffer_load_dwordx4 a[72:75], v1, s[8:11], s57 offen offset:2048 sc1
  v_exp_f32 v124, v124
  v_exp_f32 v125, v125
  v_exp_f32 v86, v86
  v_exp_f32 v87, v87
  v_pk_add_f32 v[114:115], v[114:115], v[124:125]
  v_pk_add_f32 v[116:117], v[116:117], v[84:85]
  v_cvt_pk_bf16_f32 v143, v124, v125
  v_exp_f32 v126, v126
  v_exp_f32 v127, v127
  buffer_load_dwordx4 a[76:79], v1, s[8:11], s57 offen offset:3072 sc1
  v_exp_f32 v88, v88
  v_exp_f32 v89, v89
  v_pk_add_f32 v[114:115], v[114:115], v[126:127]
  v_pk_add_f32 v[116:117], v[116:117], v[86:87]
  v_cvt_pk_bf16_f32 v144, v126, v127
  v_exp_f32 v128, v128
  v_exp_f32 v129, v129
  v_exp_f32 v90, v90
  v_exp_f32 v91, v91
  s_add_u32 s57, s55, 20480
  buffer_load_dwordx4 a[80:83], v1, s[8:11], s57 offen offset:0 sc1
  v_pk_add_f32 v[114:115], v[114:115], v[128:129]
  v_pk_add_f32 v[116:117], v[116:117], v[88:89]
  v_cvt_pk_bf16_f32 v145, v128, v129
  v_exp_f32 v130, v130
  v_exp_f32 v131, v131
  v_exp_f32 v92, v92
  v_exp_f32 v93, v93
  v_pk_add_f32 v[114:115], v[114:115], v[130:131]
  v_pk_add_f32 v[116:117], v[116:117], v[90:91]
  buffer_load_dwordx4 a[84:87], v1, s[8:11], s57 offen offset:1024 sc1
  v_cvt_pk_bf16_f32 v146, v130, v131
  v_exp_f32 v132, v132
  v_exp_f32 v133, v133
  v_exp_f32 v94, v94
  v_exp_f32 v95, v95
  v_pk_add_f32 v[114:115], v[114:115], v[132:133]
  v_pk_add_f32 v[116:117], v[116:117], v[92:93]
  v_cvt_pk_bf16_f32 v147, v132, v133
  v_exp_f32 v134, v134
  buffer_load_dwordx4 a[88:91], v1, s[8:11], s57 offen offset:2048 sc1
  v_exp_f32 v135, v135
  v_exp_f32 v96, v96
  v_exp_f32 v97, v97
  v_pk_add_f32 v[114:115], v[114:115], v[134:135]
  v_pk_add_f32 v[116:117], v[116:117], v[94:95]
  v_cvt_pk_bf16_f32 v148, v134, v135
  v_exp_f32 v136, v136
  v_exp_f32 v137, v137
  v_exp_f32 v98, v98
  buffer_load_dwordx4 a[92:95], v1, s[8:11], s57 offen offset:3072 sc1
  v_exp_f32 v99, v99
  v_pk_add_f32 v[114:115], v[114:115], v[136:137]
  v_pk_add_f32 v[116:117], v[116:117], v[96:97]
  v_cvt_pk_bf16_f32 v149, v136, v137
  v_pk_add_f32 v[116:117], v[116:117], v[98:99]
  v_add_f32 v114, v114, v115
  v_add_f32 v116, v116, v117
  v_rcp_f32 v116, v116
  s_nop 0
  s_add_u32 s57, s55, 24576
  buffer_load_dwordx4 a[96:99], v1, s[8:11], s57 offen offset:0 sc1
  v_mul_f32 v116, v116, v114
  v_pk_mul_f32 v[80:81], v[80:81], v[116:117] op_sel:[0,0] op_sel_hi:[1,0]
  v_pk_mul_f32 v[82:83], v[82:83], v[116:117] op_sel:[0,0] op_sel_hi:[1,0]
  v_pk_mul_f32 v[84:85], v[84:85], v[116:117] op_sel:[0,0] op_sel_hi:[1,0]
  v_pk_mul_f32 v[86:87], v[86:87], v[116:117] op_sel:[0,0] op_sel_hi:[1,0]
  v_pk_mul_f32 v[88:89], v[88:89], v[116:117] op_sel:[0,0] op_sel_hi:[1,0]
  v_pk_mul_f32 v[90:91], v[90:91], v[116:117] op_sel:[0,0] op_sel_hi:[1,0]
  v_pk_mul_f32 v[92:93], v[92:93], v[116:117] op_sel:[0,0] op_sel_hi:[1,0]
  v_pk_mul_f32 v[94:95], v[94:95], v[116:117] op_sel:[0,0] op_sel_hi:[1,0]
  v_pk_mul_f32 v[96:97], v[96:97], v[116:117] op_sel:[0,0] op_sel_hi:[1,0]
  v_pk_mul_f32 v[98:99], v[98:99], v[116:117] op_sel:[0,0] op_sel_hi:[1,0]
  v_cvt_pk_bf16_f32 v150, v80, v81
  v_cvt_pk_bf16_f32 v151, v82, v83
  v_cvt_pk_bf16_f32 v152, v84, v85
  v_cvt_pk_bf16_f32 v153, v86, v87
  v_cvt_pk_bf16_f32 v154, v88, v89
  v_cvt_pk_bf16_f32 v155, v90, v91
  v_cvt_pk_bf16_f32 v156, v92, v93
  v_cvt_pk_bf16_f32 v157, v94, v95
  v_cvt_pk_bf16_f32 v158, v96, v97
  v_cvt_pk_bf16_f32 v159, v98, v99
  s_mov_b32 s3, s39
  buffer_load_dwordx4 a[100:103], v29, s[8:11], s3 offen sc1
  s_addk_i32 s3, 4096
  buffer_load_dwordx4 a[104:107], v29, s[8:11], s3 offen sc1
  s_addk_i32 s3, 4096
  buffer_load_dwordx4 a[108:111], v29, s[8:11], s3 offen sc1
  s_addk_i32 s3, 4096
  buffer_load_dwordx4 a[112:115], v29, s[8:11], s3 offen sc1
  s_addk_i32 s3, 4096
  buffer_load_dwordx4 a[116:119], v29, s[8:11], s3 offen sc1
  s_addk_i32 s3, 4096
  buffer_load_dwordx4 a[120:123], v29, s[8:11], s3 offen sc1
  s_addk_i32 s3, 4096
  buffer_load_dwordx4 a[124:127], v29, s[8:11], s3 offen sc1
  s_addk_i32 s3, 4096
  buffer_load_dwordx4 a[128:131], v29, s[8:11], s3 offen sc1
  s_addk_i32 s3, 4096
  buffer_load_dwordx4 a[132:135], v29, s[8:11], s3 offen sc1
  s_addk_i32 s3, 4096
  buffer_load_dwordx4 a[136:139], v29, s[8:11], s3 offen sc1
  s_addk_i32 s3, 4096
  buffer_load_dwordx4 a[140:143], v29, s[8:11], s3 offen sc1
  s_addk_i32 s3, 4096
  buffer_load_dwordx4 a[144:147], v29, s[8:11], s3 offen sc1
  s_addk_i32 s3, 4096
  buffer_load_dwordx4 a[148:151], v29, s[8:11], s3 offen sc1
  s_addk_i32 s3, 4096
  buffer_load_dwordx4 a[152:155], v29, s[8:11], s3 offen sc1
  s_addk_i32 s3, 4096
  buffer_load_dwordx4 a[156:159], v29, s[8:11], s3 offen sc1
  s_addk_i32 s3, 4096
  buffer_load_dwordx4 a[160:163], v29, s[8:11], s3 offen sc1
  s_addk_i32 s3, 4096
  s_waitcnt vmcnt(15)
  v_mfma_f32_32x32x16_bf16 v[40:55], v[36:39], a[100:103], 0
  s_waitcnt vmcnt(14)
  v_mfma_f32_32x32x16_bf16 v[40:55], v[36:39], a[104:107], v[40:55]
  s_add_u32 m0, s27, 65536
  s_add_u32 s34, s33, 0
  buffer_load_dwordx4 v1, s[20:23], s34 offen offset:0 sc1 lds
  s_waitcnt vmcnt(14)
  v_mfma_f32_32x32x16_bf16 v[40:55], v[36:39], a[108:111], v[40:55]
  buffer_load_dwordx4 v1, s[20:23], s34 offen offset:1024 sc1 lds
  s_waitcnt vmcnt(14)
  v_mfma_f32_32x32x16_bf16 v[40:55], v[36:39], a[112:115], v[40:55]
  buffer_load_dwordx4 v1, s[20:23], s34 offen offset:2048 sc1 lds
  s_waitcnt vmcnt(14)
  v_mfma_f32_32x32x16_bf16 v[40:55], v[36:39], a[116:119], v[40:55]
  buffer_load_dwordx4 v1, s[20:23], s34 offen offset:3072 sc1 lds
  s_waitcnt vmcnt(14)
  v_mfma_f32_32x32x16_bf16 v[40:55], v[36:39], a[120:123], v[40:55]
  s_waitcnt vmcnt(13)
  v_mfma_f32_32x32x16_bf16 v[40:55], v[36:39], a[124:127], v[40:55]
  s_add_u32 m0, s27, 69632
  s_add_u32 s34, s33, 4096
  buffer_load_dwordx4 v1, s[20:23], s34 offen offset:0 sc1 lds
  s_waitcnt vmcnt(13)
  v_mfma_f32_32x32x16_bf16 v[40:55], v[36:39], a[128:131], v[40:55]
  buffer_load_dwordx4 v1, s[20:23], s34 offen offset:1024 sc1 lds
  s_waitcnt vmcnt(13)
  v_mfma_f32_32x32x16_bf16 v[40:55], v[36:39], a[132:135], v[40:55]
  buffer_load_dwordx4 v1, s[20:23], s34 offen offset:2048 sc1 lds
  s_waitcnt vmcnt(13)
  v_mfma_f32_32x32x16_bf16 v[40:55], v[36:39], a[136:139], v[40:55]
  buffer_load_dwordx4 v1, s[20:23], s34 offen offset:3072 sc1 lds
  s_waitcnt vmcnt(13)
  v_mfma_f32_32x32x16_bf16 v[40:55], v[36:39], a[140:143], v[40:55]
  s_waitcnt vmcnt(12)
  v_mfma_f32_32x32x16_bf16 v[40:55], v[36:39], a[144:147], v[40:55]
  s_add_u32 m0, s27, 98304
  s_add_u32 s34, s33, 32768
  buffer_load_dwordx4 v1, s[20:23], s34 offen offset:0 sc1 lds
  s_waitcnt vmcnt(12)
  v_mfma_f32_32x32x16_bf16 v[40:55], v[36:39], a[148:151], v[40:55]
  buffer_load_dwordx4 v1, s[20:23], s34 offen offset:1024 sc1 lds
  s_waitcnt vmcnt(12)
  v_mfma_f32_32x32x16_bf16 v[40:55], v[36:39], a[152:155], v[40:55]
  buffer_load_dwordx4 v1, s[20:23], s34 offen offset:2048 sc1 lds
  s_waitcnt vmcnt(12)
  v_mfma_f32_32x32x16_bf16 v[40:55], v[36:39], a[156:159], v[40:55]
  buffer_load_dwordx4 v1, s[20:23], s34 offen offset:3072 sc1 lds
  s_waitcnt vmcnt(12)
  v_mfma_f32_32x32x16_bf16 v[40:55], v[36:39], a[160:163], v[40:55]
  s_add_u32 m0, s27, 102400
  s_add_u32 s34, s33, 36864
  buffer_load_dwordx4 v1, s[20:23], s34 offen offset:0 sc1 lds
  s_nop 8
  v_cmp_u_f32 vcc, v40, v40
  s_nop 3
  s_cbranch_vccnz P1_RETRY
P1_SUMMED:
  v_cvt_pk_bf16_f32 v68, v40, v41
  v_cvt_pk_bf16_f32 v69, v42, v43
  v_cvt_pk_bf16_f32 v70, v44, v45
  v_cvt_pk_bf16_f32 v71, v46, v47
  ds_write_b128 v28, v[68:71]
  buffer_load_dwordx4 v1, s[20:23], s34 offen offset:1024 sc1 lds
  buffer_load_dwordx4 v1, s[20:23], s34 offen offset:2048 sc1 lds
  s_waitcnt lgkmcnt(0)
  s_barrier
  ds_read_b128 a[100:103], v32 offset:0
  ds_read_b128 a[104:107], v33 offset:0
  ds_read_b128 a[108:111], v32 offset:16
  ds_read_b128 a[112:115], v33 offset:16
  ds_read_b128 a[116:119], v32 offset:32
  ds_read_b128 a[120:123], v33 offset:32
  ds_read_b128 a[124:127], v32 offset:48
  ds_read_b128 a[128:131], v33 offset:48
  ds_read_b128 a[132:135], v32 offset:64
  ds_read_b128 a[136:139], v33 offset:64
  buffer_load_dwordx4 v1, s[20:23], s34 offen offset:3072 sc1 lds
  s_add_u32 m0, s27, 131072
  s_add_u32 s34, s33, 65536
  buffer_load_dwordx4 v1, s[20:23], s34 offen offset:0 sc1 lds
  s_waitcnt lgkmcnt(8)
  v_mfma_f32_32x32x16_bf16 v[56:71], a[104:107], v[140:143], 0
  v_mfma_f32_32x32x16_bf16 v[40:55], a[100:103], v[140:143], 0
  s_waitcnt lgkmcnt(6)
  v_mfma_f32_32x32x16_bf16 v[56:71], a[112:115], v[144:147], v[56:71]
  v_mfma_f32_32x32x16_bf16 v[40:55], a[108:111], v[144:147], v[40:55]
  s_waitcnt lgkmcnt(4)
  v_mfma_f32_32x32x16_bf16 v[56:71], a[120:123], v[148:151], v[56:71]
  v_mfma_f32_32x32x16_bf16 v[40:55], a[116:119], v[148:151], v[40:55]
  s_waitcnt lgkmcnt(2)
  v_mfma_f32_32x32x16_bf16 v[56:71], a[128:131], v[152:155], v[56:71]
  v_mfma_f32_32x32x16_bf16 v[40:55], a[124:127], v[152:155], v[40:55]
  s_waitcnt lgkmcnt(0)
  v_mfma_f32_32x32x16_bf16 v[56:71], a[136:139], v[156:159], v[56:71]
  v_mfma_f32_32x32x16_bf16 v[40:55], a[132:135], v[156:159], v[40:55]
  v_mul_f32 v114, 0x358637bd, v114
  s_nop 9
  v_add_f32 v114, v114, v60
  v_rcp_f32 v114, v114
  s_nop 0
  v_pk_mul_f32 v[56:57], v[56:57], v[114:115] op_sel:[0,0] op_sel_hi:[1,0]
  v_pk_mul_f32 v[58:59], v[58:59], v[114:115] op_sel:[0,0] op_sel_hi:[1,0]
  v_pk_mul_f32 v[40:41], v[40:41], v[114:115] op_sel:[0,0] op_sel_hi:[1,0]
  v_pk_mul_f32 v[42:43], v[42:43], v[114:115] op_sel:[0,0] op_sel_hi:[1,0]
  v_pk_mul_f32 v[44:45], v[44:45], v[114:115] op_sel:[0,0] op_sel_hi:[1,0]
  v_pk_mul_f32 v[46:47], v[46:47], v[114:115] op_sel:[0,0] op_sel_hi:[1,0]
  v_pk_mul_f32 v[48:49], v[48:49], v[114:115] op_sel:[0,0] op_sel_hi:[1,0]
  v_pk_mul_f32 v[50:51], v[50:51], v[114:115] op_sel:[0,0] op_sel_hi:[1,0]
  v_pk_mul_f32 v[52:53], v[52:53], v[114:115] op_sel:[0,0] op_sel_hi:[1,0]
  v_pk_mul_f32 v[54:55], v[54:55], v[114:115] op_sel:[0,0] op_sel_hi:[1,0]
  v_cvt_pk_bf16_f32 v148, v56, v57
  v_cvt_pk_bf16_f32 v149, v58, v59
  v_cvt_pk_bf16_f32 v140, v40, v41
  v_cvt_pk_bf16_f32 v141, v42, v43
  v_cvt_pk_bf16_f32 v142, v44, v45
  v_cvt_pk_bf16_f32 v143, v46, v47
  v_cvt_pk_bf16_f32 v144, v48, v49
  v_cvt_pk_bf16_f32 v145, v50, v51
  v_cvt_pk_bf16_f32 v146, v52, v53
  v_cvt_pk_bf16_f32 v147, v54, v55
  buffer_store_dwordx2 v[148:149], v31, s[8:11], s41 offen sc1
  buffer_store_dwordx4 v[140:143], v30, s[8:11], s40 offen sc1
  buffer_store_dwordx4 v[144:147], v30, s[8:11], s40 offen offset:256 sc1
  s_barrier
  s_waitcnt vmcnt(0)
  s_add_u32 s3, s42, 12455936
  s_mov_b64 exec, 1
  s_cmp_lg_u32 s16, 0
  s_cbranch_scc1 HS0
  buffer_store_dword v20, v1, s[8:11], s3 offen
HB0:
  s_mov_b64 exec, -1
  s_add_u32 s70, s45, 12455936
  s_mov_b64 exec, 0xff
  buffer_load_dword v21, v5, s[8:11], s70 offen sc1
  s_mov_b64 exec, -1
  s_waitcnt vmcnt(0)
  v_cmp_ne_u32 vcc, v20, v21
  s_nop 3
  s_and_b64 vcc, vcc, 0xff
  s_cbranch_vccnz PO_SPIN
PO_OK:
  buffer_load_dwordx4 a[100:103], v1, s[8:11], s46 offen offset:0 sc1
  buffer_load_dwordx4 a[104:107], v1, s[8:11], s46 offen offset:1024 sc1
  buffer_load_dwordx4 a[108:111], v1, s[8:11], s46 offen offset:2048 sc1
  buffer_load_dwordx4 a[112:115], v1, s[8:11], s46 offen offset:3072 sc1
  s_add_u32 s54, s46, 4096
  buffer_load_dwordx4 a[116:119], v1, s[8:11], s54 offen offset:0 sc1
  buffer_load_dwordx4 a[120:123], v1, s[8:11], s47 offen offset:0 sc1
  buffer_load_dwordx4 a[124:127], v1, s[8:11], s47 offen offset:1024 sc1
  buffer_load_dwordx4 a[128:131], v1, s[8:11], s47 offen offset:2048 sc1
  buffer_load_dwordx4 a[132:135], v1, s[8:11], s47 offen offset:3072 sc1
  s_add_u32 s54, s47, 4096
  buffer_load_dwordx4 a[136:139], v1, s[8:11], s54 offen offset:0 sc1
  buffer_load_dwordx4 a[140:143], v1, s[8:11], s48 offen offset:0 sc1
  buffer_load_dwordx4 a[144:147], v1, s[8:11], s48 offen offset:1024 sc1
  s_add_u32 s3, s12, 1
  s_and_b32 s3, s3, 3
  s_mul_i32 s3, s3, 15360
  s_add_u32 s3, s3, 4096
  v_add_u32 v86, s3, v1
  s_add_u32 s3, s12, 2
  s_and_b32 s3, s3, 3
  s_mul_i32 s3, s3, 15360
  s_add_u32 s3, s3, 9216
  v_add_u32 v87, s3, v1
  s_add_u32 s3, s12, 3
  s_and_b32 s3, s3, 3
  s_mul_i32 s3, s3, 15360
  s_add_u32 s3, s3, 14336
  v_add_u32 v88, s3, v1
  s_mul_i32 s3, s12, 15360
  s_add_u32 s3, s3, 4096
  v_add_u32 v89, s3, v1
  v_lshlrev_b32 v64, 16, v10
  v_and_b32 v65, 0xffff0000, v10
  v_lshlrev_b32 v66, 16, v11
  v_and_b32 v67, 0xffff0000, v11
  v_lshlrev_b32 v68, 16, v12
  v_and_b32 v69, 0xffff0000, v12
  v_lshlrev_b32 v70, 16, v13
  v_and_b32 v71, 0xffff0000, v13
  v_lshlrev_b32 v72, 16, v14
  v_and_b32 v73, 0xffff0000, v14
  v_lshlrev_b32 v74, 16, v15
  v_and_b32 v75, 0xffff0000, v15
  v_lshlrev_b32 v76, 16, v16
  v_and_b32 v77, 0xffff0000, v16
  v_lshlrev_b32 v78, 16, v17
  v_and_b32 v79, 0xffff0000, v17
  v_lshlrev_b32 v80, 16, v18
  v_and_b32 v81, 0xffff0000, v18
  v_lshlrev_b32 v82, 16, v19
  v_and_b32 v83, 0xffff0000, v19
  s_waitcnt vmcnt(11)
  v_mfma_f32_16x16x32_bf16 v[24:27], a[0:3], a[100:103], 0
  buffer_load_dwordx4 a[148:151], v1, s[8:11], s48 offen offset:2048 sc1
  v_mfma_f32_16x16x32_bf16 v[28:31], a[4:7], a[100:103], 0
  buffer_load_dwordx4 a[152:155], v1, s[8:11], s48 offen offset:3072 sc1
  v_mfma_f32_16x16x32_bf16 v[32:35], a[8:11], a[100:103], 0
  s_add_u32 s54, s48, 4096
  buffer_load_dwordx4 a[156:159], v1, s[8:11], s54 offen offset:0 sc1
  v_mfma_f32_16x16x32_bf16 v[36:39], a[12:15], a[100:103], 0
  buffer_load_dwordx4 a[160:163], v1, s[8:11], s49 offen offset:0 sc1
  v_mfma_f32_16x16x32_bf16 v[40:43], a[16:19], a[100:103], 0
  buffer_load_dwordx4 a[164:167], v1, s[8:11], s49 offen offset:1024 sc1
  s_waitcnt vmcnt(15)
  v_mfma_f32_16x16x32_bf16 v[24:27], a[20:23], a[104:107], v[24:27]
  buffer_load_dwordx4 a[168:171], v1, s[8:11], s49 offen offset:2048 sc1
  v_mfma_f32_16x16x32_bf16 v[28:31], a[24:27], a[104:107], v[28:31]
  buffer_load_dwordx4 a[172:175], v1, s[8:11], s49 offen offset:3072 sc1
  v_mfma_f32_16x16x32_bf16 v[32:35], a[28:31], a[104:107], v[32:35]
  s_add_u32 s54, s49, 4096
  buffer_load_dwordx4 a[176:179], v1, s[8:11], s54 offen offset:0 sc1
  v_mfma_f32_16x16x32_bf16 v[36:39], a[32:35], a[104:107], v[36:39]
  v_mfma_f32_16x16x32_bf16 v[40:43], a[36:39], a[104:107], v[40:43]
  s_waitcnt vmcnt(17)
  v_mfma_f32_16x16x32_bf16 v[24:27], a[40:43], a[108:111], v[24:27]
  v_mfma_f32_16x16x32_bf16 v[28:31], a[44:47], a[108:111], v[28:31]
  v_mfma_f32_16x16x32_bf16 v[32:35], a[48:51], a[108:111], v[32:35]
  v_mfma_f32_16x16x32_bf16 v[36:39], a[52:55], a[108:111], v[36:39]
  v_mfma_f32_16x16x32_bf16 v[40:43], a[56:59], a[108:111], v[40:43]
  s_waitcnt vmcnt(16)
  v_mfma_f32_16x16x32_bf16 v[24:27], a[60:63], a[112:115], v[24:27]
  buffer_load_dwordx4 v1, s[20:23], s34 offen offset:1024 sc1 lds
  v_mfma_f32_16x16x32_bf16 v[28:31], a[64:67], a[112:115], v[28:31]
  v_mfma_f32_16x16x32_bf16 v[32:35], a[68:71], a[112:115], v[32:35]
  v_mfma_f32_16x16x32_bf16 v[36:39], a[72:75], a[112:115], v[36:39]
  buffer_load_dwordx4 v1, s[20:23], s34 offen offset:2048 sc1 lds
  v_mfma_f32_16x16x32_bf16 v[40:43], a[76:79], a[112:115], v[40:43]
  s_waitcnt vmcnt(17)
  v_mfma_f32_16x16x32_bf16 v[24:27], a[80:83], a[116:119], v[24:27]
  v_mfma_f32_16x16x32_bf16 v[28:31], a[84:87], a[116:119], v[28:31]
  buffer_load_dwordx4 v1, s[20:23], s34 offen offset:3072 sc1 lds
  v_mfma_f32_16x16x32_bf16 v[32:35], a[88:91], a[116:119], v[32:35]
  v_mfma_f32_16x16x32_bf16 v[36:39], a[92:95], a[116:119], v[36:39]
  v_mfma_f32_16x16x32_bf16 v[40:43], a[96:99], a[116:119], v[40:43]
  s_add_u32 m0, s27, 135168
  s_add_u32 s34, s33, 69632
  buffer_load_dwordx4 v1, s[20:23], s34 offen offset:0 sc1 lds
  s_waitcnt vmcnt(18)
  v_mfma_f32_16x16x32_bf16 v[44:47], a[0:3], a[120:123], 0
  v_mfma_f32_16x16x32_bf16 v[48:51], a[4:7], a[120:123], 0
  v_mfma_f32_16x16x32_bf16 v[52:55], a[8:11], a[120:123], 0
  buffer_load_dwordx4 v1, s[20:23], s34 offen offset:1024 sc1 lds
  v_mfma_f32_16x16x32_bf16 v[56:59], a[12:15], a[120:123], 0
  ds_write_b128 v86, v[24:27] offset:0
  v_mfma_f32_16x16x32_bf16 v[60:63], a[16:19], a[120:123], 0
  ds_write_b128 v86, v[28:31] offset:1024
  s_waitcnt vmcnt(18)
  v_mfma_f32_16x16x32_bf16 v[44:47], a[20:23], a[124:127], v[44:47]
  buffer_load_dwordx4 v1, s[20:23], s34 offen offset:2048 sc1 lds
  v_mfma_f32_16x16x32_bf16 v[48:51], a[24:27], a[124:127], v[48:51]
  ds_write_b128 v86, v[32:35] offset:2048
  v_mfma_f32_16x16x32_bf16 v[52:55], a[28:31], a[124:127], v[52:55]
  v_mfma_f32_16x16x32_bf16 v[56:59], a[32:35], a[124:127], v[56:59]
  buffer_load_dwordx4 v1, s[20:23], s34 offen offset:3072 sc1 lds
  v_mfma_f32_16x16x32_bf16 v[60:63], a[36:39], a[124:127], v[60:63]
  ds_write_b128 v86, v[36:39] offset:3072
  s_waitcnt vmcnt(19)
  v_mfma_f32_16x16x32_bf16 v[44:47], a[40:43], a[128:131], v[44:47]
  ds_write_b128 v86, v[40:43] offset:4096
  v_mfma_f32_16x16x32_bf16 v[48:51], a[44:47], a[128:131], v[48:51]
  s_add_u32 m0, s25, 0
  s_add_u32 s34, s31, 98304
  buffer_load_dwordx4 v1, s[20:23], s34 offen offset:0 sc1 lds
  v_mfma_f32_16x16x32_bf16 v[52:55], a[48:51], a[128:131], v[52:55]
  v_mfma_f32_16x16x32_bf16 v[56:59], a[52:55], a[128:131], v[56:59]
  v_mfma_f32_16x16x32_bf16 v[60:63], a[56:59], a[128:131], v[60:63]
  s_add_u32 s77, s56, 32768
  buffer_load_dwordx4 v[160:163], v1, s[8:11], s77 offen offset:0 sc1
  s_waitcnt vmcnt(20)
  v_mfma_f32_16x16x32_bf16 v[44:47], a[60:63], a[132:135], v[44:47]
  v_mfma_f32_16x16x32_bf16 v[48:51], a[64:67], a[132:135], v[48:51]
  v_mfma_f32_16x16x32_bf16 v[52:55], a[68:71], a[132:135], v[52:55]
  buffer_load_dwordx4 v[164:167], v1, s[8:11], s77 offen offset:1024 sc1
  v_mfma_f32_16x16x32_bf16 v[56:59], a[72:75], a[132:135], v[56:59]
  v_mfma_f32_16x16x32_bf16 v[60:63], a[76:79], a[132:135], v[60:63]
  s_waitcnt vmcnt(20)
  v_mfma_f32_16x16x32_bf16 v[44:47], a[80:83], a[136:139], v[44:47]
  buffer_load_dwordx4 v[168:171], v1, s[8:11], s77 offen offset:2048 sc1
  v_mfma_f32_16x16x32_bf16 v[48:51], a[84:87], a[136:139], v[48:51]
  v_mfma_f32_16x16x32_bf16 v[52:55], a[88:91], a[136:139], v[52:55]
  v_mfma_f32_16x16x32_bf16 v[56:59], a[92:95], a[136:139], v[56:59]
  buffer_load_dwordx4 v[172:175], v1, s[8:11], s77 offen offset:3072 sc1
  v_mfma_f32_16x16x32_bf16 v[60:63], a[96:99], a[136:139], v[60:63]
  s_waitcnt vmcnt(21)
  v_mfma_f32_16x16x32_bf16 v[24:27], a[0:3], a[140:143], 0
  v_mfma_f32_16x16x32_bf16 v[28:31], a[4:7], a[140:143], 0
  s_add_u32 s77, s56, 36864
  buffer_load_dwordx4 v[176:179], v1, s[8:11], s77 offen offset:0 sc1
  v_mfma_f32_16x16x32_bf16 v[32:35], a[8:11], a[140:143], 0
  ds_write_b128 v87, v[44:47] offset:0
  v_mfma_f32_16x16x32_bf16 v[36:39], a[12:15], a[140:143], 0
  v_mfma_f32_16x16x32_bf16 v[40:43], a[16:19], a[140:143], 0
  buffer_load_dwordx4 v[180:183], v1, s[8:11], s77 offen offset:1024 sc1
  s_waitcnt vmcnt(22)
  v_mfma_f32_16x16x32_bf16 v[24:27], a[20:23], a[144:147], v[24:27]
  ds_write_b128 v87, v[48:51] offset:1024
  v_mfma_f32_16x16x32_bf16 v[28:31], a[24:27], a[144:147], v[28:31]
  ds_write_b128 v87, v[52:55] offset:2048
  v_mfma_f32_16x16x32_bf16 v[32:35], a[28:31], a[144:147], v[32:35]
  buffer_load_dwordx4 v[184:187], v1, s[8:11], s77 offen offset:2048 sc1
  v_mfma_f32_16x16x32_bf16 v[36:39], a[32:35], a[144:147], v[36:39]
  ds_write_b128 v87, v[56:59] offset:3072
  v_mfma_f32_16x16x32_bf16 v[40:43], a[36:39], a[144:147], v[40:43]
  s_waitcnt vmcnt(22)
  v_mfma_f32_16x16x32_bf16 v[24:27], a[40:43], a[148:151], v[24:27]
  buffer_load_dwordx4 v[188:191], v1, s[8:11], s77 offen offset:3072 sc1
  v_mfma_f32_16x16x32_bf16 v[28:31], a[44:47], a[148:151], v[28:31]
  ds_write_b128 v87, v[60:63] offset:4096
  v_mfma_f32_16x16x32_bf16 v[32:35], a[48:51], a[148:151], v[32:35]
  v_mfma_f32_16x16x32_bf16 v[36:39], a[52:55], a[148:151], v[36:39]
  s_add_u32 s77, s56, 40960
  buffer_load_dwordx4 v[112:115], v1, s[8:11], s77 offen offset:0 sc1
  v_mfma_f32_16x16x32_bf16 v[40:43], a[56:59], a[148:151], v[40:43]
  s_waitcnt vmcnt(23)
  v_mfma_f32_16x16x32_bf16 v[24:27], a[60:63], a[152:155], v[24:27]
  v_mfma_f32_16x16x32_bf16 v[28:31], a[64:67], a[152:155], v[28:31]
  buffer_load_dwordx4 v[116:119], v1, s[8:11], s77 offen offset:1024 sc1
  v_mfma_f32_16x16x32_bf16 v[32:35], a[68:71], a[152:155], v[32:35]
  v_mfma_f32_16x16x32_bf16 v[36:39], a[72:75], a[152:155], v[36:39]
  v_mfma_f32_16x16x32_bf16 v[40:43], a[76:79], a[152:155], v[40:43]
  buffer_load_dwordx4 v[120:123], v1, s[8:11], s77 offen offset:2048 sc1
  s_waitcnt vmcnt(24)
  v_mfma_f32_16x16x32_bf16 v[24:27], a[80:83], a[156:159], v[24:27]
  v_mfma_f32_16x16x32_bf16 v[28:31], a[84:87], a[156:159], v[28:31]
  v_mfma_f32_16x16x32_bf16 v[32:35], a[88:91], a[156:159], v[32:35]
  buffer_load_dwordx4 v[124:127], v1, s[8:11], s77 offen offset:3072 sc1
  v_mfma_f32_16x16x32_bf16 v[36:39], a[92:95], a[156:159], v[36:39]
  v_mfma_f32_16x16x32_bf16 v[40:43], a[96:99], a[156:159], v[40:43]
  s_waitcnt vmcnt(24)
  v_mfma_f32_16x16x32_bf16 v[44:47], a[0:3], a[160:163], 0
  s_add_u32 s77, s56, 45056
  buffer_load_dwordx4 v[128:131], v1, s[8:11], s77 offen offset:0 sc1
  v_mfma_f32_16x16x32_bf16 v[48:51], a[4:7], a[160:163], 0
  v_mfma_f32_16x16x32_bf16 v[52:55], a[8:11], a[160:163], 0
  ds_write_b128 v88, v[24:27] offset:0
  v_mfma_f32_16x16x32_bf16 v[56:59], a[12:15], a[160:163], 0
  buffer_load_dwordx4 v[132:135], v4, s[8:11], s77 offen offset:1024 sc1
  v_mfma_f32_16x16x32_bf16 v[60:63], a[16:19], a[160:163], 0
  ds_write_b128 v88, v[28:31] offset:1024
  s_waitcnt vmcnt(25)
  v_mfma_f32_16x16x32_bf16 v[44:47], a[20:23], a[164:167], v[44:47]
  v_mfma_f32_16x16x32_bf16 v[48:51], a[24:27], a[164:167], v[48:51]
  buffer_load_dwordx4 v[136:139], v4, s[8:11], s77 offen offset:2048 sc1
  v_mfma_f32_16x16x32_bf16 v[52:55], a[28:31], a[164:167], v[52:55]
  ds_write_b128 v88, v[32:35] offset:2048
  v_mfma_f32_16x16x32_bf16 v[56:59], a[32:35], a[164:167], v[56:59]
  ds_write_b128 v88, v[36:39] offset:3072
  v_mfma_f32_16x16x32_bf16 v[60:63], a[36:39], a[164:167], v[60:63]
  buffer_load_dwordx4 v[140:143], v4, s[8:11], s77 offen offset:3072 sc1
  s_waitcnt vmcnt(26)
  v_mfma_f32_16x16x32_bf16 v[44:47], a[40:43], a[168:171], v[44:47]
  ds_write_b128 v88, v[40:43] offset:4096
  v_mfma_f32_16x16x32_bf16 v[48:51], a[44:47], a[168:171], v[48:51]
  v_mfma_f32_16x16x32_bf16 v[52:55], a[48:51], a[168:171], v[52:55]
  s_add_u32 s77, s56, 49152
  buffer_load_dwordx4 v[144:147], v4, s[8:11], s77 offen offset:0 sc1
  v_mfma_f32_16x16x32_bf16 v[56:59], a[52:55], a[168:171], v[56:59]
  v_mfma_f32_16x16x32_bf16 v[60:63], a[56:59], a[168:171], v[60:63]
  s_waitcnt vmcnt(26)
  v_mfma_f32_16x16x32_bf16 v[44:47], a[60:63], a[172:175], v[44:47]
  buffer_load_dwordx4 v[148:151], v4, s[8:11], s77 offen offset:1024 sc1
  v_mfma_f32_16x16x32_bf16 v[48:51], a[64:67], a[172:175], v[48:51]
  v_mfma_f32_16x16x32_bf16 v[52:55], a[68:71], a[172:175], v[52:55]
  v_mfma_f32_16x16x32_bf16 v[56:59], a[72:75], a[172:175], v[56:59]
  buffer_load_dwordx4 v[152:155], v1, s[8:11], s77 offen offset:2048 sc1
  v_mfma_f32_16x16x32_bf16 v[60:63], a[76:79], a[172:175], v[60:63]
  s_waitcnt lgkmcnt(0)
  s_barrier
  s_waitcnt vmcnt(27)
  v_mfma_f32_16x16x32_bf16 v[44:47], a[80:83], a[176:179], v[44:47]
  ds_read_b128 v[24:27], v89 offset:0
  ds_read_b128 v[28:31], v89 offset:1024
  v_mfma_f32_16x16x32_bf16 v[48:51], a[84:87], a[176:179], v[48:51]
  buffer_load_dwordx4 v[156:159], v1, s[8:11], s77 offen offset:3072 sc1
  v_mfma_f32_16x16x32_bf16 v[52:55], a[88:91], a[176:179], v[52:55]
  ds_read_b128 v[32:35], v89 offset:2048
  ds_read_b128 v[36:39], v89 offset:3072
  v_mfma_f32_16x16x32_bf16 v[56:59], a[92:95], a[176:179], v[56:59]
  ds_read_b128 v[40:43], v89 offset:4096
  ds_read_b128 v[92:95], v89 offset:5120
  v_mfma_f32_16x16x32_bf16 v[60:63], a[96:99], a[176:179], v[60:63]
  ds_read_b128 v[96:99], v89 offset:6144
  ds_read_b128 v[100:103], v89 offset:7168
  ds_read_b128 v[104:107], v89 offset:8192
  ds_read_b128 v[108:111], v89 offset:9216
  s_waitcnt lgkmcnt(9)
  v_pk_add_f32 v[64:65], v[64:65], v[24:25]
  v_pk_add_f32 v[66:67], v[66:67], v[26:27]
  s_waitcnt lgkmcnt(8)
  v_pk_add_f32 v[68:69], v[68:69], v[28:29]
  v_pk_add_f32 v[70:71], v[70:71], v[30:31]
  s_waitcnt lgkmcnt(7)
  v_pk_add_f32 v[72:73], v[72:73], v[32:33]
  v_pk_add_f32 v[74:75], v[74:75], v[34:35]
  s_waitcnt lgkmcnt(6)
  v_pk_add_f32 v[76:77], v[76:77], v[36:37]
  v_pk_add_f32 v[78:79], v[78:79], v[38:39]
  s_waitcnt lgkmcnt(5)
  v_pk_add_f32 v[80:81], v[80:81], v[40:41]
  v_pk_add_f32 v[82:83], v[82:83], v[42:43]
  ds_read_b128 v[24:27], v89 offset:10240
  ds_read_b128 v[28:31], v89 offset:11264
  ds_read_b128 v[32:35], v89 offset:12288
  ds_read_b128 v[36:39], v89 offset:13312
  ds_read_b128 v[40:43], v89 offset:14336
  s_waitcnt lgkmcnt(9)
  v_pk_add_f32 v[64:65], v[64:65], v[92:93]
  v_pk_add_f32 v[66:67], v[66:67], v[94:95]
  s_waitcnt lgkmcnt(8)
  v_pk_add_f32 v[68:69], v[68:69], v[96:97]
  v_pk_add_f32 v[70:71], v[70:71], v[98:99]
  s_waitcnt lgkmcnt(7)
  v_pk_add_f32 v[72:73], v[72:73], v[100:101]
  v_pk_add_f32 v[74:75], v[74:75], v[102:103]
  s_waitcnt lgkmcnt(6)
  v_pk_add_f32 v[76:77], v[76:77], v[104:105]
  v_pk_add_f32 v[78:79], v[78:79], v[106:107]
  s_waitcnt lgkmcnt(5)
  v_pk_add_f32 v[80:81], v[80:81], v[108:109]
  v_pk_add_f32 v[82:83], v[82:83], v[110:111]
  s_waitcnt lgkmcnt(4)
  v_pk_add_f32 v[64:65], v[64:65], v[24:25]
  v_pk_add_f32 v[66:67], v[66:67], v[26:27]
  s_waitcnt lgkmcnt(3)
  v_pk_add_f32 v[68:69], v[68:69], v[28:29]
  v_pk_add_f32 v[70:71], v[70:71], v[30:31]
  s_waitcnt lgkmcnt(2)
  v_pk_add_f32 v[72:73], v[72:73], v[32:33]
  v_pk_add_f32 v[74:75], v[74:75], v[34:35]
  s_waitcnt lgkmcnt(1)
  v_pk_add_f32 v[76:77], v[76:77], v[36:37]
  v_pk_add_f32 v[78:79], v[78:79], v[38:39]
  s_waitcnt lgkmcnt(0)
  v_pk_add_f32 v[80:81], v[80:81], v[40:41]
  v_pk_add_f32 v[82:83], v[82:83], v[42:43]
  v_pk_add_f32 v[64:65], v[64:65], v[44:45]
  v_pk_add_f32 v[66:67], v[66:67], v[46:47]
  v_pk_add_f32 v[68:69], v[68:69], v[48:49]
  v_pk_add_f32 v[70:71], v[70:71], v[50:51]
  v_pk_add_f32 v[72:73], v[72:73], v[52:53]
  v_pk_add_f32 v[74:75], v[74:75], v[54:55]
  v_pk_add_f32 v[76:77], v[76:77], v[56:57]
  v_pk_add_f32 v[78:79], v[78:79], v[58:59]
  v_pk_add_f32 v[80:81], v[80:81], v[60:61]
  v_pk_add_f32 v[82:83], v[82:83], v[62:63]
  v_cvt_pk_bf16_f32 v10, v64, v65
  v_cvt_pk_bf16_f32 v11, v66, v67
  v_cvt_pk_bf16_f32 v12, v68, v69
  v_cvt_pk_bf16_f32 v13, v70, v71
  v_cvt_pk_bf16_f32 v14, v72, v73
  v_cvt_pk_bf16_f32 v15, v74, v75
  v_cvt_pk_bf16_f32 v16, v76, v77
  v_cvt_pk_bf16_f32 v17, v78, v79
  v_cvt_pk_bf16_f32 v18, v80, v81
  v_cvt_pk_bf16_f32 v19, v82, v83
  v_mov_b32 v24, v10
  v_mov_b32 v25, v11
  v_mov_b32 v26, v12
  v_mov_b32 v27, v13
  v_mov_b32 v28, v14
  v_mov_b32 v29, v15
  v_mov_b32 v30, v16
  v_mov_b32 v31, v17
  v_permlane32_swap_b32 v24, v26
  v_permlane32_swap_b32 v25, v27
  v_permlane32_swap_b32 v28, v30
  v_permlane32_swap_b32 v29, v31
  s_add_u32 s3, s58, 0
  s_cmp_lg_u32 s16, 0
  s_cbranch_scc1 HS1
  buffer_store_dwordx4 v[24:27], v7, s[8:11], s3 offen
  buffer_store_dwordx4 v[28:31], v7, s[8:11], s3 offen offset:2048
  s_addk_i32 s3, 4096
  buffer_store_dwordx2 v[18:19], v6, s[8:11], s3 offen
HB1:
  s_mov_b32 s3, 0x3f803f80
  v_mov_b32 v92, 0
  v_mov_b32 v93, 0
  v_add_u32 v20, 1, v20
  v_dot2_f32_bf16 v92, v10, s3, v92
  v_dot2_f32_bf16 v93, v10, v10, v93
  v_dot2_f32_bf16 v92, v11, s3, v92
  v_dot2_f32_bf16 v93, v11, v11, v93
  v_dot2_f32_bf16 v92, v12, s3, v92
  v_dot2_f32_bf16 v93, v12, v12, v93
  v_dot2_f32_bf16 v92, v13, s3, v92
  v_dot2_f32_bf16 v93, v13, v13, v93
  v_dot2_f32_bf16 v92, v14, s3, v92
  v_dot2_f32_bf16 v93, v14, v14, v93
  v_dot2_f32_bf16 v92, v15, s3, v92
  v_dot2_f32_bf16 v93, v15, v15, v93
  v_dot2_f32_bf16 v92, v16, s3, v92
  v_dot2_f32_bf16 v93, v16, v16, v93
  v_dot2_f32_bf16 v92, v17, s3, v92
  v_dot2_f32_bf16 v93, v17, v17, v93
  v_dot2_f32_bf16 v92, v18, s3, v92
  v_dot2_f32_bf16 v93, v18, v18, v93
  v_dot2_f32_bf16 v92, v19, s3, v92
  v_dot2_f32_bf16 v93, v19, v19, v93
  v_mov_b32 v94, v20
  v_mov_b32 v95, v20
  v_mov_b32 v90, v92
  v_mov_b32 v91, v93
  s_nop 0
  v_permlane16_swap_b32 v92, v90
  v_permlane16_swap_b32 v93, v91
  v_add_f32 v92, v92, v90
  v_add_f32 v93, v93, v91
  v_mov_b32 v90, v92
  v_mov_b32 v91, v93
  s_nop 0
  v_permlane32_swap_b32 v92, v90
  v_permlane32_swap_b32 v93, v91
  v_add_f32 v92, v92, v90
  v_add_f32 v93, v93, v91
  s_add_u32 s3, s59, 2621440
  s_waitcnt vmcnt(0)
  s_mov_b64 exec, 0xffff
  s_cmp_lg_u32 s16, 0
  s_cbranch_scc1 HS2
  buffer_store_dwordx4 v[92:95], v1, s[8:11], s3 offen
HB2:
  s_mov_b64 exec, -1
  s_barrier
  s_add_u32 s70, s37, 2621440
  buffer_load_dwordx4 v[24:27], v8, s[8:11], s70 offen offset:0 sc1
  buffer_load_dwordx4 v[28:31], v8, s[8:11], s70 offen offset:512 sc1
  buffer_load_dwordx4 v[32:35], v8, s[8:11], s70 offen offset:1024 sc1
  buffer_load_dwordx4 v[36:39], v8, s[8:11], s70 offen offset:1536 sc1
  s_waitcnt vmcnt(1)
  v_max3_u32 v40, v26, v30, v34
  v_min3_u32 v41, v26, v30, v34
  s_waitcnt vmcnt(0)
  v_max_u32 v40, v40, v38
  v_min_u32 v41, v41, v38
  v_cmp_ne_u32 vcc, v20, v40
  v_cmp_ne_u32 s[64:65], v20, v41
  s_nop 3
  s_or_b64 vcc, vcc, s[64:65]
  s_cbranch_vccnz PXM_SPIN
PXM_OK:
  s_add_u32 s71, s36, 0
  buffer_load_dwordx4 a[0:3], v1, s[8:11], s71 offen offset:0 sc1
  buffer_load_dwordx4 a[4:7], v1, s[8:11], s71 offen offset:1024 sc1
  buffer_load_dwordx4 a[8:11], v1, s[8:11], s71 offen offset:2048 sc1
  buffer_load_dwordx4 a[12:15], v1, s[8:11], s71 offen offset:3072 sc1
  s_add_u32 s35, s71, 4096
  buffer_load_dwordx4 a[16:19], v1, s[8:11], s35 offen offset:0 sc1
  buffer_load_dwordx4 a[20:23], v1, s[8:11], s35 offen offset:1024 sc1
  buffer_load_dwordx4 a[24:27], v1, s[8:11], s35 offen offset:2048 sc1
  s_barrier
  ds_read_b128 a[160:163], v2 offset:0
  buffer_load_dwordx4 a[28:31], v1, s[8:11], s35 offen offset:3072 sc1
  ds_read_b128 a[164:167], v2 offset:1024
  ds_read_b128 a[168:171], v2 offset:2048
  ds_read_b128 a[172:175], v2 offset:3072
  s_add_u32 s35, s71, 8192
  buffer_load_dwordx4 a[32:35], v1, s[8:11], s35 offen offset:0 sc1
  ds_read_b128 a[176:179], v2 offset:4096
  ds_read_b128 a[180:183], v2 offset:5120
  ds_read_b128 a[184:187], v2 offset:6144
  buffer_load_dwordx4 a[36:39], v1, s[8:11], s35 offen offset:1024 sc1
  s_waitcnt vmcnt(9) lgkmcnt(4)
  v_mfma_f32_32x32x16_bf16 v[40:55], a[160:163], a[0:3], 0
  ds_read_b128 a[188:191], v2 offset:7168
  v_mfma_f32_32x32x16_bf16 v[56:71], a[164:167], a[0:3], 0
  ds_read_b128 a[160:163], v2 offset:8192
  v_mfma_f32_32x32x16_bf16 v[72:87], a[168:171], a[0:3], 0
  ds_read_b128 a[164:167], v2 offset:9216
  buffer_load_dwordx4 a[40:43], v1, s[8:11], s35 offen offset:2048 sc1
  s_waitcnt vmcnt(9) lgkmcnt(4)
  v_mfma_f32_32x32x16_bf16 v[40:55], a[172:175], a[4:7], v[40:55]
  ds_read_b128 a[168:171], v2 offset:10240
  v_mfma_f32_32x32x16_bf16 v[56:71], a[176:179], a[4:7], v[56:71]
  ds_read_b128 a[172:175], v2 offset:11264
  v_mfma_f32_32x32x16_bf16 v[72:87], a[180:183], a[4:7], v[72:87]
  ds_read_b128 a[176:179], v2 offset:12288
  buffer_load_dwordx4 a[44:47], v1, s[8:11], s35 offen offset:3072 sc1
  s_waitcnt vmcnt(9) lgkmcnt(4)
  v_mfma_f32_32x32x16_bf16 v[40:55], a[184:187], a[8:11], v[40:55]
  ds_read_b128 a[180:183], v2 offset:13312
  v_mfma_f32_32x32x16_bf16 v[56:71], a[188:191], a[8:11], v[56:71]
  ds_read_b128 a[184:187], v2 offset:14336
  v_mfma_f32_32x32x16_bf16 v[72:87], a[160:163], a[8:11], v[72:87]
  ds_read_b128 a[188:191], v2 offset:15360
  s_add_u32 s35, s71, 12288
  buffer_load_dwordx4 a[48:51], v1, s[8:11], s35 offen offset:0 sc1
  s_waitcnt vmcnt(9) lgkmcnt(4)
  v_mfma_f32_32x32x16_bf16 v[40:55], a[164:167], a[12:15], v[40:55]
  ds_read_b128 a[160:163], v2 offset:16384
  v_mfma_f32_32x32x16_bf16 v[56:71], a[168:171], a[12:15], v[56:71]
  ds_read_b128 a[164:167], v2 offset:17408
  s_add_u32 m0, s27, 4096
  s_add_u32 s34, s33, 102400
  buffer_load_dwordx4 v1, s[20:23], s34 offen offset:0 sc1 lds
  v_mfma_f32_32x32x16_bf16 v[72:87], a[172:175], a[12:15], v[72:87]
  ds_read_b128 a[168:171], v2 offset:18432
  buffer_load_dwordx4 a[52:55], v1, s[8:11], s35 offen offset:1024 sc1
  s_waitcnt vmcnt(10) lgkmcnt(4)
  v_mfma_f32_32x32x16_bf16 v[40:55], a[176:179], a[16:19], v[40:55]
  ds_read_b128 a[172:175], v2 offset:19456
  v_add_f32 v24, v24, v28
  v_add_f32 v25, v25, v29
  v_add_f32 v32, v32, v36
  v_add_f32 v33, v33, v37
  v_add_f32 v24, v24, v32
  v_mfma_f32_32x32x16_bf16 v[56:71], a[180:183], a[16:19], v[56:71]
  ds_read_b128 a[176:179], v2 offset:20480
  v_add_f32 v25, v25, v33
  v_mov_b32 v26, v24
  v_mov_b32 v27, v25
  s_nop 0
  v_permlane32_swap_b32 v24, v26
  v_permlane32_swap_b32 v25, v27
  v_mfma_f32_32x32x16_bf16 v[72:87], a[184:187], a[16:19], v[72:87]
  ds_read_b128 a[180:183], v2 offset:21504
  buffer_load_dwordx4 a[56:59], v1, s[8:11], s35 offen offset:2048 sc1
  v_add_f32 v24, v24, v26
  s_waitcnt vmcnt(10) lgkmcnt(4)
  v_mfma_f32_32x32x16_bf16 v[40:55], a[188:191], a[20:23], v[40:55]
  ds_read_b128 a[184:187], v2 offset:22528
  buffer_load_dwordx4 v1, s[20:23], s34 offen offset:1024 sc1 lds
  v_add_f32 v25, v25, v27
  v_mul_f32 v24, 0xbacccccd, v24
  v_mfma_f32_32x32x16_bf16 v[56:71], a[160:163], a[20:23], v[56:71]
  ds_read_b128 a[188:191], v2 offset:23552
  v_mul_f32 v25, 0x3acccccd, v25
  v_cvt_pk_bf16_f32 v104, v24, v24
  v_fma_f32 v25, -v24, v24, v25
  v_cvt_pk_bf16_f32 v105, v24, v24
  v_max_f32 v25, 0, v25
  v_mfma_f32_32x32x16_bf16 v[72:87], a[164:167], a[20:23], v[72:87]
  ds_read_b128 a[160:163], v2 offset:24576
  buffer_load_dwordx4 a[60:63], v1, s[8:11], s35 offen offset:3072 sc1
  v_cvt_pk_bf16_f32 v106, v24, v24
  s_waitcnt vmcnt(11) lgkmcnt(4)
  v_mfma_f32_32x32x16_bf16 v[40:55], a[168:171], a[24:27], v[40:55]
  ds_read_b128 a[164:167], v2 offset:25600
  buffer_load_dwordx4 v1, s[20:23], s34 offen offset:2048 sc1 lds
  v_add_f32 v108, 0x3727c5ac, v25
  v_cvt_pk_bf16_f32 v107, v24, v24
  v_mfma_f32_32x32x16_bf16 v[56:71], a[172:175], a[24:27], v[56:71]
  ds_read_b128 a[168:171], v2 offset:26624
  v_rsq_f32 v110, v108
  s_nop 0
  v_mul_f32 v111, 0xc0135761, v110
  v_mul_f32 v110, v110, v110
  v_mfma_f32_32x32x16_bf16 v[72:87], a[176:179], a[24:27], v[72:87]
  ds_read_b128 a[172:175], v2 offset:27648
  s_add_u32 s35, s71, 16384
  buffer_load_dwordx4 a[64:67], v1, s[8:11], s35 offen offset:0 sc1
  s_waitcnt vmcnt(12) lgkmcnt(4)
  v_mfma_f32_32x32x16_bf16 v[40:55], a[180:183], a[28:31], v[40:55]
  ds_read_b128 a[176:179], v2 offset:28672
  v_mul_f32 v110, 0x3d372713, v110
  v_mul_f32 v110, v111, v110
  v_mfma_f32_32x32x16_bf16 v[56:71], a[184:187], a[28:31], v[56:71]
  ds_read_b128 a[180:183], v2 offset:29696
  buffer_load_dwordx4 v1, s[20:23], s34 offen offset:3072 sc1 lds
  v_mfma_f32_32x32x16_bf16 v[72:87], a[188:191], a[28:31], v[72:87]
  ds_read_b128 a[184:187], v2 offset:30720
  buffer_load_dwordx4 a[68:71], v1, s[8:11], s35 offen offset:1024 sc1
  s_waitcnt vmcnt(13) lgkmcnt(4)
  v_mfma_f32_32x32x16_bf16 v[40:55], a[160:163], a[32:35], v[40:55]
  ds_read_b128 a[188:191], v2 offset:31744
  v_mfma_f32_32x32x16_bf16 v[56:71], a[164:167], a[32:35], v[56:71]
  ds_read_b128 a[160:163], v2 offset:32768
  v_mfma_f32_32x32x16_bf16 v[72:87], a[168:171], a[32:35], v[72:87]
  ds_read_b128 a[164:167], v2 offset:33792
  buffer_load_dwordx4 a[72:75], v1, s[8:11], s35 offen offset:2048 sc1
  s_waitcnt vmcnt(13) lgkmcnt(4)
  v_mfma_f32_32x32x16_bf16 v[40:55], a[172:175], a[36:39], v[40:55]
  ds_read_b128 a[168:171], v2 offset:34816
  s_add_u32 m0, s27, 8192
  s_add_u32 s34, s33, 106496
  buffer_load_dwordx4 v1, s[20:23], s34 offen offset:0 sc1 lds
  v_mfma_f32_32x32x16_bf16 v[56:71], a[176:179], a[36:39], v[56:71]
  ds_read_b128 a[172:175], v2 offset:35840
  v_mfma_f32_32x32x16_bf16 v[72:87], a[180:183], a[36:39], v[72:87]
  ds_read_b128 a[176:179], v2 offset:36864
  buffer_load_dwordx4 a[76:79], v1, s[8:11], s35 offen offset:3072 sc1
  s_waitcnt vmcnt(14) lgkmcnt(4)
  v_mfma_f32_32x32x16_bf16 v[40:55], a[184:187], a[40:43], v[40:55]
  ds_read_b128 a[180:183], v2 offset:37888
  buffer_load_dwordx4 v1, s[20:23], s34 offen offset:1024 sc1 lds
  v_mfma_f32_32x32x16_bf16 v[56:71], a[188:191], a[40:43], v[56:71]
  ds_read_b128 a[184:187], v2 offset:38912
  v_mfma_f32_32x32x16_bf16 v[72:87], a[160:163], a[40:43], v[72:87]
  ds_read_b128 a[188:191], v2 offset:39936
  s_add_u32 s35, s71, 20480
  buffer_load_dwordx4 a[80:83], v1, s[8:11], s35 offen offset:0 sc1
  s_waitcnt vmcnt(15) lgkmcnt(4)
  v_mfma_f32_32x32x16_bf16 v[40:55], a[164:167], a[44:47], v[40:55]
  ds_read_b128 a[160:163], v2 offset:40960
  v_mfma_f32_32x32x16_bf16 v[56:71], a[168:171], a[44:47], v[56:71]
  ds_read_b128 a[164:167], v2 offset:41984
  buffer_load_dwordx4 v1, s[20:23], s34 offen offset:2048 sc1 lds
  v_mfma_f32_32x32x16_bf16 v[72:87], a[172:175], a[44:47], v[72:87]
  ds_read_b128 a[168:171], v2 offset:43008
  buffer_load_dwordx4 a[84:87], v1, s[8:11], s35 offen offset:1024 sc1
  s_waitcnt vmcnt(16) lgkmcnt(4)
  v_mfma_f32_32x32x16_bf16 v[40:55], a[176:179], a[48:51], v[40:55]
  ds_read_b128 a[172:175], v2 offset:44032
  v_mfma_f32_32x32x16_bf16 v[56:71], a[180:183], a[48:51], v[56:71]
  ds_read_b128 a[176:179], v2 offset:45056
  v_mfma_f32_32x32x16_bf16 v[72:87], a[184:187], a[48:51], v[72:87]
  ds_read_b128 a[180:183], v2 offset:46080
  buffer_load_dwordx4 a[88:91], v1, s[8:11], s35 offen offset:2048 sc1
  s_waitcnt vmcnt(15) lgkmcnt(4)
  v_mfma_f32_32x32x16_bf16 v[40:55], a[188:191], a[52:55], v[40:55]
  ds_read_b128 a[184:187], v2 offset:47104
  buffer_load_dwordx4 v1, s[20:23], s34 offen offset:3072 sc1 lds
  v_mfma_f32_32x32x16_bf16 v[56:71], a[160:163], a[52:55], v[56:71]
  ds_read_b128 a[188:191], v2 offset:48128
  v_mfma_f32_32x32x16_bf16 v[72:87], a[164:167], a[52:55], v[72:87]
  ds_read_b128 a[160:163], v2 offset:49152
  buffer_load_dwordx4 a[92:95], v1, s[8:11], s35 offen offset:3072 sc1
  s_waitcnt vmcnt(16) lgkmcnt(4)
  v_mfma_f32_32x32x16_bf16 v[40:55], a[168:171], a[56:59], v[40:55]
  ds_read_b128 a[164:167], v2 offset:50176
  s_add_u32 m0, s26, 36864
  s_add_u32 s34, s32, 135168
  buffer_load_dwordx4 v1, s[20:23], s34 offen offset:0 sc1 lds
  v_mfma_f32_32x32x16_bf16 v[56:71], a[172:175], a[56:59], v[56:71]
  ds_read_b128 a[168:171], v2 offset:51200
  v_mfma_f32_32x32x16_bf16 v[72:87], a[176:179], a[56:59], v[72:87]
  ds_read_b128 a[172:175], v2 offset:52224
  s_add_u32 s35, s71, 24576
  buffer_load_dwordx4 a[96:99], v1, s[8:11], s35 offen offset:0 sc1
  s_waitcnt vmcnt(16) lgkmcnt(4)
  v_mfma_f32_32x32x16_bf16 v[40:55], a[180:183], a[60:63], v[40:55]
  ds_read_b128 a[176:179], v2 offset:53248
  v_mfma_f32_32x32x16_bf16 v[56:71], a[184:187], a[60:63], v[56:71]
  ds_read_b128 a[180:183], v2 offset:54272
  buffer_load_dwordx4 v1, s[20:23], s34 offen offset:1024 sc1 lds
  v_mfma_f32_32x32x16_bf16 v[72:87], a[188:191], a[60:63], v[72:87]
  ds_read_b128 a[184:187], v2 offset:55296
  buffer_load_dwordx4 a[100:103], v1, s[8:11], s35 offen offset:1024 sc1
  s_waitcnt vmcnt(16) lgkmcnt(4)
  v_mfma_f32_32x32x16_bf16 v[40:55], a[160:163], a[64:67], v[40:55]
  ds_read_b128 a[188:191], v2 offset:56320
  v_mfma_f32_32x32x16_bf16 v[56:71], a[164:167], a[64:67], v[56:71]
  ds_read_b128 a[160:163], v2 offset:57344
  v_mfma_f32_32x32x16_bf16 v[72:87], a[168:171], a[64:67], v[72:87]
  ds_read_b128 a[164:167], v2 offset:58368
  buffer_load_dwordx4 a[104:107], v1, s[8:11], s35 offen offset:2048 sc1
  s_waitcnt vmcnt(15) lgkmcnt(4)
  v_mfma_f32_32x32x16_bf16 v[40:55], a[172:175], a[68:71], v[40:55]
  ds_read_b128 a[168:171], v2 offset:59392
  buffer_load_dwordx4 v1, s[20:23], s34 offen offset:2048 sc1 lds
  v_mfma_f32_32x32x16_bf16 v[56:71], a[176:179], a[68:71], v[56:71]
  ds_read_b128 a[172:175], v2 offset:60416
  v_mfma_f32_32x32x16_bf16 v[72:87], a[180:183], a[68:71], v[72:87]
  ds_read_b128 a[176:179], v2 offset:61440
  buffer_load_dwordx4 a[108:111], v1, s[8:11], s35 offen offset:3072 sc1
  s_waitcnt vmcnt(16) lgkmcnt(4)
  v_mfma_f32_32x32x16_bf16 v[40:55], a[184:187], a[72:75], v[40:55]
  ds_read_b128 a[180:183], v2 offset:62464
  buffer_load_dwordx4 v1, s[20:23], s34 offen offset:3072 sc1 lds
  v_mfma_f32_32x32x16_bf16 v[56:71], a[188:191], a[72:75], v[56:71]
  ds_read_b128 a[184:187], v2 offset:63488
  v_mfma_f32_32x32x16_bf16 v[72:87], a[160:163], a[72:75], v[72:87]
  ds_read_b128 a[188:191], v2 offset:64512
  s_add_u32 s35, s71, 28672
  buffer_load_dwordx4 a[112:115], v1, s[8:11], s35 offen offset:0 sc1
  s_waitcnt vmcnt(16) lgkmcnt(4)
  v_mfma_f32_32x32x16_bf16 v[40:55], a[164:167], a[76:79], v[40:55]
  ds_read_b128 a[160:163], v3 offset:0
  v_mfma_f32_32x32x16_bf16 v[56:71], a[168:171], a[76:79], v[56:71]
  ds_read_b128 a[164:167], v3 offset:1024
  s_add_u32 m0, s26, 40960
  s_add_u32 s34, s32, 139264
  buffer_load_dwordx4 v1, s[20:23], s34 offen offset:0 sc1 lds
  v_mfma_f32_32x32x16_bf16 v[72:87], a[172:175], a[76:79], v[72:87]
  ds_read_b128 a[168:171], v3 offset:2048
  buffer_load_dwordx4 a[116:119], v1, s[8:11], s35 offen offset:1024 sc1
  s_waitcnt vmcnt(16) lgkmcnt(4)
  v_mfma_f32_32x32x16_bf16 v[40:55], a[176:179], a[80:83], v[40:55]
  ds_read_b128 a[172:175], v3 offset:3072
  v_mfma_f32_32x32x16_bf16 v[56:71], a[180:183], a[80:83], v[56:71]
  ds_read_b128 a[176:179], v3 offset:4096
  v_mfma_f32_32x32x16_bf16 v[72:87], a[184:187], a[80:83], v[72:87]
  ds_read_b128 a[180:183], v3 offset:5120
  buffer_load_dwordx4 a[120:123], v1, s[8:11], s35 offen offset:2048 sc1
  s_waitcnt vmcnt(15) lgkmcnt(4)
  v_mfma_f32_32x32x16_bf16 v[40:55], a[188:191], a[84:87], v[40:55]
  ds_read_b128 a[184:187], v3 offset:6144
  buffer_load_dwordx4 v1, s[20:23], s34 offen offset:1024 sc1 lds
  v_mfma_f32_32x32x16_bf16 v[56:71], a[160:163], a[84:87], v[56:71]
  ds_read_b128 a[188:191], v3 offset:7168
  v_mfma_f32_32x32x16_bf16 v[72:87], a[164:167], a[84:87], v[72:87]
  ds_read_b128 a[160:163], v3 offset:8192
  buffer_load_dwordx4 a[124:127], v1, s[8:11], s35 offen offset:3072 sc1
  s_waitcnt vmcnt(16) lgkmcnt(4)
  v_mfma_f32_32x32x16_bf16 v[40:55], a[168:171], a[88:91], v[40:55]
  ds_read_b128 a[164:167], v3 offset:9216
  buffer_load_dwordx4 v1, s[20:23], s34 offen offset:2048 sc1 lds
  v_mfma_f32_32x32x16_bf16 v[56:71], a[172:175], a[88:91], v[56:71]
  ds_read_b128 a[168:171], v3 offset:10240
  v_mfma_f32_32x32x16_bf16 v[72:87], a[176:179], a[88:91], v[72:87]
  ds_read_b128 a[172:175], v3 offset:11264
  s_add_u32 s35, s71, 32768
  buffer_load_dwordx4 a[128:131], v1, s[8:11], s35 offen offset:0 sc1
  s_waitcnt vmcnt(16) lgkmcnt(4)
  v_mfma_f32_32x32x16_bf16 v[40:55], a[180:183], a[92:95], v[40:55]
  ds_read_b128 a[176:179], v3 offset:12288
  v_mfma_f32_32x32x16_bf16 v[56:71], a[184:187], a[92:95], v[56:71]
  ds_read_b128 a[180:183], v3 offset:13312
  v_mfma_f32_32x32x16_bf16 v[72:87], a[188:191], a[92:95], v[72:87]
  ds_read_b128 a[184:187], v3 offset:14336
  buffer_load_dwordx4 a[132:135], v1, s[8:11], s35 offen offset:1024 sc1
  s_waitcnt vmcnt(15) lgkmcnt(4)
  v_mfma_f32_32x32x16_bf16 v[40:55], a[160:163], a[96:99], v[40:55]
  ds_read_b128 a[188:191], v3 offset:15360
  v_mfma_f32_32x32x16_bf16 v[56:71], a[164:167], a[96:99], v[56:71]
  ds_read_b128 a[160:163], v3 offset:16384
  v_mfma_f32_32x32x16_bf16 v[72:87], a[168:171], a[96:99], v[72:87]
  ds_read_b128 a[164:167], v3 offset:17408
  buffer_load_dwordx4 a[136:139], v1, s[8:11], s35 offen offset:2048 sc1
  s_waitcnt vmcnt(14) lgkmcnt(4)
  v_mfma_f32_32x32x16_bf16 v[40:55], a[172:175], a[100:103], v[40:55]
  ds_read_b128 a[168:171], v3 offset:18432
  v_mfma_f32_32x32x16_bf16 v[56:71], a[176:179], a[100:103], v[56:71]
  ds_read_b128 a[172:175], v3 offset:19456
  v_mfma_f32_32x32x16_bf16 v[72:87], a[180:183], a[100:103], v[72:87]
  ds_read_b128 a[176:179], v3 offset:20480
  buffer_load_dwordx4 a[140:143], v1, s[8:11], s35 offen offset:3072 sc1
  s_waitcnt vmcnt(14) lgkmcnt(4)
  v_mfma_f32_32x32x16_bf16 v[40:55], a[184:187], a[104:107], v[40:55]
  ds_read_b128 a[180:183], v3 offset:21504
  v_mfma_f32_32x32x16_bf16 v[56:71], a[188:191], a[104:107], v[56:71]
  ds_read_b128 a[184:187], v3 offset:22528
  v_mfma_f32_32x32x16_bf16 v[72:87], a[160:163], a[104:107], v[72:87]
  ds_read_b128 a[188:191], v3 offset:23552
  s_add_u32 s35, s71, 36864
  buffer_load_dwordx4 a[144:147], v1, s[8:11], s35 offen offset:0 sc1
  s_waitcnt vmcnt(13) lgkmcnt(4)
  v_mfma_f32_32x32x16_bf16 v[40:55], a[164:167], a[108:111], v[40:55]
  ds_read_b128 a[160:163], v3 offset:24576
  v_mfma_f32_32x32x16_bf16 v[56:71], a[168:171], a[108:111], v[56:71]
  ds_read_b128 a[164:167], v3 offset:25600
  v_mfma_f32_32x32x16_bf16 v[72:87], a[172:175], a[108:111], v[72:87]
  ds_read_b128 a[168:171], v3 offset:26624
  buffer_load_dwordx4 a[148:151], v1, s[8:11], s35 offen offset:1024 sc1
  s_waitcnt vmcnt(12) lgkmcnt(4)
  v_mfma_f32_32x32x16_bf16 v[40:55], a[176:179], a[112:115], v[40:55]
  ds_read_b128 a[172:175], v3 offset:27648
  v_mfma_f32_32x32x16_bf16 v[56:71], a[180:183], a[112:115], v[56:71]
  ds_read_b128 a[176:179], v3 offset:28672
  v_mfma_f32_32x32x16_bf16 v[72:87], a[184:187], a[112:115], v[72:87]
  ds_read_b128 a[180:183], v3 offset:29696
  buffer_load_dwordx4 a[152:155], v1, s[8:11], s35 offen offset:2048 sc1
  s_waitcnt vmcnt(11) lgkmcnt(4)
  v_mfma_f32_32x32x16_bf16 v[40:55], a[188:191], a[116:119], v[40:55]
  ds_read_b128 a[184:187], v3 offset:30720
  v_mfma_f32_32x32x16_bf16 v[56:71], a[160:163], a[116:119], v[56:71]
  ds_read_b128 a[188:191], v3 offset:31744
  v_mfma_f32_32x32x16_bf16 v[72:87], a[164:167], a[116:119], v[72:87]
  ds_read_b128 a[160:163], v1 offset:0
  buffer_load_dwordx4 a[156:159], v1, s[8:11], s35 offen offset:3072 sc1
  s_waitcnt vmcnt(11) lgkmcnt(4)
  v_mfma_f32_32x32x16_bf16 v[40:55], a[168:171], a[120:123], v[40:55]
  ds_read_b128 a[164:167], v1 offset:1024
  v_mfma_f32_32x32x16_bf16 v[56:71], a[172:175], a[120:123], v[56:71]
  ds_read_b128 a[168:171], v1 offset:2048
  v_mfma_f32_32x32x16_bf16 v[72:87], a[176:179], a[120:123], v[72:87]
  ds_read_b128 a[172:175], v1 offset:3072
  s_waitcnt vmcnt(8)
  s_barrier
  s_waitcnt lgkmcnt(4)
  v_mfma_f32_32x32x16_bf16 v[40:55], a[180:183], a[124:127], v[40:55]
  ds_read_b128 a[176:179], v1 offset:4096
  s_add_u32 m0, s27, 65536
  s_add_u32 s34, s33, 163840
  buffer_load_dwordx4 v1, s[20:23], s34 offen offset:0 sc1 lds
  v_mfma_f32_32x32x16_bf16 v[56:71], a[184:187], a[124:127], v[56:71]
  ds_read_b128 a[180:183], v1 offset:5120
  buffer_load_dwordx4 v1, s[20:23], s34 offen offset:1024 sc1 lds
  v_mfma_f32_32x32x16_bf16 v[72:87], a[188:191], a[124:127], v[72:87]
  ds_read_b128 a[184:187], v1 offset:6144
  buffer_load_dwordx4 v1, s[20:23], s34 offen offset:2048 sc1 lds
  s_waitcnt vmcnt(10) lgkmcnt(4)
  v_mfma_f32_32x32x16_bf16 v[40:55], a[160:163], a[128:131], v[40:55]
  ds_read_b128 a[188:191], v1 offset:7168
  buffer_load_dwordx4 v1, s[20:23], s34 offen offset:3072 sc1 lds
  v_mfma_f32_32x32x16_bf16 v[56:71], a[164:167], a[128:131], v[56:71]
  ds_read_b128 a[160:163], v1 offset:8192
  v_mfma_f32_32x32x16_bf16 v[72:87], a[168:171], a[128:131], v[72:87]
  ds_read_b128 a[164:167], v1 offset:9216
  s_waitcnt vmcnt(10) lgkmcnt(4)
  v_mfma_f32_32x32x16_bf16 v[40:55], a[172:175], a[132:135], v[40:55]
  ds_read_b128 a[168:171], v1 offset:10240
  s_add_u32 m0, s27, 69632
  s_add_u32 s34, s33, 167936
  buffer_load_dwordx4 v1, s[20:23], s34 offen offset:0 sc1 lds
  v_mfma_f32_32x32x16_bf16 v[56:71], a[176:179], a[132:135], v[56:71]
  ds_read_b128 a[172:175], v1 offset:11264
  v_mfma_f32_32x32x16_bf16 v[72:87], a[180:183], a[132:135], v[72:87]
  ds_read_b128 a[176:179], v1 offset:12288
  s_waitcnt vmcnt(10) lgkmcnt(4)
  v_mfma_f32_32x32x16_bf16 v[40:55], a[184:187], a[136:139], v[40:55]
  ds_read_b128 a[180:183], v1 offset:13312
  v_mfma_f32_32x32x16_bf16 v[56:71], a[188:191], a[136:139], v[56:71]
  ds_read_b128 a[184:187], v1 offset:14336
  v_mfma_f32_32x32x16_bf16 v[72:87], a[160:163], a[136:139], v[72:87]
  ds_read_b128 a[188:191], v1 offset:15360
  s_waitcnt vmcnt(9) lgkmcnt(4)
  v_mfma_f32_32x32x16_bf16 v[40:55], a[164:167], a[140:143], v[40:55]
  ds_read_b128 a[160:163], v1 offset:16384
  buffer_load_dwordx4 v1, s[20:23], s34 offen offset:1024 sc1 lds
  v_mfma_f32_32x32x16_bf16 v[56:71], a[168:171], a[140:143], v[56:71]
  ds_read_b128 a[164:167], v1 offset:17408
  v_mfma_f32_32x32x16_bf16 v[72:87], a[172:175], a[140:143], v[72:87]
  ds_read_b128 a[168:171], v1 offset:18432
  buffer_load_dwordx4 v1, s[20:23], s34 offen offset:2048 sc1 lds
  s_waitcnt vmcnt(10) lgkmcnt(4)
  v_mfma_f32_32x32x16_bf16 v[40:55], a[176:179], a[144:147], v[40:55]
  ds_read_b128 a[172:175], v1 offset:19456
  buffer_load_dwordx4 v1, s[20:23], s34 offen offset:3072 sc1 lds
  v_mfma_f32_32x32x16_bf16 v[56:71], a[180:183], a[144:147], v[56:71]
  ds_read_b128 a[176:179], v1 offset:20480
  s_add_u32 m0, s27, 98304
  s_add_u32 s34, s33, 196608
  buffer_load_dwordx4 v1, s[20:23], s34 offen offset:0 sc1 lds
  v_mfma_f32_32x32x16_bf16 v[72:87], a[184:187], a[144:147], v[72:87]
  ds_read_b128 a[180:183], v1 offset:21504
  s_waitcnt vmcnt(11) lgkmcnt(4)
  v_mfma_f32_32x32x16_bf16 v[40:55], a[188:191], a[148:151], v[40:55]
  ds_read_b128 a[184:187], v1 offset:22528
  v_mfma_f32_32x32x16_bf16 v[56:71], a[160:163], a[148:151], v[56:71]
  ds_read_b128 a[188:191], v1 offset:23552
  v_mfma_f32_32x32x16_bf16 v[72:87], a[164:167], a[148:151], v[72:87]
  ds_read_b128 a[160:163], v1 offset:24576
  buffer_load_dwordx4 v1, s[20:23], s34 offen offset:1024 sc1 lds
  s_waitcnt vmcnt(11) lgkmcnt(4)
  v_mfma_f32_32x32x16_bf16 v[40:55], a[168:171], a[152:155], v[40:55]
  ds_read_b128 a[164:167], v1 offset:25600
  v_mfma_f32_32x32x16_bf16 v[56:71], a[172:175], a[152:155], v[56:71]
  ds_read_b128 a[168:171], v1 offset:26624
  v_mfma_f32_32x32x16_bf16 v[72:87], a[176:179], a[152:155], v[72:87]
  ds_read_b128 a[172:175], v1 offset:27648
  s_waitcnt vmcnt(10) lgkmcnt(4)
  v_mfma_f32_32x32x16_bf16 v[40:55], a[180:183], a[156:159], v[40:55]
  ds_read_b128 a[176:179], v1 offset:28672
  v_mfma_f32_32x32x16_bf16 v[56:71], a[184:187], a[156:159], v[56:71]
  ds_read_b128 a[180:183], v1 offset:29696
  v_mfma_f32_32x32x16_bf16 v[72:87], a[188:191], a[156:159], v[72:87]
  ds_read_b128 a[184:187], v1 offset:30720
  buffer_load_dwordx4 v1, s[20:23], s34 offen offset:2048 sc1 lds
  s_waitcnt lgkmcnt(4)
  v_mfma_f32_32x32x16_bf16 v[40:55], a[160:163], v[104:107], v[40:55]
  ds_read_b128 a[188:191], v1 offset:31744
  v_mfma_f32_32x32x16_bf16 v[56:71], a[164:167], v[104:107], v[56:71]
  ds_read_b128 a[160:163], v1 offset:32768
  v_mfma_f32_32x32x16_bf16 v[72:87], a[168:171], v[104:107], v[72:87]
  ds_read_b128 a[164:167], v1 offset:33792
  s_waitcnt lgkmcnt(4)
  v_mfma_f32_32x32x16_bf16 v[88:103], a[172:175], a[0:3], 0
  ds_read_b128 a[168:171], v1 offset:34816
  v_mfma_f32_32x32x16_bf16 v[88:103], a[176:179], a[4:7], v[88:103]
  ds_read_b128 a[172:175], v1 offset:35840
  v_mfma_f32_32x32x16_bf16 v[88:103], a[180:183], a[8:11], v[88:103]
  ds_read_b128 a[176:179], v1 offset:36864
  buffer_load_dwordx4 v1, s[20:23], s34 offen offset:3072 sc1 lds
  v_mul_f32 v24, v40, v40
  s_waitcnt lgkmcnt(4)
  v_mfma_f32_32x32x16_bf16 v[88:103], a[184:187], a[12:15], v[88:103]
  ds_read_b128 a[180:183], v1 offset:37888
  v_mul_f32 v25, v41, v41
  v_mul_f32 v26, v42, v42
  v_mul_f32 v27, v43, v43
  s_barrier
  v_mfma_f32_32x32x16_bf16 v[88:103], a[188:191], a[16:19], v[88:103]
  ds_read_b128 a[184:187], v1 offset:38912
  v_fma_f32 v24, v24, v110, v111
  v_fma_f32 v25, v25, v110, v111
  v_fma_f32 v26, v26, v110, v111
  v_fma_f32 v27, v27, v110, v111
  v_mul_f32 v24, v24, v40
  v_mfma_f32_32x32x16_bf16 v[88:103], a[160:163], a[20:23], v[88:103]
  ds_read_b128 a[188:191], v1 offset:39936
  v_mul_f32 v25, v25, v41
  v_mul_f32 v26, v26, v42
  v_mul_f32 v27, v27, v43
  s_waitcnt lgkmcnt(4)
  v_mfma_f32_32x32x16_bf16 v[88:103], a[164:167], a[24:27], v[88:103]
  ds_read_b128 a[160:163], v1 offset:40960
  v_exp_f32 v24, v24
  v_mul_f32 v48, v40, v48
  v_exp_f32 v25, v25
  v_mfma_f32_32x32x16_bf16 v[88:103], a[168:171], a[28:31], v[88:103]
  ds_read_b128 a[164:167], v1 offset:41984
  v_mul_f32 v49, v41, v49
  v_exp_f32 v26, v26
  v_mul_f32 v50, v42, v50
  v_mfma_f32_32x32x16_bf16 v[88:103], a[172:175], a[32:35], v[88:103]
  ds_read_b128 a[168:171], v1 offset:43008
  s_add_u32 m0, s27, 102400
  s_add_u32 s34, s33, 200704
  buffer_load_dwordx4 v1, s[20:23], s34 offen offset:0 sc1 lds
  s_waitcnt lgkmcnt(4)
  v_mfma_f32_32x32x16_bf16 v[88:103], a[176:179], a[36:39], v[88:103]
  ds_read_b128 a[172:175], v1 offset:44032
  v_exp_f32 v27, v27
  v_mul_f32 v51, v43, v51
  v_fma_f32 v24, v24, v108, v108
  v_fma_f32 v25, v25, v108, v108
  v_mfma_f32_32x32x16_bf16 v[88:103], a[180:183], a[40:43], v[88:103]
  ds_read_b128 a[176:179], v1 offset:45056
  v_fma_f32 v26, v26, v108, v108
  v_fma_f32 v27, v27, v108, v108
  v_rcp_f32 v24, v24
  v_mfma_f32_32x32x16_bf16 v[88:103], a[184:187], a[44:47], v[88:103]
  ds_read_b128 a[180:183], v1 offset:46080
  v_rcp_f32 v25, v25
  v_rcp_f32 v26, v26
  s_waitcnt lgkmcnt(4)
  v_mfma_f32_32x32x16_bf16 v[88:103], a[188:191], a[48:51], v[88:103]
  ds_read_b128 a[184:187], v1 offset:47104
  v_rcp_f32 v27, v27
  v_mul_f32 v48, v48, v24
  v_mul_f32 v49, v49, v25
  v_mul_f32 v50, v50, v26
  v_mfma_f32_32x32x16_bf16 v[88:103], a[160:163], a[52:55], v[88:103]
  ds_read_b128 a[188:191], v1 offset:48128
  v_mul_f32 v51, v51, v27
  v_cvt_pk_bf16_f32 v28, v48, v49
  v_cvt_pk_bf16_f32 v29, v50, v51
  v_mul_f32 v24, v44, v44
  v_mul_f32 v25, v45, v45
  v_mfma_f32_32x32x16_bf16 v[88:103], a[164:167], a[56:59], v[88:103]
  ds_read_b128 a[160:163], v1 offset:49152
  buffer_load_dwordx4 v1, s[20:23], s34 offen offset:1024 sc1 lds
  v_mul_f32 v26, v46, v46
  s_waitcnt lgkmcnt(4)
  v_mfma_f32_32x32x16_bf16 v[88:103], a[168:171], a[60:63], v[88:103]
  ds_read_b128 a[164:167], v1 offset:50176
  v_mul_f32 v27, v47, v47
  v_fma_f32 v24, v24, v110, v111
  v_fma_f32 v25, v25, v110, v111
  v_fma_f32 v26, v26, v110, v111
  v_fma_f32 v27, v27, v110, v111
  v_mfma_f32_32x32x16_bf16 v[88:103], a[172:175], a[64:67], v[88:103]
  ds_read_b128 a[168:171], v1 offset:51200
  buffer_load_dwordx4 v1, s[20:23], s34 offen offset:2048 sc1 lds
  v_mul_f32 v24, v24, v44
  v_mul_f32 v25, v25, v45
  v_mfma_f32_32x32x16_bf16 v[88:103], a[176:179], a[68:71], v[88:103]
  ds_read_b128 a[172:175], v1 offset:52224
  buffer_load_dwordx4 v1, s[20:23], s34 offen offset:3072 sc1 lds
  v_mul_f32 v26, v26, v46
  s_waitcnt lgkmcnt(4)
  v_mfma_f32_32x32x16_bf16 v[88:103], a[180:183], a[72:75], v[88:103]
  ds_read_b128 a[176:179], v1 offset:53248
  s_add_u32 m0, s27, 131072
  s_add_u32 s34, s33, 229376
  buffer_load_dwordx4 v1, s[20:23], s34 offen offset:0 sc1 lds
  v_mfma_f32_32x32x16_bf16 v[88:103], a[184:187], a[76:79], v[88:103]
  ds_read_b128 a[180:183], v1 offset:54272
  v_mul_f32 v27, v27, v47
  v_exp_f32 v24, v24
  v_mul_f32 v52, v44, v52
  v_mfma_f32_32x32x16_bf16 v[88:103], a[188:191], a[80:83], v[88:103]
  ds_read_b128 a[184:187], v1 offset:55296
  v_exp_f32 v25, v25
  v_mul_f32 v53, v45, v53
  s_waitcnt lgkmcnt(4)
  v_mfma_f32_32x32x16_bf16 v[88:103], a[160:163], a[84:87], v[88:103]
  ds_read_b128 a[188:191], v1 offset:56320
  v_exp_f32 v26, v26
  v_mul_f32 v54, v46, v54
  v_exp_f32 v27, v27
  v_mfma_f32_32x32x16_bf16 v[88:103], a[164:167], a[88:91], v[88:103]
  ds_read_b128 a[160:163], v1 offset:57344
  buffer_load_dwordx4 v1, s[20:23], s34 offen offset:1024 sc1 lds
  v_mul_f32 v55, v47, v55
  v_fma_f32 v24, v24, v108, v108
  v_mfma_f32_32x32x16_bf16 v[88:103], a[168:171], a[92:95], v[88:103]
  ds_read_b128 a[164:167], v1 offset:58368
  v_fma_f32 v25, v25, v108, v108
  v_fma_f32 v26, v26, v108, v108
  v_fma_f32 v27, v27, v108, v108
  s_waitcnt lgkmcnt(4)
  v_mfma_f32_32x32x16_bf16 v[88:103], a[172:175], a[96:99], v[88:103]
  ds_read_b128 a[168:171], v1 offset:59392
  v_rcp_f32 v24, v24
  v_rcp_f32 v25, v25
  v_mfma_f32_32x32x16_bf16 v[88:103], a[176:179], a[100:103], v[88:103]
  ds_read_b128 a[172:175], v1 offset:60416
  v_rcp_f32 v26, v26
  v_rcp_f32 v27, v27
  v_mul_f32 v52, v52, v24
  v_mfma_f32_32x32x16_bf16 v[88:103], a[180:183], a[104:107], v[88:103]
  ds_read_b128 a[176:179], v1 offset:61440
  v_mul_f32 v53, v53, v25
  v_mul_f32 v54, v54, v26
  v_mul_f32 v55, v55, v27
  v_cvt_pk_bf16_f32 v30, v52, v53
  s_waitcnt lgkmcnt(4)
  v_mfma_f32_32x32x16_bf16 v[88:103], a[184:187], a[108:111], v[88:103]
  ds_read_b128 a[180:183], v1 offset:62464
  v_cvt_pk_bf16_f32 v31, v54, v55
  buffer_store_dwordx4 v[28:31], v9, s[8:11], s60 offen offset:0 sc1
  v_mul_f32 v24, v56, v56
  v_mfma_f32_32x32x16_bf16 v[88:103], a[188:191], a[112:115], v[88:103]
  ds_read_b128 a[184:187], v1 offset:63488
  buffer_load_dwordx4 v1, s[20:23], s34 offen offset:2048 sc1 lds
  v_mul_f32 v25, v57, v57
  v_mul_f32 v26, v58, v58
  v_mfma_f32_32x32x16_bf16 v[88:103], a[160:163], a[116:119], v[88:103]
  ds_read_b128 a[188:191], v1 offset:64512
  v_mul_f32 v27, v59, v59
  v_fma_f32 v24, v24, v110, v111
  s_waitcnt vmcnt(12)
  s_barrier
  s_waitcnt lgkmcnt(4)
  v_mfma_f32_32x32x16_bf16 v[88:103], a[164:167], a[120:123], v[88:103]
  ds_read_b128 a[160:163], v2 offset:0
  v_fma_f32 v25, v25, v110, v111
  v_fma_f32 v26, v26, v110, v111
  v_fma_f32 v27, v27, v110, v111
  v_mul_f32 v24, v24, v56
  v_mul_f32 v25, v25, v57
  v_mfma_f32_32x32x16_bf16 v[88:103], a[168:171], a[124:127], v[88:103]
  ds_read_b128 a[164:167], v2 offset:1024
  v_mul_f32 v26, v26, v58
  v_mul_f32 v27, v27, v59
  v_exp_f32 v24, v24
  v_mul_f32 v64, v56, v64
  v_mfma_f32_32x32x16_bf16 v[88:103], a[172:175], a[128:131], v[88:103]
  ds_read_b128 a[168:171], v2 offset:2048
  v_exp_f32 v25, v25
  v_mul_f32 v65, v57, v65
  s_waitcnt lgkmcnt(4)
  v_mfma_f32_32x32x16_bf16 v[88:103], a[176:179], a[132:135], v[88:103]
  ds_read_b128 a[172:175], v2 offset:3072
  v_exp_f32 v26, v26
  v_mul_f32 v66, v58, v66
  v_exp_f32 v27, v27
  v_mfma_f32_32x32x16_bf16 v[88:103], a[180:183], a[136:139], v[88:103]
  ds_read_b128 a[176:179], v2 offset:4096
  buffer_load_dwordx4 v1, s[20:23], s34 offen offset:3072 sc1 lds
  v_mul_f32 v67, v59, v67
  v_fma_f32 v24, v24, v108, v108
  v_mfma_f32_32x32x16_bf16 v[88:103], a[184:187], a[140:143], v[88:103]
  ds_read_b128 a[180:183], v2 offset:5120
  v_fma_f32 v25, v25, v108, v108
  v_fma_f32 v26, v26, v108, v108
  v_fma_f32 v27, v27, v108, v108
  s_waitcnt lgkmcnt(4)
  v_mfma_f32_32x32x16_bf16 v[88:103], a[188:191], a[144:147], v[88:103]
  ds_read_b128 a[184:187], v2 offset:6144
  v_rcp_f32 v24, v24
  v_rcp_f32 v25, v25
  v_mfma_f32_32x32x16_bf16 v[88:103], a[160:163], a[148:151], v[88:103]
  ds_read_b128 a[188:191], v2 offset:7168
  v_rcp_f32 v26, v26
  v_rcp_f32 v27, v27
  v_mul_f32 v64, v64, v24
  v_mfma_f32_32x32x16_bf16 v[88:103], a[164:167], a[152:155], v[88:103]
  ds_read_b128 a[160:163], v2 offset:8192
  v_mul_f32 v65, v65, v25
  v_mul_f32 v66, v66, v26
  v_mul_f32 v67, v67, v27
  v_cvt_pk_bf16_f32 v32, v64, v65
  s_waitcnt lgkmcnt(4)
  v_mfma_f32_32x32x16_bf16 v[88:103], a[168:171], a[156:159], v[88:103]
  ds_read_b128 a[164:167], v2 offset:9216
  v_cvt_pk_bf16_f32 v33, v66, v67
  v_mul_f32 v24, v60, v60
  v_mul_f32 v25, v61, v61
  v_mul_f32 v26, v62, v62
  v_mul_f32 v27, v63, v63
  v_mfma_f32_32x32x16_bf16 v[88:103], a[172:175], v[104:107], v[88:103]
  ds_read_b128 a[168:171], v2 offset:10240
  s_add_u32 m0, s27, 135168
  s_add_u32 s34, s33, 233472
  buffer_load_dwordx4 v1, s[20:23], s34 offen offset:0 sc1 lds
  v_mfma_f32_32x32x16_bf16 v[40:55], a[176:179], a[0:3], 0
  ds_read_b128 a[172:175], v2 offset:11264
  v_fma_f32 v24, v24, v110, v111
  v_fma_f32 v25, v25, v110, v111
  v_fma_f32 v26, v26, v110, v111
  v_fma_f32 v27, v27, v110, v111
  s_waitcnt lgkmcnt(4)
  v_mfma_f32_32x32x16_bf16 v[40:55], a[180:183], a[4:7], v[40:55]
  ds_read_b128 a[176:179], v2 offset:12288
  v_mul_f32 v24, v24, v60
  v_mul_f32 v25, v25, v61
  v_mul_f32 v26, v26, v62
  v_mul_f32 v27, v27, v63
  v_mfma_f32_32x32x16_bf16 v[40:55], a[184:187], a[8:11], v[40:55]
  ds_read_b128 a[180:183], v2 offset:13312
  v_exp_f32 v24, v24
  v_mul_f32 v68, v60, v68
  v_exp_f32 v25, v25
  v_mfma_f32_32x32x16_bf16 v[40:55], a[188:191], a[12:15], v[40:55]
  ds_read_b128 a[184:187], v2 offset:14336
  v_mul_f32 v69, v61, v69
  v_exp_f32 v26, v26
  v_mul_f32 v70, v62, v70
  s_waitcnt lgkmcnt(4)
  v_mfma_f32_32x32x16_bf16 v[40:55], a[160:163], a[16:19], v[40:55]
  ds_read_b128 a[188:191], v2 offset:15360
  v_exp_f32 v27, v27
  v_mul_f32 v71, v63, v71
  v_fma_f32 v24, v24, v108, v108
  v_fma_f32 v25, v25, v108, v108
  v_mfma_f32_32x32x16_bf16 v[40:55], a[164:167], a[20:23], v[40:55]
  ds_read_b128 a[160:163], v2 offset:16384
  buffer_load_dwordx4 v1, s[20:23], s34 offen offset:1024 sc1 lds
  v_fma_f32 v26, v26, v108, v108
  v_fma_f32 v27, v27, v108, v108
  v_mfma_f32_32x32x16_bf16 v[40:55], a[168:171], a[24:27], v[40:55]
  ds_read_b128 a[164:167], v2 offset:17408
  v_rcp_f32 v24, v24
  v_rcp_f32 v25, v25
  s_waitcnt lgkmcnt(4)
  v_mfma_f32_32x32x16_bf16 v[40:55], a[172:175], a[28:31], v[40:55]
  ds_read_b128 a[168:171], v2 offset:18432
  buffer_load_dwordx4 v1, s[20:23], s34 offen offset:2048 sc1 lds
  v_rcp_f32 v26, v26
  v_mfma_f32_32x32x16_bf16 v[40:55], a[176:179], a[32:35], v[40:55]
  ds_read_b128 a[172:175], v2 offset:19456
  buffer_load_dwordx4 v1, s[20:23], s34 offen offset:3072 sc1 lds
  v_rcp_f32 v27, v27
  v_mfma_f32_32x32x16_bf16 v[40:55], a[180:183], a[36:39], v[40:55]
  ds_read_b128 a[176:179], v2 offset:20480
  s_add_u32 m0, s27, 0
  s_add_u32 s34, s33, 262144
  buffer_load_dwordx4 v1, s[20:23], s34 offen offset:0 sc1 lds
  s_waitcnt lgkmcnt(4)
  v_mfma_f32_32x32x16_bf16 v[40:55], a[184:187], a[40:43], v[40:55]
  ds_read_b128 a[180:183], v2 offset:21504
  v_mul_f32 v68, v68, v24
  v_mul_f32 v69, v69, v25
  v_mul_f32 v70, v70, v26
  v_mul_f32 v71, v71, v27
  v_cvt_pk_bf16_f32 v34, v68, v69
  v_mfma_f32_32x32x16_bf16 v[40:55], a[188:191], a[44:47], v[40:55]
  ds_read_b128 a[184:187], v2 offset:22528
  v_cvt_pk_bf16_f32 v35, v70, v71
  buffer_store_dwordx4 v[32:35], v9, s[8:11], s60 offen offset:512 sc1
  v_mul_f32 v24, v72, v72
  v_mfma_f32_32x32x16_bf16 v[40:55], a[160:163], a[48:51], v[40:55]
  ds_read_b128 a[188:191], v2 offset:23552
  v_mul_f32 v25, v73, v73
  v_mul_f32 v26, v74, v74
  v_mul_f32 v27, v75, v75
  v_fma_f32 v24, v24, v110, v111
  s_waitcnt lgkmcnt(4)
  v_mfma_f32_32x32x16_bf16 v[40:55], a[164:167], a[52:55], v[40:55]
  ds_read_b128 a[160:163], v2 offset:24576
  buffer_load_dwordx4 v1, s[20:23], s34 offen offset:1024 sc1 lds
  v_fma_f32 v25, v25, v110, v111
  v_fma_f32 v26, v26, v110, v111
  v_mfma_f32_32x32x16_bf16 v[40:55], a[168:171], a[56:59], v[40:55]
  ds_read_b128 a[164:167], v2 offset:25600
  v_fma_f32 v27, v27, v110, v111
  v_mul_f32 v24, v24, v72
  v_mul_f32 v25, v25, v73
  v_mul_f32 v26, v26, v74
  v_mul_f32 v27, v27, v75
  v_mfma_f32_32x32x16_bf16 v[40:55], a[172:175], a[60:63], v[40:55]
  ds_read_b128 a[168:171], v2 offset:26624
  v_exp_f32 v24, v24
  v_mul_f32 v80, v72, v80
  s_waitcnt lgkmcnt(4)
  v_mfma_f32_32x32x16_bf16 v[40:55], a[176:179], a[64:67], v[40:55]
  ds_read_b128 a[172:175], v2 offset:27648
  v_exp_f32 v25, v25
  v_mul_f32 v81, v73, v81
  v_exp_f32 v26, v26
  v_mfma_f32_32x32x16_bf16 v[40:55], a[180:183], a[68:71], v[40:55]
  ds_read_b128 a[176:179], v2 offset:28672
  v_mul_f32 v82, v74, v82
  v_exp_f32 v27, v27
  v_mul_f32 v83, v75, v83
  v_fma_f32 v24, v24, v108, v108
  v_mfma_f32_32x32x16_bf16 v[40:55], a[184:187], a[72:75], v[40:55]
  ds_read_b128 a[180:183], v2 offset:29696
  v_fma_f32 v25, v25, v108, v108
  v_fma_f32 v26, v26, v108, v108
  v_fma_f32 v27, v27, v108, v108
  s_waitcnt lgkmcnt(4)
  v_mfma_f32_32x32x16_bf16 v[40:55], a[188:191], a[76:79], v[40:55]
  ds_read_b128 a[184:187], v2 offset:30720
  buffer_load_dwordx4 v1, s[20:23], s34 offen offset:2048 sc1 lds
  v_rcp_f32 v24, v24
  v_mfma_f32_32x32x16_bf16 v[40:55], a[160:163], a[80:83], v[40:55]
  ds_read_b128 a[188:191], v2 offset:31744
  v_rcp_f32 v25, v25
  s_waitcnt vmcnt(13)
  s_barrier
  v_mfma_f32_32x32x16_bf16 v[40:55], a[164:167], a[84:87], v[40:55]
  ds_read_b128 a[160:163], v2 offset:32768
  v_rcp_f32 v26, v26
  v_rcp_f32 v27, v27
  s_waitcnt lgkmcnt(4)
  v_mfma_f32_32x32x16_bf16 v[40:55], a[168:171], a[88:91], v[40:55]
  ds_read_b128 a[164:167], v2 offset:33792
  v_mul_f32 v80, v80, v24
  v_mul_f32 v81, v81, v25
  v_mul_f32 v82, v82, v26
  v_mul_f32 v83, v83, v27
  v_cvt_pk_bf16_f32 v28, v80, v81
  v_mfma_f32_32x32x16_bf16 v[40:55], a[172:175], a[92:95], v[40:55]
  ds_read_b128 a[168:171], v2 offset:34816
  v_cvt_pk_bf16_f32 v29, v82, v83
  v_mul_f32 v24, v76, v76
  v_mul_f32 v25, v77, v77
  v_mul_f32 v26, v78, v78
  v_mul_f32 v27, v79, v79
  v_mfma_f32_32x32x16_bf16 v[40:55], a[176:179], a[96:99], v[40:55]
  ds_read_b128 a[172:175], v2 offset:35840
  v_fma_f32 v24, v24, v110, v111
  v_fma_f32 v25, v25, v110, v111
  v_fma_f32 v26, v26, v110, v111
  v_fma_f32 v27, v27, v110, v111
  s_waitcnt lgkmcnt(4)
  v_mfma_f32_32x32x16_bf16 v[40:55], a[180:183], a[100:103], v[40:55]
  ds_read_b128 a[176:179], v2 offset:36864
  buffer_load_dwordx4 v1, s[20:23], s34 offen offset:3072 sc1 lds
  v_mul_f32 v24, v24, v76
  v_mul_f32 v25, v25, v77
  v_mfma_f32_32x32x16_bf16 v[40:55], a[184:187], a[104:107], v[40:55]
  ds_read_b128 a[180:183], v2 offset:37888
  v_mul_f32 v26, v26, v78
  v_mul_f32 v27, v27, v79
  v_exp_f32 v24, v24
  v_mul_f32 v84, v76, v84
  v_mfma_f32_32x32x16_bf16 v[40:55], a[188:191], a[108:111], v[40:55]
  ds_read_b128 a[184:187], v2 offset:38912
  v_exp_f32 v25, v25
  v_mul_f32 v85, v77, v85
  s_waitcnt lgkmcnt(4)
  v_mfma_f32_32x32x16_bf16 v[40:55], a[160:163], a[112:115], v[40:55]
  ds_read_b128 a[188:191], v2 offset:39936
  v_exp_f32 v26, v26
  v_mul_f32 v86, v78, v86
  v_exp_f32 v27, v27
  v_mfma_f32_32x32x16_bf16 v[40:55], a[164:167], a[116:119], v[40:55]
  ds_read_b128 a[160:163], v2 offset:40960
  v_mul_f32 v87, v79, v87
  v_fma_f32 v24, v24, v108, v108
  v_fma_f32 v25, v25, v108, v108
  v_fma_f32 v26, v26, v108, v108
  v_fma_f32 v27, v27, v108, v108
  v_mfma_f32_32x32x16_bf16 v[40:55], a[168:171], a[120:123], v[40:55]
  ds_read_b128 a[164:167], v2 offset:41984
  v_rcp_f32 v24, v24
  v_rcp_f32 v25, v25
  s_waitcnt lgkmcnt(4)
  v_mfma_f32_32x32x16_bf16 v[40:55], a[172:175], a[124:127], v[40:55]
  ds_read_b128 a[168:171], v2 offset:43008
  s_add_u32 m0, s27, 4096
  s_add_u32 s34, s33, 266240
  buffer_load_dwordx4 v1, s[20:23], s34 offen offset:0 sc1 lds
  v_mfma_f32_32x32x16_bf16 v[40:55], a[176:179], a[128:131], v[40:55]
  ds_read_b128 a[172:175], v2 offset:44032
  v_rcp_f32 v26, v26
  v_rcp_f32 v27, v27
  v_mul_f32 v84, v84, v24
  v_mfma_f32_32x32x16_bf16 v[40:55], a[180:183], a[132:135], v[40:55]
  ds_read_b128 a[176:179], v2 offset:45056
  v_mul_f32 v85, v85, v25
  v_mul_f32 v86, v86, v26
  v_mul_f32 v87, v87, v27
  v_cvt_pk_bf16_f32 v30, v84, v85
  s_waitcnt lgkmcnt(4)
  v_mfma_f32_32x32x16_bf16 v[40:55], a[184:187], a[136:139], v[40:55]
  ds_read_b128 a[180:183], v2 offset:46080
  v_cvt_pk_bf16_f32 v31, v86, v87
  buffer_store_dwordx4 v[28:31], v9, s[8:11], s60 offen offset:1024 sc1
  v_mul_f32 v24, v88, v88
  v_mfma_f32_32x32x16_bf16 v[40:55], a[188:191], a[140:143], v[40:55]
  ds_read_b128 a[184:187], v2 offset:47104
  v_mul_f32 v25, v89, v89
  v_mul_f32 v26, v90, v90
  v_mul_f32 v27, v91, v91
  v_fma_f32 v24, v24, v110, v111
  v_fma_f32 v25, v25, v110, v111
  v_mfma_f32_32x32x16_bf16 v[40:55], a[160:163], a[144:147], v[40:55]
  ds_read_b128 a[188:191], v2 offset:48128
  v_fma_f32 v26, v26, v110, v111
  v_fma_f32 v27, v27, v110, v111
  v_mul_f32 v24, v24, v88
  v_mul_f32 v25, v25, v89
  s_waitcnt lgkmcnt(4)
  v_mfma_f32_32x32x16_bf16 v[40:55], a[164:167], a[148:151], v[40:55]
  ds_read_b128 a[160:163], v2 offset:49152
  buffer_load_dwordx4 v1, s[20:23], s34 offen offset:1024 sc1 lds
  v_mul_f32 v26, v26, v90
  v_mul_f32 v27, v27, v91
  v_mfma_f32_32x32x16_bf16 v[40:55], a[168:171], a[152:155], v[40:55]
  ds_read_b128 a[164:167], v2 offset:50176
  v_exp_f32 v24, v24
  v_mul_f32 v96, v88, v96
  v_exp_f32 v25, v25
  v_mfma_f32_32x32x16_bf16 v[40:55], a[172:175], a[156:159], v[40:55]
  ds_read_b128 a[168:171], v2 offset:51200
  v_mul_f32 v97, v89, v97
  v_exp_f32 v26, v26
  v_mul_f32 v98, v90, v98
  s_waitcnt lgkmcnt(4)
  v_mfma_f32_32x32x16_bf16 v[40:55], a[176:179], v[104:107], v[40:55]
  ds_read_b128 a[172:175], v2 offset:52224
  v_exp_f32 v27, v27
  v_mul_f32 v99, v91, v99
  v_fma_f32 v24, v24, v108, v108
  v_fma_f32 v25, v25, v108, v108
  v_mfma_f32_32x32x16_bf16 v[56:71], a[180:183], a[0:3], 0
  ds_read_b128 a[176:179], v2 offset:53248
  v_fma_f32 v26, v26, v108, v108
  v_fma_f32 v27, v27, v108, v108
  v_rcp_f32 v24, v24
  v_mfma_f32_32x32x16_bf16 v[56:71], a[184:187], a[4:7], v[56:71]
  ds_read_b128 a[180:183], v2 offset:54272
  v_rcp_f32 v25, v25
  v_rcp_f32 v26, v26
  s_waitcnt lgkmcnt(4)
  v_mfma_f32_32x32x16_bf16 v[56:71], a[188:191], a[8:11], v[56:71]
  ds_read_b128 a[184:187], v2 offset:55296
  buffer_load_dwordx4 v1, s[20:23], s34 offen offset:2048 sc1 lds
  v_rcp_f32 v27, v27
  v_mfma_f32_32x32x16_bf16 v[56:71], a[160:163], a[12:15], v[56:71]
  ds_read_b128 a[188:191], v2 offset:56320
  v_mul_f32 v96, v96, v24
  v_mul_f32 v97, v97, v25
  v_mul_f32 v98, v98, v26
  v_mul_f32 v99, v99, v27
  v_cvt_pk_bf16_f32 v32, v96, v97
  v_mfma_f32_32x32x16_bf16 v[56:71], a[164:167], a[16:19], v[56:71]
  ds_read_b128 a[160:163], v2 offset:57344
  v_cvt_pk_bf16_f32 v33, v98, v99
  v_mul_f32 v24, v92, v92
  v_mul_f32 v25, v93, v93
  v_mul_f32 v26, v94, v94
  s_waitcnt lgkmcnt(4)
  v_mfma_f32_32x32x16_bf16 v[56:71], a[168:171], a[20:23], v[56:71]
  ds_read_b128 a[164:167], v2 offset:58368
  v_mul_f32 v27, v95, v95
  v_fma_f32 v24, v24, v110, v111
  v_fma_f32 v25, v25, v110, v111
  v_fma_f32 v26, v26, v110, v111
  v_fma_f32 v27, v27, v110, v111
  v_mfma_f32_32x32x16_bf16 v[56:71], a[172:175], a[24:27], v[56:71]
  ds_read_b128 a[168:171], v2 offset:59392
  v_mul_f32 v24, v24, v92
  v_mul_f32 v25, v25, v93
  v_mul_f32 v26, v26, v94
  v_mul_f32 v27, v27, v95
  v_mfma_f32_32x32x16_bf16 v[56:71], a[176:179], a[28:31], v[56:71]
  ds_read_b128 a[172:175], v2 offset:60416
  v_exp_f32 v24, v24
  v_mul_f32 v100, v92, v100
  s_waitcnt lgkmcnt(4)
  v_mfma_f32_32x32x16_bf16 v[56:71], a[180:183], a[32:35], v[56:71]
  ds_read_b128 a[176:179], v2 offset:61440
  buffer_load_dwordx4 v1, s[20:23], s34 offen offset:3072 sc1 lds
  v_exp_f32 v25, v25
  v_mfma_f32_32x32x16_bf16 v[56:71], a[184:187], a[36:39], v[56:71]
  ds_read_b128 a[180:183], v2 offset:62464
  v_mul_f32 v101, v93, v101
  v_exp_f32 v26, v26
  v_mul_f32 v102, v94, v102
  v_mfma_f32_32x32x16_bf16 v[56:71], a[188:191], a[40:43], v[56:71]
  ds_read_b128 a[184:187], v2 offset:63488
  v_exp_f32 v27, v27
  v_mul_f32 v103, v95, v103
  v_fma_f32 v24, v24, v108, v108
  s_waitcnt lgkmcnt(4)
  v_mfma_f32_32x32x16_bf16 v[56:71], a[160:163], a[44:47], v[56:71]
  ds_read_b128 a[188:191], v2 offset:64512
  v_fma_f32 v25, v25, v108, v108
  v_fma_f32 v26, v26, v108, v108
  v_fma_f32 v27, v27, v108, v108
  s_waitcnt vmcnt(10)
  s_barrier
  v_mfma_f32_32x32x16_bf16 v[56:71], a[164:167], a[48:51], v[56:71]
  ds_read_b128 a[160:163], v3 offset:0
  v_rcp_f32 v24, v24
  v_rcp_f32 v25, v25
  v_mfma_f32_32x32x16_bf16 v[56:71], a[168:171], a[52:55], v[56:71]
  ds_read_b128 a[164:167], v3 offset:1024
  v_rcp_f32 v26, v26
  v_rcp_f32 v27, v27
  s_waitcnt lgkmcnt(4)
  v_mfma_f32_32x32x16_bf16 v[56:71], a[172:175], a[56:59], v[56:71]
  ds_read_b128 a[168:171], v3 offset:2048
  v_mul_f32 v100, v100, v24
  v_mul_f32 v101, v101, v25
  v_mul_f32 v102, v102, v26
  v_mul_f32 v103, v103, v27
  v_cvt_pk_bf16_f32 v34, v100, v101
  v_mfma_f32_32x32x16_bf16 v[56:71], a[176:179], a[60:63], v[56:71]
  ds_read_b128 a[172:175], v3 offset:3072
  v_cvt_pk_bf16_f32 v35, v102, v103
  buffer_store_dwordx4 v[32:35], v9, s[8:11], s60 offen offset:1536 sc1
  v_mul_f32 v24, v40, v40
  v_mfma_f32_32x32x16_bf16 v[56:71], a[180:183], a[64:67], v[56:71]
  ds_read_b128 a[176:179], v3 offset:4096
  v_mul_f32 v25, v41, v41
  v_mul_f32 v26, v42, v42
  v_mul_f32 v27, v43, v43
  v_fma_f32 v24, v24, v110, v111
  s_waitcnt lgkmcnt(4)
  v_mfma_f32_32x32x16_bf16 v[56:71], a[184:187], a[68:71], v[56:71]
  ds_read_b128 a[180:183], v3 offset:5120
  v_fma_f32 v25, v25, v110, v111
  v_fma_f32 v26, v26, v110, v111
  v_fma_f32 v27, v27, v110, v111
  v_mul_f32 v24, v24, v40
  v_mul_f32 v25, v25, v41
  v_mfma_f32_32x32x16_bf16 v[56:71], a[188:191], a[72:75], v[56:71]
  ds_read_b128 a[184:187], v3 offset:6144
  v_mul_f32 v26, v26, v42
  v_mul_f32 v27, v27, v43
  v_exp_f32 v24, v24
  v_mul_f32 v48, v40, v48
  v_mfma_f32_32x32x16_bf16 v[56:71], a[160:163], a[76:79], v[56:71]
  ds_read_b128 a[188:191], v3 offset:7168
  v_exp_f32 v25, v25
  v_mul_f32 v49, v41, v49
  s_waitcnt lgkmcnt(4)
  v_mfma_f32_32x32x16_bf16 v[56:71], a[164:167], a[80:83], v[56:71]
  ds_read_b128 a[160:163], v3 offset:8192
  v_exp_f32 v26, v26
  v_mul_f32 v50, v42, v50
  v_exp_f32 v27, v27
  v_mfma_f32_32x32x16_bf16 v[56:71], a[168:171], a[84:87], v[56:71]
  ds_read_b128 a[164:167], v3 offset:9216
  v_mul_f32 v51, v43, v51
  v_fma_f32 v24, v24, v108, v108
  v_fma_f32 v25, v25, v108, v108
  v_fma_f32 v26, v26, v108, v108
  v_fma_f32 v27, v27, v108, v108
  v_mfma_f32_32x32x16_bf16 v[56:71], a[172:175], a[88:91], v[56:71]
  ds_read_b128 a[168:171], v3 offset:10240
  v_rcp_f32 v24, v24
  v_rcp_f32 v25, v25
  s_waitcnt lgkmcnt(4)
  v_mfma_f32_32x32x16_bf16 v[56:71], a[176:179], a[92:95], v[56:71]
  ds_read_b128 a[172:175], v3 offset:11264
  v_rcp_f32 v26, v26
  v_rcp_f32 v27, v27
  v_mul_f32 v48, v48, v24
  v_mfma_f32_32x32x16_bf16 v[56:71], a[180:183], a[96:99], v[56:71]
  ds_read_b128 a[176:179], v3 offset:12288
  v_mul_f32 v49, v49, v25
  v_mul_f32 v50, v50, v26
  v_mul_f32 v51, v51, v27
  v_cvt_pk_bf16_f32 v28, v48, v49
  v_cvt_pk_bf16_f32 v29, v50, v51
  v_mfma_f32_32x32x16_bf16 v[56:71], a[184:187], a[100:103], v[56:71]
  ds_read_b128 a[180:183], v3 offset:13312
  v_mul_f32 v24, v44, v44
  v_mul_f32 v25, v45, v45
  v_mul_f32 v26, v46, v46
  v_mul_f32 v27, v47, v47
  s_waitcnt lgkmcnt(4)
  v_mfma_f32_32x32x16_bf16 v[56:71], a[188:191], a[104:107], v[56:71]
  ds_read_b128 a[184:187], v3 offset:14336
  v_fma_f32 v24, v24, v110, v111
  v_fma_f32 v25, v25, v110, v111
  v_fma_f32 v26, v26, v110, v111
  v_fma_f32 v27, v27, v110, v111
  v_mul_f32 v24, v24, v44
  v_mfma_f32_32x32x16_bf16 v[56:71], a[160:163], a[108:111], v[56:71]
  ds_read_b128 a[188:191], v3 offset:15360
  v_mul_f32 v25, v25, v45
  v_mul_f32 v26, v26, v46
  v_mul_f32 v27, v27, v47
  v_exp_f32 v24, v24
  v_mfma_f32_32x32x16_bf16 v[56:71], a[164:167], a[112:115], v[56:71]
  ds_read_b128 a[160:163], v3 offset:16384
  v_mul_f32 v52, v44, v52
  v_exp_f32 v25, v25
  v_mul_f32 v53, v45, v53
  s_waitcnt lgkmcnt(4)
  v_mfma_f32_32x32x16_bf16 v[56:71], a[168:171], a[116:119], v[56:71]
  ds_read_b128 a[164:167], v3 offset:17408
  v_exp_f32 v26, v26
  v_mul_f32 v54, v46, v54
  v_exp_f32 v27, v27
  v_mfma_f32_32x32x16_bf16 v[56:71], a[172:175], a[120:123], v[56:71]
  ds_read_b128 a[168:171], v3 offset:18432
  v_mul_f32 v55, v47, v55
  v_fma_f32 v24, v24, v108, v108
  v_fma_f32 v25, v25, v108, v108
  v_fma_f32 v26, v26, v108, v108
  v_fma_f32 v27, v27, v108, v108
  v_mfma_f32_32x32x16_bf16 v[56:71], a[176:179], a[124:127], v[56:71]
  ds_read_b128 a[172:175], v3 offset:19456
  v_rcp_f32 v24, v24
  v_rcp_f32 v25, v25
  s_waitcnt lgkmcnt(4)
  v_mfma_f32_32x32x16_bf16 v[56:71], a[180:183], a[128:131], v[56:71]
  ds_read_b128 a[176:179], v3 offset:20480
  v_rcp_f32 v26, v26
  v_rcp_f32 v27, v27
  v_mul_f32 v52, v52, v24
  v_mfma_f32_32x32x16_bf16 v[56:71], a[184:187], a[132:135], v[56:71]
  ds_read_b128 a[180:183], v3 offset:21504
  v_mul_f32 v53, v53, v25
  v_mul_f32 v54, v54, v26
  v_mul_f32 v55, v55, v27
  v_cvt_pk_bf16_f32 v30, v52, v53
  v_cvt_pk_bf16_f32 v31, v54, v55
  v_mfma_f32_32x32x16_bf16 v[56:71], a[188:191], a[136:139], v[56:71]
  ds_read_b128 a[184:187], v3 offset:22528
  buffer_store_dwordx4 v[28:31], v9, s[8:11], s60 offen offset:2048 sc1
  s_waitcnt lgkmcnt(4)
  v_mfma_f32_32x32x16_bf16 v[56:71], a[160:163], a[140:143], v[56:71]
  ds_read_b128 a[188:191], v3 offset:23552
  v_mfma_f32_32x32x16_bf16 v[56:71], a[164:167], a[144:147], v[56:71]
  ds_read_b128 a[160:163], v3 offset:24576
  v_mfma_f32_32x32x16_bf16 v[56:71], a[168:171], a[148:151], v[56:71]
  ds_read_b128 a[164:167], v3 offset:25600
  s_waitcnt lgkmcnt(4)
  v_mfma_f32_32x32x16_bf16 v[56:71], a[172:175], a[152:155], v[56:71]
  ds_read_b128 a[168:171], v3 offset:26624
  v_mfma_f32_32x32x16_bf16 v[56:71], a[176:179], a[156:159], v[56:71]
  ds_read_b128 a[172:175], v3 offset:27648
  v_mfma_f32_32x32x16_bf16 v[56:71], a[180:183], v[104:107], v[56:71]
  ds_read_b128 a[176:179], v3 offset:28672
  s_waitcnt lgkmcnt(4)
  v_mfma_f32_32x32x16_bf16 v[72:87], a[184:187], a[0:3], 0
  ds_read_b128 a[180:183], v3 offset:29696
  v_mfma_f32_32x32x16_bf16 v[72:87], a[188:191], a[4:7], v[72:87]
  ds_read_b128 a[184:187], v3 offset:30720
  s_add_u32 s77, s56, 53248
  buffer_load_dwordx4 a[0:3], v1, s[8:11], s77 offen offset:0 sc1
  v_mfma_f32_32x32x16_bf16 v[72:87], a[160:163], a[8:11], v[72:87]
  ds_read_b128 a[188:191], v3 offset:31744
  s_nop 1
  v_mul_f32 v24, v56, v56
  v_mul_f32 v25, v57, v57
  s_waitcnt vmcnt(3)
  s_barrier
  s_waitcnt lgkmcnt(4)
  v_mfma_f32_32x32x16_bf16 v[72:87], a[164:167], a[12:15], v[72:87]
  ds_read_b128 a[160:163], v1 offset:0
  buffer_load_dwordx4 a[4:7], v1, s[8:11], s77 offen offset:1024 sc1
  v_mul_f32 v26, v58, v58
  v_mul_f32 v27, v59, v59
  v_mfma_f32_32x32x16_bf16 v[72:87], a[168:171], a[16:19], v[72:87]
  ds_read_b128 a[164:167], v1 offset:1024
  v_fma_f32 v24, v24, v110, v111
  v_fma_f32 v25, v25, v110, v111
  v_fma_f32 v26, v26, v110, v111
  v_fma_f32 v27, v27, v110, v111
  v_mul_f32 v24, v24, v56
  v_mfma_f32_32x32x16_bf16 v[72:87], a[172:175], a[20:23], v[72:87]
  ds_read_b128 a[168:171], v1 offset:2048
  buffer_load_dwordx4 a[8:11], v1, s[8:11], s77 offen offset:2048 sc1
  v_mul_f32 v25, v25, v57
  s_waitcnt lgkmcnt(4)
  v_mfma_f32_32x32x16_bf16 v[72:87], a[176:179], a[24:27], v[72:87]
  ds_read_b128 a[172:175], v1 offset:3072
  v_mul_f32 v26, v26, v58
  v_mul_f32 v27, v27, v59
  v_exp_f32 v24, v24
  v_mul_f32 v64, v56, v64
  v_mfma_f32_32x32x16_bf16 v[72:87], a[180:183], a[28:31], v[72:87]
  ds_read_b128 a[176:179], v1 offset:4096
  buffer_load_dwordx4 a[12:15], v1, s[8:11], s77 offen offset:3072 sc1
  v_exp_f32 v25, v25
  v_mfma_f32_32x32x16_bf16 v[72:87], a[184:187], a[32:35], v[72:87]
  ds_read_b128 a[180:183], v1 offset:5120
  v_mul_f32 v65, v57, v65
  v_exp_f32 v26, v26
  v_mul_f32 v66, v58, v66
  s_waitcnt lgkmcnt(4)
  v_mfma_f32_32x32x16_bf16 v[72:87], a[188:191], a[36:39], v[72:87]
  ds_read_b128 a[184:187], v1 offset:6144
  s_add_u32 s77, s56, 57344
  buffer_load_dwordx4 a[16:19], v1, s[8:11], s77 offen offset:0 sc1
  v_mfma_f32_32x32x16_bf16 v[72:87], a[160:163], a[40:43], v[72:87]
  ds_read_b128 a[188:191], v1 offset:7168
  v_exp_f32 v27, v27
  v_mul_f32 v67, v59, v67
  v_fma_f32 v24, v24, v108, v108
  v_fma_f32 v25, v25, v108, v108
  v_mfma_f32_32x32x16_bf16 v[72:87], a[164:167], a[44:47], v[72:87]
  ds_read_b128 a[160:163], v1 offset:8192
  buffer_load_dwordx4 a[20:23], v1, s[8:11], s77 offen offset:1024 sc1
  v_fma_f32 v26, v26, v108, v108
  s_waitcnt lgkmcnt(4)
  v_mfma_f32_32x32x16_bf16 v[72:87], a[168:171], a[48:51], v[72:87]
  ds_read_b128 a[164:167], v1 offset:9216
  v_fma_f32 v27, v27, v108, v108
  v_rcp_f32 v24, v24
  v_rcp_f32 v25, v25
  v_mfma_f32_32x32x16_bf16 v[72:87], a[172:175], a[52:55], v[72:87]
  ds_read_b128 a[168:171], v1 offset:10240
  buffer_load_dwordx4 a[24:27], v1, s[8:11], s77 offen offset:2048 sc1
  v_rcp_f32 v26, v26
  v_mfma_f32_32x32x16_bf16 v[72:87], a[176:179], a[56:59], v[72:87]
  ds_read_b128 a[172:175], v1 offset:11264
  v_rcp_f32 v27, v27
  v_mul_f32 v64, v64, v24
  v_mul_f32 v65, v65, v25
  s_waitcnt lgkmcnt(4)
  v_mfma_f32_32x32x16_bf16 v[72:87], a[180:183], a[60:63], v[72:87]
  ds_read_b128 a[176:179], v1 offset:12288
  buffer_load_dwordx4 a[28:31], v1, s[8:11], s77 offen offset:3072 sc1
  v_mfma_f32_32x32x16_bf16 v[72:87], a[184:187], a[64:67], v[72:87]
  ds_read_b128 a[180:183], v1 offset:13312
  s_waitcnt vmcnt(8)
  s_add_u32 s3, s42, 12464128
  s_mov_b64 exec, 1
  s_cmp_lg_u32 s16, 0
  s_cbranch_scc1 HS3
  buffer_store_dword v20, v1, s[8:11], s3 offen
HB3:
  s_mov_b64 exec, -1
  v_mul_f32 v66, v66, v26
  v_mfma_f32_32x32x16_bf16 v[72:87], a[188:191], a[68:71], v[72:87]
  ds_read_b128 a[184:187], v1 offset:14336
  s_add_u32 s77, s56, 61440
  buffer_load_dwordx4 a[32:35], v1, s[8:11], s77 offen offset:0 sc1
  s_waitcnt lgkmcnt(4)
  v_mfma_f32_32x32x16_bf16 v[72:87], a[160:163], a[72:75], v[72:87]
  ds_read_b128 a[188:191], v1 offset:15360
  v_mul_f32 v67, v67, v27
  v_cvt_pk_bf16_f32 v32, v64, v65
  v_cvt_pk_bf16_f32 v33, v66, v67
  v_mul_f32 v24, v60, v60
  v_mul_f32 v25, v61, v61
  v_mfma_f32_32x32x16_bf16 v[72:87], a[164:167], a[76:79], v[72:87]
  ds_read_b128 a[160:163], v1 offset:16384
  buffer_load_dwordx4 a[36:39], v1, s[8:11], s77 offen offset:1024 sc1
  v_mul_f32 v26, v62, v62
  v_mul_f32 v27, v63, v63
  v_mfma_f32_32x32x16_bf16 v[72:87], a[168:171], a[80:83], v[72:87]
  ds_read_b128 a[164:167], v1 offset:17408
  v_fma_f32 v24, v24, v110, v111
  v_fma_f32 v25, v25, v110, v111
  v_fma_f32 v26, v26, v110, v111
  v_fma_f32 v27, v27, v110, v111
  s_waitcnt lgkmcnt(4)
  v_mfma_f32_32x32x16_bf16 v[72:87], a[172:175], a[84:87], v[72:87]
  ds_read_b128 a[168:171], v1 offset:18432
  buffer_load_dwordx4 a[40:43], v1, s[8:11], s77 offen offset:2048 sc1
  v_mul_f32 v24, v24, v60
  v_mul_f32 v25, v25, v61
  v_mfma_f32_32x32x16_bf16 v[72:87], a[176:179], a[88:91], v[72:87]
  ds_read_b128 a[172:175], v1 offset:19456
  v_mul_f32 v26, v26, v62
  v_mul_f32 v27, v27, v63
  v_exp_f32 v24, v24
  v_mul_f32 v68, v60, v68
  v_mfma_f32_32x32x16_bf16 v[72:87], a[180:183], a[92:95], v[72:87]
  ds_read_b128 a[176:179], v1 offset:20480
  buffer_load_dwordx4 a[44:47], v1, s[8:11], s77 offen offset:3072 sc1
  s_waitcnt lgkmcnt(4)
  v_mfma_f32_32x32x16_bf16 v[72:87], a[184:187], a[96:99], v[72:87]
  ds_read_b128 a[180:183], v1 offset:21504
  v_exp_f32 v25, v25
  v_mul_f32 v69, v61, v69
  v_exp_f32 v26, v26
  v_mfma_f32_32x32x16_bf16 v[72:87], a[188:191], a[100:103], v[72:87]
  ds_read_b128 a[184:187], v1 offset:22528
  s_add_u32 s77, s56, 65536
  buffer_load_dwordx4 a[48:51], v1, s[8:11], s77 offen offset:0 sc1
  v_mul_f32 v70, v62, v70
  v_mfma_f32_32x32x16_bf16 v[72:87], a[160:163], a[104:107], v[72:87]
  ds_read_b128 a[188:191], v1 offset:23552
  v_exp_f32 v27, v27
  v_mul_f32 v71, v63, v71
  v_fma_f32 v24, v24, v108, v108
  s_waitcnt lgkmcnt(4)
  v_mfma_f32_32x32x16_bf16 v[72:87], a[164:167], a[108:111], v[72:87]
  ds_read_b128 a[160:163], v1 offset:24576
  buffer_load_dwordx4 a[52:55], v4, s[8:11], s77 offen offset:1024 sc1
  v_fma_f32 v25, v25, v108, v108
  v_fma_f32 v26, v26, v108, v108
  v_mfma_f32_32x32x16_bf16 v[72:87], a[168:171], a[112:115], v[72:87]
  ds_read_b128 a[164:167], v1 offset:25600
  v_fma_f32 v27, v27, v108, v108
  v_rcp_f32 v24, v24
  v_rcp_f32 v25, v25
  v_mfma_f32_32x32x16_bf16 v[72:87], a[172:175], a[116:119], v[72:87]
  ds_read_b128 a[168:171], v1 offset:26624
  buffer_load_dwordx4 a[56:59], v4, s[8:11], s77 offen offset:2048 sc1
  s_waitcnt lgkmcnt(4)
  v_mfma_f32_32x32x16_bf16 v[72:87], a[176:179], a[120:123], v[72:87]
  ds_read_b128 a[172:175], v1 offset:27648
  v_rcp_f32 v26, v26
  v_rcp_f32 v27, v27
  v_mul_f32 v68, v68, v24
  v_mfma_f32_32x32x16_bf16 v[72:87], a[180:183], a[124:127], v[72:87]
  ds_read_b128 a[176:179], v1 offset:28672
  buffer_load_dwordx4 a[60:63], v4, s[8:11], s77 offen offset:3072 sc1
  v_mul_f32 v69, v69, v25
  v_mul_f32 v70, v70, v26
  v_mfma_f32_32x32x16_bf16 v[72:87], a[184:187], a[128:131], v[72:87]
  ds_read_b128 a[180:183], v1 offset:29696
  v_mul_f32 v71, v71, v27
  v_cvt_pk_bf16_f32 v34, v68, v69
  v_cvt_pk_bf16_f32 v35, v70, v71
  s_waitcnt lgkmcnt(4)
  v_mfma_f32_32x32x16_bf16 v[72:87], a[188:191], a[132:135], v[72:87]
  ds_read_b128 a[184:187], v1 offset:30720
  s_add_u32 s77, s56, 69632
  buffer_load_dwordx4 a[64:67], v4, s[8:11], s77 offen offset:0 sc1
  v_mfma_f32_32x32x16_bf16 v[72:87], a[160:163], a[136:139], v[72:87]
  buffer_store_dwordx4 v[32:35], v9, s[8:11], s61 offen offset:0 sc1
  v_mfma_f32_32x32x16_bf16 v[72:87], a[164:167], a[140:143], v[72:87]
  buffer_load_dwordx4 a[68:71], v4, s[8:11], s77 offen offset:1024 sc1
  s_waitcnt lgkmcnt(2)
  v_mfma_f32_32x32x16_bf16 v[72:87], a[168:171], a[144:147], v[72:87]
  v_mfma_f32_32x32x16_bf16 v[72:87], a[172:175], a[148:151], v[72:87]
  v_mfma_f32_32x32x16_bf16 v[72:87], a[176:179], a[152:155], v[72:87]
  s_waitcnt lgkmcnt(0)
  v_mfma_f32_32x32x16_bf16 v[72:87], a[180:183], a[156:159], v[72:87]
  v_mfma_f32_32x32x16_bf16 v[72:87], a[184:187], v[104:107], v[72:87]
  s_add_u32 s70, s45, 12464128
  s_mov_b64 exec, 0xff
  buffer_load_dword v21, v5, s[8:11], s70 offen sc1
  s_mov_b64 exec, -1
  s_barrier
  s_nop 6
  v_pk_mul_f32 v[24:25], v[72:73], v[72:73]
  v_pk_mul_f32 v[26:27], v[74:75], v[74:75]
  v_pk_fma_f32 v[24:25], v[24:25], v[110:111], v[110:111] op_sel:[0,0,1] op_sel_hi:[1,0,1]
  v_pk_fma_f32 v[26:27], v[26:27], v[110:111], v[110:111] op_sel:[0,0,1] op_sel_hi:[1,0,1]
  v_pk_mul_f32 v[24:25], v[24:25], v[72:73]
  v_pk_mul_f32 v[26:27], v[26:27], v[74:75]
  v_exp_f32 v24, v24
  v_exp_f32 v25, v25
  v_exp_f32 v26, v26
  v_exp_f32 v27, v27
  v_pk_mul_f32 v[80:81], v[72:73], v[80:81]
  v_pk_mul_f32 v[82:83], v[74:75], v[82:83]
  v_pk_fma_f32 v[24:25], v[24:25], v[108:109], v[108:109] op_sel:[0,0,0] op_sel_hi:[1,0,0]
  v_pk_fma_f32 v[26:27], v[26:27], v[108:109], v[108:109] op_sel:[0,0,0] op_sel_hi:[1,0,0]
  v_rcp_f32 v24, v24
  v_rcp_f32 v25, v25
  v_rcp_f32 v26, v26
  v_rcp_f32 v27, v27
  v_pk_mul_f32 v[80:81], v[80:81], v[24:25]
  v_pk_mul_f32 v[82:83], v[82:83], v[26:27]
  v_cvt_pk_bf16_f32 v28, v80, v81
  v_cvt_pk_bf16_f32 v29, v82, v83
  s_waitcnt vmcnt(0)
  v_cmp_ne_u32 vcc, v20, v21
  s_nop 3
  s_and_b64 vcc, vcc, 0xff
  s_cbranch_vccnz PHE_SPIN
PHE_OK:
  buffer_load_dwordx4 a[72:75], v1, s[8:11], s50 offen offset:0 sc1
  buffer_load_dwordx4 a[76:79], v1, s[8:11], s50 offen offset:1024 sc1
  buffer_load_dwordx4 a[80:83], v1, s[8:11], s50 offen offset:2048 sc1
  buffer_load_dwordx4 a[84:87], v1, s[8:11], s50 offen offset:3072 sc1
  s_add_u32 s54, s50, 4096
  buffer_load_dwordx4 a[88:91], v1, s[8:11], s54 offen offset:0 sc1
  buffer_load_dwordx4 a[92:95], v1, s[8:11], s54 offen offset:1024 sc1
  v_pk_mul_f32 v[24:25], v[76:77], v[76:77]
  v_pk_mul_f32 v[26:27], v[78:79], v[78:79]
  v_pk_fma_f32 v[24:25], v[24:25], v[110:111], v[110:111] op_sel:[0,0,1] op_sel_hi:[1,0,1]
  v_pk_fma_f32 v[26:27], v[26:27], v[110:111], v[110:111] op_sel:[0,0,1] op_sel_hi:[1,0,1]
  v_pk_mul_f32 v[24:25], v[24:25], v[76:77]
  v_pk_mul_f32 v[26:27], v[26:27], v[78:79]
  v_exp_f32 v24, v24
  v_exp_f32 v25, v25
  v_exp_f32 v26, v26
  v_exp_f32 v27, v27
  v_pk_mul_f32 v[84:85], v[76:77], v[84:85]
  v_pk_mul_f32 v[86:87], v[78:79], v[86:87]
  v_pk_fma_f32 v[24:25], v[24:25], v[108:109], v[108:109] op_sel:[0,0,0] op_sel_hi:[1,0,0]
  v_pk_fma_f32 v[26:27], v[26:27], v[108:109], v[108:109] op_sel:[0,0,0] op_sel_hi:[1,0,0]
  v_rcp_f32 v24, v24
  v_rcp_f32 v25, v25
  v_rcp_f32 v26, v26
  v_rcp_f32 v27, v27
  v_pk_mul_f32 v[84:85], v[84:85], v[24:25]
  v_pk_mul_f32 v[86:87], v[86:87], v[26:27]
  v_cvt_pk_bf16_f32 v30, v84, v85
  v_cvt_pk_bf16_f32 v31, v86, v87
  buffer_store_dwordx4 v[28:31], v9, s[8:11], s61 offen offset:512 sc1
  s_add_u32 s3, s12, 1
  s_and_b32 s3, s3, 3
  s_mul_i32 s3, s3, 15360
  s_add_u32 s3, s3, 102400
  v_add_u32 v106, s3, v1
  s_add_u32 s3, s12, 2
  s_and_b32 s3, s3, 3
  s_mul_i32 s3, s3, 15360
  s_add_u32 s3, s3, 107520
  v_add_u32 v107, s3, v1
  s_add_u32 s3, s12, 3
  s_and_b32 s3, s3, 3
  s_mul_i32 s3, s3, 15360
  s_add_u32 s3, s3, 112640
  v_add_u32 v108, s3, v1
  s_mul_i32 s3, s12, 15360
  s_add_u32 s3, s3, 102400
  v_add_u32 v109, s3, v1
  v_lshlrev_b32 v84, 16, v10
  v_and_b32 v85, 0xffff0000, v10
  v_lshlrev_b32 v86, 16, v11
  v_and_b32 v87, 0xffff0000, v11
  v_lshlrev_b32 v88, 16, v12
  v_and_b32 v89, 0xffff0000, v12
  v_lshlrev_b32 v90, 16, v13
  v_and_b32 v91, 0xffff0000, v13
  v_lshlrev_b32 v92, 16, v14
  v_and_b32 v93, 0xffff0000, v14
  v_lshlrev_b32 v94, 16, v15
  v_and_b32 v95, 0xffff0000, v15
  v_lshlrev_b32 v96, 16, v16
  v_and_b32 v97, 0xffff0000, v16
  v_lshlrev_b32 v98, 16, v17
  v_and_b32 v99, 0xffff0000, v17
  v_lshlrev_b32 v100, 16, v18
  v_and_b32 v101, 0xffff0000, v18
  v_lshlrev_b32 v102, 16, v19
  v_and_b32 v103, 0xffff0000, v19
  s_waitcnt vmcnt(6)
  v_mfma_f32_16x16x32_bf16 v[24:27], v[192:195], a[72:75], 0
  buffer_load_dwordx4 a[96:99], v1, s[8:11], s54 offen offset:2048 sc1
  v_mfma_f32_16x16x32_bf16 v[28:31], v[196:199], a[72:75], 0
  buffer_load_dwordx4 a[100:103], v1, s[8:11], s54 offen offset:3072 sc1
  v_mfma_f32_16x16x32_bf16 v[32:35], v[200:203], a[72:75], 0
  s_add_u32 s54, s50, 8192
  buffer_load_dwordx4 a[104:107], v1, s[8:11], s54 offen offset:0 sc1
  v_mfma_f32_16x16x32_bf16 v[36:39], v[204:207], a[72:75], 0
  v_mfma_f32_16x16x32_bf16 v[40:43], v[208:211], a[72:75], 0
  s_waitcnt vmcnt(8)
  v_mfma_f32_16x16x32_bf16 v[24:27], v[212:215], a[76:79], v[24:27]
  buffer_load_dwordx4 a[108:111], v4, s[8:11], s54 offen offset:1024 sc1
  v_mfma_f32_16x16x32_bf16 v[28:31], v[216:219], a[76:79], v[28:31]
  v_mfma_f32_16x16x32_bf16 v[32:35], v[220:223], a[76:79], v[32:35]
  v_mfma_f32_16x16x32_bf16 v[36:39], v[224:227], a[76:79], v[36:39]
  v_mfma_f32_16x16x32_bf16 v[40:43], v[228:231], a[76:79], v[40:43]
  s_waitcnt vmcnt(8)
  v_mfma_f32_16x16x32_bf16 v[24:27], v[232:235], a[80:83], v[24:27]
  buffer_load_dwordx4 a[112:115], v1, s[8:11], s51 offen offset:0 sc1
  v_mfma_f32_16x16x32_bf16 v[28:31], v[236:239], a[80:83], v[28:31]
  v_mfma_f32_16x16x32_bf16 v[32:35], v[240:243], a[80:83], v[32:35]
  v_mfma_f32_16x16x32_bf16 v[36:39], v[244:247], a[80:83], v[36:39]
  v_mfma_f32_16x16x32_bf16 v[40:43], v[248:251], a[80:83], v[40:43]
  s_waitcnt vmcnt(8)
  v_mfma_f32_16x16x32_bf16 v[24:27], v[252:255], a[84:87], v[24:27]
  s_waitcnt vmcnt(5)
  s_add_u32 s3, s42, 12468224
  s_mov_b64 exec, 1
  s_cmp_lg_u32 s16, 0
  s_cbranch_scc1 HS4
  buffer_store_dword v20, v1, s[8:11], s3 offen
HB4:
  s_mov_b64 exec, -1
  buffer_load_dwordx4 a[116:119], v1, s[8:11], s51 offen offset:1024 sc1
  v_mfma_f32_16x16x32_bf16 v[28:31], a[192:195], a[84:87], v[28:31]
  v_mfma_f32_16x16x32_bf16 v[32:35], a[196:199], a[84:87], v[32:35]
  v_mfma_f32_16x16x32_bf16 v[36:39], a[200:203], a[84:87], v[36:39]
  v_mfma_f32_16x16x32_bf16 v[40:43], a[204:207], a[84:87], v[40:43]
  v_mfma_f32_16x16x32_bf16 v[24:27], a[208:211], a[88:91], v[24:27]
  buffer_load_dwordx4 a[120:123], v1, s[8:11], s51 offen offset:2048 sc1
  v_mfma_f32_16x16x32_bf16 v[28:31], a[212:215], a[88:91], v[28:31]
  v_mfma_f32_16x16x32_bf16 v[32:35], a[216:219], a[88:91], v[32:35]
  v_mfma_f32_16x16x32_bf16 v[36:39], a[220:223], a[88:91], v[36:39]
  v_mfma_f32_16x16x32_bf16 v[40:43], a[224:227], a[88:91], v[40:43]
  v_mfma_f32_16x16x32_bf16 v[24:27], a[228:231], a[92:95], v[24:27]
  buffer_load_dwordx4 a[124:127], v1, s[8:11], s51 offen offset:3072 sc1
  v_mfma_f32_16x16x32_bf16 v[28:31], a[232:235], a[92:95], v[28:31]
  v_mfma_f32_16x16x32_bf16 v[32:35], a[236:239], a[92:95], v[32:35]
  v_mfma_f32_16x16x32_bf16 v[36:39], a[240:243], a[92:95], v[36:39]
  v_mfma_f32_16x16x32_bf16 v[40:43], a[244:247], a[92:95], v[40:43]
  s_waitcnt vmcnt(8)
  v_mfma_f32_16x16x32_bf16 v[24:27], a[248:251], a[96:99], v[24:27]
  s_add_u32 s54, s51, 4096
  buffer_load_dwordx4 a[128:131], v1, s[8:11], s54 offen offset:0 sc1
  v_mfma_f32_16x16x32_bf16 v[28:31], a[252:255], a[96:99], v[28:31]
  v_mfma_f32_16x16x32_bf16 v[32:35], v[160:163], a[96:99], v[32:35]
  v_mfma_f32_16x16x32_bf16 v[36:39], v[164:167], a[96:99], v[36:39]
  v_mfma_f32_16x16x32_bf16 v[40:43], v[168:171], a[96:99], v[40:43]
  s_waitcnt vmcnt(8)
  v_mfma_f32_16x16x32_bf16 v[24:27], v[172:175], a[100:103], v[24:27]
  buffer_load_dwordx4 a[132:135], v1, s[8:11], s54 offen offset:1024 sc1
  v_mfma_f32_16x16x32_bf16 v[28:31], v[176:179], a[100:103], v[28:31]
  v_mfma_f32_16x16x32_bf16 v[32:35], v[180:183], a[100:103], v[32:35]
  v_mfma_f32_16x16x32_bf16 v[36:39], v[184:187], a[100:103], v[36:39]
  v_mfma_f32_16x16x32_bf16 v[40:43], v[188:191], a[100:103], v[40:43]
  s_waitcnt vmcnt(8)
  v_mfma_f32_16x16x32_bf16 v[24:27], v[112:115], a[104:107], v[24:27]
  buffer_load_dwordx4 a[136:139], v1, s[8:11], s54 offen offset:2048 sc1
  v_mfma_f32_16x16x32_bf16 v[28:31], v[116:119], a[104:107], v[28:31]
  v_mfma_f32_16x16x32_bf16 v[32:35], v[120:123], a[104:107], v[32:35]
  v_mfma_f32_16x16x32_bf16 v[36:39], v[124:127], a[104:107], v[36:39]
  v_mfma_f32_16x16x32_bf16 v[40:43], v[128:131], a[104:107], v[40:43]
  s_waitcnt vmcnt(8)
  v_mfma_f32_16x16x32_bf16 v[24:27], v[132:135], a[108:111], v[24:27]
  buffer_load_dwordx4 a[140:143], v1, s[8:11], s54 offen offset:3072 sc1
  v_mfma_f32_16x16x32_bf16 v[28:31], v[136:139], a[108:111], v[28:31]
  v_mfma_f32_16x16x32_bf16 v[32:35], v[140:143], a[108:111], v[32:35]
  v_mfma_f32_16x16x32_bf16 v[36:39], v[144:147], a[108:111], v[36:39]
  v_mfma_f32_16x16x32_bf16 v[40:43], v[148:151], a[108:111], v[40:43]
  s_waitcnt vmcnt(8)
  v_mfma_f32_16x16x32_bf16 v[44:47], v[192:195], a[112:115], 0
  s_add_u32 s54, s51, 8192
  buffer_load_dwordx4 a[144:147], v1, s[8:11], s54 offen offset:0 sc1
  v_mfma_f32_16x16x32_bf16 v[48:51], v[196:199], a[112:115], 0
  v_mfma_f32_16x16x32_bf16 v[52:55], v[200:203], a[112:115], 0
  v_mfma_f32_16x16x32_bf16 v[56:59], v[204:207], a[112:115], 0
  v_mfma_f32_16x16x32_bf16 v[60:63], v[208:211], a[112:115], 0
  s_waitcnt vmcnt(7)
  v_mfma_f32_16x16x32_bf16 v[44:47], v[212:215], a[116:119], v[44:47]
  buffer_load_dwordx4 a[148:151], v4, s[8:11], s54 offen offset:1024 sc1
  v_mfma_f32_16x16x32_bf16 v[48:51], v[216:219], a[116:119], v[48:51]
  v_mfma_f32_16x16x32_bf16 v[52:55], v[220:223], a[116:119], v[52:55]
  v_mfma_f32_16x16x32_bf16 v[56:59], v[224:227], a[116:119], v[56:59]
  v_mfma_f32_16x16x32_bf16 v[60:63], v[228:231], a[116:119], v[60:63]
  s_waitcnt vmcnt(7)
  v_mfma_f32_16x16x32_bf16 v[44:47], v[232:235], a[120:123], v[44:47]
  buffer_load_dwordx4 a[152:155], v1, s[8:11], s52 offen offset:0 sc1
  v_mfma_f32_16x16x32_bf16 v[48:51], v[236:239], a[120:123], v[48:51]
  v_mfma_f32_16x16x32_bf16 v[52:55], v[240:243], a[120:123], v[52:55]
  v_mfma_f32_16x16x32_bf16 v[56:59], v[244:247], a[120:123], v[56:59]
  v_mfma_f32_16x16x32_bf16 v[60:63], v[248:251], a[120:123], v[60:63]
  s_waitcnt vmcnt(7)
  v_mfma_f32_16x16x32_bf16 v[44:47], v[252:255], a[124:127], v[44:47]
  buffer_load_dwordx4 a[156:159], v1, s[8:11], s52 offen offset:1024 sc1
  v_mfma_f32_16x16x32_bf16 v[48:51], a[192:195], a[124:127], v[48:51]
  v_mfma_f32_16x16x32_bf16 v[52:55], a[196:199], a[124:127], v[52:55]
  v_mfma_f32_16x16x32_bf16 v[56:59], a[200:203], a[124:127], v[56:59]
  v_mfma_f32_16x16x32_bf16 v[60:63], a[204:207], a[124:127], v[60:63]
  s_waitcnt vmcnt(7)
  v_mfma_f32_16x16x32_bf16 v[44:47], a[208:211], a[128:131], v[44:47]
  buffer_load_dwordx4 a[160:163], v1, s[8:11], s52 offen offset:2048 sc1
  v_mfma_f32_16x16x32_bf16 v[48:51], a[212:215], a[128:131], v[48:51]
  v_mfma_f32_16x16x32_bf16 v[52:55], a[216:219], a[128:131], v[52:55]
  v_mfma_f32_16x16x32_bf16 v[56:59], a[220:223], a[128:131], v[56:59]
  v_mfma_f32_16x16x32_bf16 v[60:63], a[224:227], a[128:131], v[60:63]
  s_waitcnt vmcnt(7)
  v_mfma_f32_16x16x32_bf16 v[44:47], a[228:231], a[132:135], v[44:47]
  buffer_load_dwordx4 a[164:167], v1, s[8:11], s52 offen offset:3072 sc1
  v_mfma_f32_16x16x32_bf16 v[48:51], a[232:235], a[132:135], v[48:51]
  v_mfma_f32_16x16x32_bf16 v[52:55], a[236:239], a[132:135], v[52:55]
  v_mfma_f32_16x16x32_bf16 v[56:59], a[240:243], a[132:135], v[56:59]
  v_mfma_f32_16x16x32_bf16 v[60:63], a[244:247], a[132:135], v[60:63]
  s_waitcnt vmcnt(7)
  v_mfma_f32_16x16x32_bf16 v[44:47], a[248:251], a[136:139], v[44:47]
  s_add_u32 s54, s52, 4096
  buffer_load_dwordx4 a[168:171], v1, s[8:11], s54 offen offset:0 sc1
  v_mfma_f32_16x16x32_bf16 v[48:51], a[252:255], a[136:139], v[48:51]
  v_mfma_f32_16x16x32_bf16 v[52:55], v[160:163], a[136:139], v[52:55]
  v_mfma_f32_16x16x32_bf16 v[56:59], v[164:167], a[136:139], v[56:59]
  v_mfma_f32_16x16x32_bf16 v[60:63], v[168:171], a[136:139], v[60:63]
  s_waitcnt vmcnt(7)
  v_mfma_f32_16x16x32_bf16 v[44:47], v[172:175], a[140:143], v[44:47]
  buffer_load_dwordx4 a[172:175], v1, s[8:11], s54 offen offset:1024 sc1
  v_mfma_f32_16x16x32_bf16 v[48:51], v[176:179], a[140:143], v[48:51]
  v_mfma_f32_16x16x32_bf16 v[52:55], v[180:183], a[140:143], v[52:55]
  v_mfma_f32_16x16x32_bf16 v[56:59], v[184:187], a[140:143], v[56:59]
  v_mfma_f32_16x16x32_bf16 v[60:63], v[188:191], a[140:143], v[60:63]
  s_waitcnt vmcnt(7)
  v_mfma_f32_16x16x32_bf16 v[44:47], v[112:115], a[144:147], v[44:47]
  buffer_load_dwordx4 a[176:179], v1, s[8:11], s54 offen offset:2048 sc1
  v_mfma_f32_16x16x32_bf16 v[48:51], v[116:119], a[144:147], v[48:51]
  v_mfma_f32_16x16x32_bf16 v[52:55], v[120:123], a[144:147], v[52:55]
  s_add_u32 s70, s45, 12468224
  s_mov_b64 exec, 0xff
  buffer_load_dword v21, v5, s[8:11], s70 offen sc1
  s_mov_b64 exec, -1
  v_mfma_f32_16x16x32_bf16 v[56:59], v[124:127], a[144:147], v[56:59]
  v_mfma_f32_16x16x32_bf16 v[60:63], v[128:131], a[144:147], v[60:63]
  s_waitcnt vmcnt(8)
  v_mfma_f32_16x16x32_bf16 v[44:47], v[132:135], a[148:151], v[44:47]
  buffer_load_dwordx4 a[180:183], v1, s[8:11], s54 offen offset:3072 sc1
  v_mfma_f32_16x16x32_bf16 v[48:51], v[136:139], a[148:151], v[48:51]
  v_mfma_f32_16x16x32_bf16 v[52:55], v[140:143], a[148:151], v[52:55]
  v_mfma_f32_16x16x32_bf16 v[56:59], v[144:147], a[148:151], v[56:59]
  v_mfma_f32_16x16x32_bf16 v[60:63], v[148:151], a[148:151], v[60:63]
  s_waitcnt vmcnt(8)
  v_mfma_f32_16x16x32_bf16 v[64:67], v[192:195], a[152:155], 0
  s_add_u32 s54, s52, 8192
  buffer_load_dwordx4 a[184:187], v1, s[8:11], s54 offen offset:0 sc1
  v_mfma_f32_16x16x32_bf16 v[68:71], v[196:199], a[152:155], 0
  v_mfma_f32_16x16x32_bf16 v[72:75], v[200:203], a[152:155], 0
  v_mfma_f32_16x16x32_bf16 v[76:79], v[204:207], a[152:155], 0
  v_mfma_f32_16x16x32_bf16 v[80:83], v[208:211], a[152:155], 0
  s_waitcnt vmcnt(8)
  v_mfma_f32_16x16x32_bf16 v[64:67], v[212:215], a[156:159], v[64:67]
  buffer_load_dwordx4 a[188:191], v4, s[8:11], s54 offen offset:1024 sc1
  v_mfma_f32_16x16x32_bf16 v[68:71], v[216:219], a[156:159], v[68:71]
  v_mfma_f32_16x16x32_bf16 v[72:75], v[220:223], a[156:159], v[72:75]
  v_mfma_f32_16x16x32_bf16 v[76:79], v[224:227], a[156:159], v[76:79]
  v_mfma_f32_16x16x32_bf16 v[80:83], v[228:231], a[156:159], v[80:83]
  s_waitcnt vmcnt(8)
  v_mfma_f32_16x16x32_bf16 v[64:67], v[232:235], a[160:163], v[64:67]
  v_mfma_f32_16x16x32_bf16 v[68:71], v[236:239], a[160:163], v[68:71]
  v_mfma_f32_16x16x32_bf16 v[72:75], v[240:243], a[160:163], v[72:75]
  v_mfma_f32_16x16x32_bf16 v[76:79], v[244:247], a[160:163], v[76:79]
  v_mfma_f32_16x16x32_bf16 v[80:83], v[248:251], a[160:163], v[80:83]
  s_waitcnt vmcnt(7)
  v_mfma_f32_16x16x32_bf16 v[64:67], v[252:255], a[164:167], v[64:67]
  v_mfma_f32_16x16x32_bf16 v[68:71], a[192:195], a[164:167], v[68:71]
  s_waitcnt vmcnt(3)
  v_cmp_ne_u32 vcc, v20, v21
  s_nop 3
  s_and_b64 vcc, vcc, 0xff
  s_cbranch_vccnz PHL_SPIN
PHL_OK:
  s_add_u32 s54, s50, 8192
  buffer_load_dwordx4 a[72:75], v1, s[8:11], s54 offen offset:2048 sc1
  v_mfma_f32_16x16x32_bf16 v[72:75], a[196:199], a[164:167], v[72:75]
  buffer_load_dwordx4 a[76:79], v1, s[8:11], s54 offen offset:3072 sc1
  v_mfma_f32_16x16x32_bf16 v[76:79], a[200:203], a[164:167], v[76:79]
  v_mfma_f32_16x16x32_bf16 v[80:83], a[204:207], a[164:167], v[80:83]
  v_mfma_f32_16x16x32_bf16 v[64:67], a[208:211], a[168:171], v[64:67]
  s_add_u32 s54, s50, 12288
  buffer_load_dwordx4 a[80:83], v1, s[8:11], s54 offen offset:0 sc1
  v_mfma_f32_16x16x32_bf16 v[68:71], a[212:215], a[168:171], v[68:71]
  v_mfma_f32_16x16x32_bf16 v[72:75], a[216:219], a[168:171], v[72:75]
  v_mfma_f32_16x16x32_bf16 v[76:79], a[220:223], a[168:171], v[76:79]
  v_mfma_f32_16x16x32_bf16 v[80:83], a[224:227], a[168:171], v[80:83]
  v_mfma_f32_16x16x32_bf16 v[64:67], a[228:231], a[172:175], v[64:67]
  buffer_load_dwordx4 a[84:87], v4, s[8:11], s54 offen offset:1024 sc1
  v_mfma_f32_16x16x32_bf16 v[68:71], a[232:235], a[172:175], v[68:71]
  v_mfma_f32_16x16x32_bf16 v[72:75], a[236:239], a[172:175], v[72:75]
  v_mfma_f32_16x16x32_bf16 v[76:79], a[240:243], a[172:175], v[76:79]
  v_mfma_f32_16x16x32_bf16 v[80:83], a[244:247], a[172:175], v[80:83]
  v_mfma_f32_16x16x32_bf16 v[64:67], a[248:251], a[176:179], v[64:67]
  s_add_u32 s54, s51, 8192
  buffer_load_dwordx4 a[88:91], v1, s[8:11], s54 offen offset:2048 sc1
  v_mfma_f32_16x16x32_bf16 v[68:71], a[252:255], a[176:179], v[68:71]
  v_mfma_f32_16x16x32_bf16 v[72:75], v[160:163], a[176:179], v[72:75]
  v_mfma_f32_16x16x32_bf16 v[76:79], v[164:167], a[176:179], v[76:79]
  v_mfma_f32_16x16x32_bf16 v[80:83], v[168:171], a[176:179], v[80:83]
  s_waitcnt vmcnt(7)
  v_mfma_f32_16x16x32_bf16 v[64:67], v[172:175], a[180:183], v[64:67]
  buffer_load_dwordx4 a[92:95], v1, s[8:11], s54 offen offset:3072 sc1
  v_mfma_f32_16x16x32_bf16 v[68:71], v[176:179], a[180:183], v[68:71]
  v_mfma_f32_16x16x32_bf16 v[72:75], v[180:183], a[180:183], v[72:75]
  v_mfma_f32_16x16x32_bf16 v[76:79], v[184:187], a[180:183], v[76:79]
  v_mfma_f32_16x16x32_bf16 v[80:83], v[188:191], a[180:183], v[80:83]
  s_waitcnt vmcnt(7)
  v_mfma_f32_16x16x32_bf16 v[64:67], v[112:115], a[184:187], v[64:67]
  s_add_u32 s54, s51, 12288
  buffer_load_dwordx4 a[96:99], v1, s[8:11], s54 offen offset:0 sc1
  v_mfma_f32_16x16x32_bf16 v[68:71], v[116:119], a[184:187], v[68:71]
  v_mfma_f32_16x16x32_bf16 v[72:75], v[120:123], a[184:187], v[72:75]
  v_mfma_f32_16x16x32_bf16 v[76:79], v[124:127], a[184:187], v[76:79]
  v_mfma_f32_16x16x32_bf16 v[80:83], v[128:131], a[184:187], v[80:83]
  s_waitcnt vmcnt(7)
  v_mfma_f32_16x16x32_bf16 v[64:67], v[132:135], a[188:191], v[64:67]
  buffer_load_dwordx4 a[100:103], v4, s[8:11], s54 offen offset:1024 sc1
  v_mfma_f32_16x16x32_bf16 v[68:71], v[136:139], a[188:191], v[68:71]
  v_mfma_f32_16x16x32_bf16 v[72:75], v[140:143], a[188:191], v[72:75]
  v_mfma_f32_16x16x32_bf16 v[76:79], v[144:147], a[188:191], v[76:79]
  v_mfma_f32_16x16x32_bf16 v[80:83], v[148:151], a[188:191], v[80:83]
  s_waitcnt vmcnt(7)
  v_mfma_f32_16x16x32_bf16 v[24:27], v[152:155], a[72:75], v[24:27]
  s_add_u32 s54, s52, 8192
  buffer_load_dwordx4 a[104:107], v1, s[8:11], s54 offen offset:2048 sc1
  v_mfma_f32_16x16x32_bf16 v[28:31], v[156:159], a[72:75], v[28:31]
  v_mfma_f32_16x16x32_bf16 v[32:35], a[0:3], a[72:75], v[32:35]
  v_mfma_f32_16x16x32_bf16 v[36:39], a[4:7], a[72:75], v[36:39]
  v_mfma_f32_16x16x32_bf16 v[40:43], a[8:11], a[72:75], v[40:43]
  s_waitcnt vmcnt(7)
  v_mfma_f32_16x16x32_bf16 v[24:27], a[12:15], a[76:79], v[24:27]
  buffer_load_dwordx4 a[108:111], v1, s[8:11], s54 offen offset:3072 sc1
  v_mfma_f32_16x16x32_bf16 v[28:31], a[16:19], a[76:79], v[28:31]
  v_mfma_f32_16x16x32_bf16 v[32:35], a[20:23], a[76:79], v[32:35]
  v_mfma_f32_16x16x32_bf16 v[36:39], a[24:27], a[76:79], v[36:39]
  v_mfma_f32_16x16x32_bf16 v[40:43], a[28:31], a[76:79], v[40:43]
  s_waitcnt vmcnt(7)
  v_mfma_f32_16x16x32_bf16 v[24:27], a[32:35], a[80:83], v[24:27]
  s_add_u32 s54, s52, 12288
  buffer_load_dwordx4 a[112:115], v1, s[8:11], s54 offen offset:0 sc1
  v_mfma_f32_16x16x32_bf16 v[28:31], a[36:39], a[80:83], v[28:31]
  v_mfma_f32_16x16x32_bf16 v[32:35], a[40:43], a[80:83], v[32:35]
  v_mfma_f32_16x16x32_bf16 v[36:39], a[44:47], a[80:83], v[36:39]
  v_mfma_f32_16x16x32_bf16 v[40:43], a[48:51], a[80:83], v[40:43]
  s_waitcnt vmcnt(7)
  v_mfma_f32_16x16x32_bf16 v[24:27], a[52:55], a[84:87], v[24:27]
  buffer_load_dwordx4 a[116:119], v4, s[8:11], s54 offen offset:1024 sc1
  v_mfma_f32_16x16x32_bf16 v[28:31], a[56:59], a[84:87], v[28:31]
  v_mfma_f32_16x16x32_bf16 v[32:35], a[60:63], a[84:87], v[32:35]
  v_mfma_f32_16x16x32_bf16 v[36:39], a[64:67], a[84:87], v[36:39]
  v_mfma_f32_16x16x32_bf16 v[40:43], a[68:71], a[84:87], v[40:43]
  s_waitcnt vmcnt(7)
  v_mfma_f32_16x16x32_bf16 v[44:47], v[152:155], a[88:91], v[44:47]
  buffer_load_dwordx4 a[120:123], v1, s[8:11], s53 offen offset:0 sc1
  v_mfma_f32_16x16x32_bf16 v[48:51], v[156:159], a[88:91], v[48:51]
  v_mfma_f32_16x16x32_bf16 v[52:55], a[0:3], a[88:91], v[52:55]
  ds_write_b128 v106, v[24:27] offset:0
  v_mfma_f32_16x16x32_bf16 v[56:59], a[4:7], a[88:91], v[56:59]
  v_mfma_f32_16x16x32_bf16 v[60:63], a[8:11], a[88:91], v[60:63]
  ds_write_b128 v106, v[28:31] offset:1024
  s_waitcnt vmcnt(7)
  v_mfma_f32_16x16x32_bf16 v[44:47], a[12:15], a[92:95], v[44:47]
  buffer_load_dwordx4 a[124:127], v1, s[8:11], s53 offen offset:1024 sc1
  v_mfma_f32_16x16x32_bf16 v[48:51], a[16:19], a[92:95], v[48:51]
  ds_write_b128 v106, v[32:35] offset:2048
  v_mfma_f32_16x16x32_bf16 v[52:55], a[20:23], a[92:95], v[52:55]
  v_mfma_f32_16x16x32_bf16 v[56:59], a[24:27], a[92:95], v[56:59]
  ds_write_b128 v106, v[36:39] offset:3072
  v_mfma_f32_16x16x32_bf16 v[60:63], a[28:31], a[92:95], v[60:63]
  s_waitcnt vmcnt(7)
  v_mfma_f32_16x16x32_bf16 v[44:47], a[32:35], a[96:99], v[44:47]
  buffer_load_dwordx4 a[128:131], v1, s[8:11], s53 offen offset:2048 sc1
  v_mfma_f32_16x16x32_bf16 v[48:51], a[36:39], a[96:99], v[48:51]
  ds_write_b128 v106, v[40:43] offset:4096
  v_mfma_f32_16x16x32_bf16 v[52:55], a[40:43], a[96:99], v[52:55]
  v_mfma_f32_16x16x32_bf16 v[56:59], a[44:47], a[96:99], v[56:59]
  v_mfma_f32_16x16x32_bf16 v[60:63], a[48:51], a[96:99], v[60:63]
  s_waitcnt vmcnt(7)
  v_mfma_f32_16x16x32_bf16 v[44:47], a[52:55], a[100:103], v[44:47]
  buffer_load_dwordx4 a[132:135], v1, s[8:11], s53 offen offset:3072 sc1
  v_mfma_f32_16x16x32_bf16 v[48:51], a[56:59], a[100:103], v[48:51]
  v_mfma_f32_16x16x32_bf16 v[52:55], a[60:63], a[100:103], v[52:55]
  v_mfma_f32_16x16x32_bf16 v[56:59], a[64:67], a[100:103], v[56:59]
  v_mfma_f32_16x16x32_bf16 v[60:63], a[68:71], a[100:103], v[60:63]
  s_waitcnt vmcnt(7)
  v_mfma_f32_16x16x32_bf16 v[64:67], v[152:155], a[104:107], v[64:67]
  s_add_u32 s54, s53, 4096
  buffer_load_dwordx4 a[136:139], v1, s[8:11], s54 offen offset:0 sc1
  v_mfma_f32_16x16x32_bf16 v[68:71], v[156:159], a[104:107], v[68:71]
  v_mfma_f32_16x16x32_bf16 v[72:75], a[0:3], a[104:107], v[72:75]
  ds_write_b128 v107, v[44:47] offset:0
  v_mfma_f32_16x16x32_bf16 v[76:79], a[4:7], a[104:107], v[76:79]
  v_mfma_f32_16x16x32_bf16 v[80:83], a[8:11], a[104:107], v[80:83]
  ds_write_b128 v107, v[48:51] offset:1024
  s_waitcnt vmcnt(7)
  v_mfma_f32_16x16x32_bf16 v[64:67], a[12:15], a[108:111], v[64:67]
  buffer_load_dwordx4 a[140:143], v1, s[8:11], s54 offen offset:1024 sc1
  v_mfma_f32_16x16x32_bf16 v[68:71], a[16:19], a[108:111], v[68:71]
  ds_write_b128 v107, v[52:55] offset:2048
  v_mfma_f32_16x16x32_bf16 v[72:75], a[20:23], a[108:111], v[72:75]
  v_mfma_f32_16x16x32_bf16 v[76:79], a[24:27], a[108:111], v[76:79]
  ds_write_b128 v107, v[56:59] offset:3072
  v_mfma_f32_16x16x32_bf16 v[80:83], a[28:31], a[108:111], v[80:83]
  s_waitcnt vmcnt(7)
  v_mfma_f32_16x16x32_bf16 v[64:67], a[32:35], a[112:115], v[64:67]
  buffer_load_dwordx4 a[144:147], v1, s[8:11], s54 offen offset:2048 sc1
  v_mfma_f32_16x16x32_bf16 v[68:71], a[36:39], a[112:115], v[68:71]
  ds_write_b128 v107, v[60:63] offset:4096
  v_mfma_f32_16x16x32_bf16 v[72:75], a[40:43], a[112:115], v[72:75]
  v_mfma_f32_16x16x32_bf16 v[76:79], a[44:47], a[112:115], v[76:79]
  v_mfma_f32_16x16x32_bf16 v[80:83], a[48:51], a[112:115], v[80:83]
  s_waitcnt vmcnt(7)
  v_mfma_f32_16x16x32_bf16 v[64:67], a[52:55], a[116:119], v[64:67]
  buffer_load_dwordx4 a[148:151], v1, s[8:11], s54 offen offset:3072 sc1
  v_mfma_f32_16x16x32_bf16 v[68:71], a[56:59], a[116:119], v[68:71]
  v_mfma_f32_16x16x32_bf16 v[72:75], a[60:63], a[116:119], v[72:75]
  v_mfma_f32_16x16x32_bf16 v[76:79], a[64:67], a[116:119], v[76:79]
  v_mfma_f32_16x16x32_bf16 v[80:83], a[68:71], a[116:119], v[80:83]
  s_waitcnt vmcnt(7)
  v_mfma_f32_16x16x32_bf16 v[24:27], v[192:195], a[120:123], 0
  s_add_u32 s54, s53, 8192
  buffer_load_dwordx4 a[152:155], v1, s[8:11], s54 offen offset:0 sc1
  v_mfma_f32_16x16x32_bf16 v[28:31], v[196:199], a[120:123], 0
  v_mfma_f32_16x16x32_bf16 v[32:35], v[200:203], a[120:123], 0
  ds_write_b128 v108, v[64:67] offset:0
  v_mfma_f32_16x16x32_bf16 v[36:39], v[204:207], a[120:123], 0
  v_mfma_f32_16x16x32_bf16 v[40:43], v[208:211], a[120:123], 0
  ds_write_b128 v108, v[68:71] offset:1024
  s_waitcnt vmcnt(7)
  v_mfma_f32_16x16x32_bf16 v[24:27], v[212:215], a[124:127], v[24:27]
  buffer_load_dwordx4 a[156:159], v4, s[8:11], s54 offen offset:1024 sc1
  v_mfma_f32_16x16x32_bf16 v[28:31], v[216:219], a[124:127], v[28:31]
  ds_write_b128 v108, v[72:75] offset:2048
  v_mfma_f32_16x16x32_bf16 v[32:35], v[220:223], a[124:127], v[32:35]
  v_mfma_f32_16x16x32_bf16 v[36:39], v[224:227], a[124:127], v[36:39]
  ds_write_b128 v108, v[76:79] offset:3072
  v_mfma_f32_16x16x32_bf16 v[40:43], v[228:231], a[124:127], v[40:43]
  s_waitcnt vmcnt(7)
  v_mfma_f32_16x16x32_bf16 v[24:27], v[232:235], a[128:131], v[24:27]
  buffer_load_dwordx4 a[160:163], v1, s[8:11], s54 offen offset:2048 sc1
  v_mfma_f32_16x16x32_bf16 v[28:31], v[236:239], a[128:131], v[28:31]
  ds_write_b128 v108, v[80:83] offset:4096
  v_mfma_f32_16x16x32_bf16 v[32:35], v[240:243], a[128:131], v[32:35]
  v_mfma_f32_16x16x32_bf16 v[36:39], v[244:247], a[128:131], v[36:39]
  v_mfma_f32_16x16x32_bf16 v[40:43], v[248:251], a[128:131], v[40:43]
  s_waitcnt vmcnt(7)
  v_mfma_f32_16x16x32_bf16 v[24:27], v[252:255], a[132:135], v[24:27]
  buffer_load_dwordx4 a[164:167], v1, s[8:11], s54 offen offset:3072 sc1
  v_mfma_f32_16x16x32_bf16 v[28:31], a[192:195], a[132:135], v[28:31]
  s_add_u32 m0, s27, 0
  s_add_u32 s34, s30, 0
  buffer_load_dwordx4 v1, s[8:11], s34 offen offset:0 sc1 lds
  v_mfma_f32_16x16x32_bf16 v[32:35], a[196:199], a[132:135], v[32:35]
  v_mfma_f32_16x16x32_bf16 v[36:39], a[200:203], a[132:135], v[36:39]
  buffer_load_dwordx4 v1, s[8:11], s34 offen offset:1024 sc1 lds
  v_mfma_f32_16x16x32_bf16 v[40:43], a[204:207], a[132:135], v[40:43]
  s_waitcnt vmcnt(9)
  v_mfma_f32_16x16x32_bf16 v[24:27], a[208:211], a[136:139], v[24:27]
  s_add_u32 s54, s53, 12288
  buffer_load_dwordx4 a[168:171], v1, s[8:11], s54 offen offset:0 sc1
  v_mfma_f32_16x16x32_bf16 v[28:31], a[212:215], a[136:139], v[28:31]
  buffer_load_dwordx4 v1, s[8:11], s34 offen offset:2048 sc1 lds
  v_mfma_f32_16x16x32_bf16 v[32:35], a[216:219], a[136:139], v[32:35]
  s_waitcnt lgkmcnt(0)
  s_barrier
  v_mfma_f32_16x16x32_bf16 v[36:39], a[220:223], a[136:139], v[36:39]
  ds_read_b128 v[44:47], v109 offset:0
  ds_read_b128 v[48:51], v109 offset:1024
  v_mfma_f32_16x16x32_bf16 v[40:43], a[224:227], a[136:139], v[40:43]
  buffer_load_dwordx4 v1, s[8:11], s34 offen offset:3072 sc1 lds
  s_waitcnt vmcnt(11)
  v_mfma_f32_16x16x32_bf16 v[24:27], a[228:231], a[140:143], v[24:27]
  buffer_load_dwordx4 a[172:175], v4, s[8:11], s54 offen offset:1024 sc1
  v_mfma_f32_16x16x32_bf16 v[28:31], a[232:235], a[140:143], v[28:31]
  ds_read_b128 v[52:55], v109 offset:2048
  ds_read_b128 v[56:59], v109 offset:3072
  v_mfma_f32_16x16x32_bf16 v[32:35], a[236:239], a[140:143], v[32:35]
  s_add_u32 m0, s27, 4096
  s_add_u32 s34, s30, 4096
  buffer_load_dwordx4 v1, s[8:11], s34 offen offset:0 sc1 lds
  v_mfma_f32_16x16x32_bf16 v[36:39], a[240:243], a[140:143], v[36:39]
  ds_read_b128 v[60:63], v109 offset:4096
  ds_read_b128 v[64:67], v109 offset:5120
  v_mfma_f32_16x16x32_bf16 v[40:43], a[244:247], a[140:143], v[40:43]
  ds_read_b128 v[68:71], v109 offset:6144
  ds_read_b128 v[72:75], v109 offset:7168
  s_waitcnt vmcnt(12)
  v_mfma_f32_16x16x32_bf16 v[24:27], a[248:251], a[144:147], v[24:27]
  buffer_load_dwordx4 v1, s[8:11], s34 offen offset:1024 sc1 lds
  v_mfma_f32_16x16x32_bf16 v[28:31], a[252:255], a[144:147], v[28:31]
  ds_read_b128 v[76:79], v109 offset:8192
  ds_read_b128 v[80:83], v109 offset:9216
  v_mfma_f32_16x16x32_bf16 v[32:35], v[160:163], a[144:147], v[32:35]
  v_mfma_f32_16x16x32_bf16 v[36:39], v[164:167], a[144:147], v[36:39]
  buffer_load_dwordx4 v1, s[8:11], s34 offen offset:2048 sc1 lds
  v_mfma_f32_16x16x32_bf16 v[40:43], v[168:171], a[144:147], v[40:43]
  s_waitcnt vmcnt(13)
  v_mfma_f32_16x16x32_bf16 v[24:27], v[172:175], a[148:151], v[24:27]
  v_mfma_f32_16x16x32_bf16 v[28:31], v[176:179], a[148:151], v[28:31]
  buffer_load_dwordx4 v1, s[8:11], s34 offen offset:3072 sc1 lds
  v_mfma_f32_16x16x32_bf16 v[32:35], v[180:183], a[148:151], v[32:35]
  s_waitcnt lgkmcnt(9)
  v_add_f32 v84, v84, v44
  v_add_f32 v85, v85, v45
  v_mfma_f32_16x16x32_bf16 v[36:39], v[184:187], a[148:151], v[36:39]
  v_add_f32 v86, v86, v46
  v_add_f32 v87, v87, v47
  v_mfma_f32_16x16x32_bf16 v[40:43], v[188:191], a[148:151], v[40:43]
  s_add_u32 m0, s27, 32768
  s_add_u32 s34, s30, 32768
  buffer_load_dwordx4 v1, s[8:11], s34 offen offset:0 sc1 lds
  s_waitcnt vmcnt(14)
  v_mfma_f32_16x16x32_bf16 v[24:27], v[112:115], a[152:155], v[24:27]
  s_waitcnt lgkmcnt(8)
  v_add_f32 v88, v88, v48
  v_add_f32 v89, v89, v49
  v_mfma_f32_16x16x32_bf16 v[28:31], v[116:119], a[152:155], v[28:31]
  v_add_f32 v90, v90, v50
  v_add_f32 v91, v91, v51
  v_mfma_f32_16x16x32_bf16 v[32:35], v[120:123], a[152:155], v[32:35]
  buffer_load_dwordx4 v1, s[8:11], s34 offen offset:1024 sc1 lds
  v_mfma_f32_16x16x32_bf16 v[36:39], v[124:127], a[152:155], v[36:39]
  s_waitcnt lgkmcnt(7)
  v_add_f32 v92, v92, v52
  v_add_f32 v93, v93, v53
  v_mfma_f32_16x16x32_bf16 v[40:43], v[128:131], a[152:155], v[40:43]
  v_add_f32 v94, v94, v54
  v_add_f32 v95, v95, v55
  s_waitcnt vmcnt(14)
  v_mfma_f32_16x16x32_bf16 v[24:27], v[132:135], a[156:159], v[24:27]
  buffer_load_dwordx4 v1, s[8:11], s34 offen offset:2048 sc1 lds
  v_mfma_f32_16x16x32_bf16 v[28:31], v[136:139], a[156:159], v[28:31]
  s_waitcnt lgkmcnt(6)
  v_add_f32 v96, v96, v56
  v_add_f32 v97, v97, v57
  v_mfma_f32_16x16x32_bf16 v[32:35], v[140:143], a[156:159], v[32:35]
  v_add_f32 v98, v98, v58
  v_add_f32 v99, v99, v59
  v_mfma_f32_16x16x32_bf16 v[36:39], v[144:147], a[156:159], v[36:39]
  buffer_load_dwordx4 v1, s[8:11], s34 offen offset:3072 sc1 lds
  v_mfma_f32_16x16x32_bf16 v[40:43], v[148:151], a[156:159], v[40:43]
  s_waitcnt lgkmcnt(5)
  v_add_f32 v100, v100, v60
  v_add_f32 v101, v101, v61
  s_waitcnt vmcnt(15)
  v_mfma_f32_16x16x32_bf16 v[24:27], v[152:155], a[160:163], v[24:27]
  v_add_f32 v102, v102, v62
  v_add_f32 v103, v103, v63
  v_mfma_f32_16x16x32_bf16 v[28:31], v[156:159], a[160:163], v[28:31]
  s_add_u32 m0, s27, 36864
  s_add_u32 s34, s30, 36864
  buffer_load_dwordx4 v1, s[8:11], s34 offen offset:0 sc1 lds
  v_mfma_f32_16x16x32_bf16 v[32:35], a[0:3], a[160:163], v[32:35]
  ds_read_b128 v[44:47], v109 offset:10240
  ds_read_b128 v[48:51], v109 offset:11264
  v_mfma_f32_16x16x32_bf16 v[36:39], a[4:7], a[160:163], v[36:39]
  ds_read_b128 v[52:55], v109 offset:12288
  ds_read_b128 v[56:59], v109 offset:13312
  v_mfma_f32_16x16x32_bf16 v[40:43], a[8:11], a[160:163], v[40:43]
  buffer_load_dwordx4 v1, s[8:11], s34 offen offset:1024 sc1 lds
  s_waitcnt vmcnt(16)
  v_mfma_f32_16x16x32_bf16 v[24:27], a[12:15], a[164:167], v[24:27]
  ds_read_b128 v[60:63], v109 offset:14336
  s_waitcnt lgkmcnt(9)
  v_add_f32 v84, v84, v64
  v_mfma_f32_16x16x32_bf16 v[28:31], a[16:19], a[164:167], v[28:31]
  v_add_f32 v85, v85, v65
  v_add_f32 v86, v86, v66
  v_mfma_f32_16x16x32_bf16 v[32:35], a[20:23], a[164:167], v[32:35]
  buffer_load_dwordx4 v1, s[8:11], s34 offen offset:2048 sc1 lds
  v_mfma_f32_16x16x32_bf16 v[36:39], a[24:27], a[164:167], v[36:39]
  v_add_f32 v87, v87, v67
  s_waitcnt lgkmcnt(8)
  v_add_f32 v88, v88, v68
  v_mfma_f32_16x16x32_bf16 v[40:43], a[28:31], a[164:167], v[40:43]
  v_add_f32 v89, v89, v69
  v_add_f32 v90, v90, v70
  s_waitcnt vmcnt(14)
  v_mfma_f32_16x16x32_bf16 v[24:27], a[32:35], a[168:171], v[24:27]
  buffer_load_dwordx4 v1, s[8:11], s34 offen offset:3072 sc1 lds
  v_mfma_f32_16x16x32_bf16 v[28:31], a[36:39], a[168:171], v[28:31]
  v_add_f32 v91, v91, v71
  s_waitcnt lgkmcnt(7)
  v_add_f32 v92, v92, v72
  v_mfma_f32_16x16x32_bf16 v[32:35], a[40:43], a[168:171], v[32:35]
  v_add_f32 v93, v93, v73
  v_add_f32 v94, v94, v74
  v_mfma_f32_16x16x32_bf16 v[36:39], a[44:47], a[168:171], v[36:39]
  v_add_f32 v95, v95, v75
  s_waitcnt lgkmcnt(6)
  v_add_f32 v96, v96, v76
  v_mfma_f32_16x16x32_bf16 v[40:43], a[48:51], a[168:171], v[40:43]
  v_add_f32 v97, v97, v77
  v_add_f32 v98, v98, v78
  s_waitcnt vmcnt(12)
  v_mfma_f32_16x16x32_bf16 v[24:27], a[52:55], a[172:175], v[24:27]
  v_add_f32 v99, v99, v79
  s_waitcnt lgkmcnt(5)
  v_add_f32 v100, v100, v80
  v_mfma_f32_16x16x32_bf16 v[28:31], a[56:59], a[172:175], v[28:31]
  v_add_f32 v101, v101, v81
  v_add_f32 v102, v102, v82
  v_mfma_f32_16x16x32_bf16 v[32:35], a[60:63], a[172:175], v[32:35]
  v_add_f32 v103, v103, v83
  s_waitcnt lgkmcnt(4)
  v_add_f32 v84, v84, v44
  v_mfma_f32_16x16x32_bf16 v[36:39], a[64:67], a[172:175], v[36:39]
  v_add_f32 v85, v85, v45
  v_add_f32 v86, v86, v46
  v_mfma_f32_16x16x32_bf16 v[40:43], a[68:71], a[172:175], v[40:43]
  v_add_f32 v87, v87, v47
  s_waitcnt lgkmcnt(3)
  v_add_f32 v88, v88, v48
  v_add_f32 v89, v89, v49
  v_pk_add_f32 v[90:91], v[90:91], v[50:51]
  s_waitcnt lgkmcnt(2)
  v_pk_add_f32 v[92:93], v[92:93], v[52:53]
  v_pk_add_f32 v[94:95], v[94:95], v[54:55]
  s_waitcnt lgkmcnt(1)
  v_pk_add_f32 v[96:97], v[96:97], v[56:57]
  v_pk_add_f32 v[98:99], v[98:99], v[58:59]
  s_waitcnt lgkmcnt(0)
  v_pk_add_f32 v[100:101], v[100:101], v[60:61]
  v_pk_add_f32 v[102:103], v[102:103], v[62:63]
  v_pk_add_f32 v[84:85], v[84:85], v[24:25]
  v_pk_add_f32 v[86:87], v[86:87], v[26:27]
  v_pk_add_f32 v[88:89], v[88:89], v[28:29]
  v_pk_add_f32 v[90:91], v[90:91], v[30:31]
  v_pk_add_f32 v[92:93], v[92:93], v[32:33]
  v_pk_add_f32 v[94:95], v[94:95], v[34:35]
  v_pk_add_f32 v[96:97], v[96:97], v[36:37]
  v_pk_add_f32 v[98:99], v[98:99], v[38:39]
  v_pk_add_f32 v[100:101], v[100:101], v[40:41]
  v_pk_add_f32 v[102:103], v[102:103], v[42:43]
  v_cvt_pk_bf16_f32 v10, v84, v85
  v_cvt_pk_bf16_f32 v11, v86, v87
  v_cvt_pk_bf16_f32 v12, v88, v89
  v_cvt_pk_bf16_f32 v13, v90, v91
  v_cvt_pk_bf16_f32 v14, v92, v93
  v_cvt_pk_bf16_f32 v15, v94, v95
  v_cvt_pk_bf16_f32 v16, v96, v97
  v_cvt_pk_bf16_f32 v17, v98, v99
  v_cvt_pk_bf16_f32 v18, v100, v101
  v_cvt_pk_bf16_f32 v19, v102, v103
  v_mov_b32 v44, v10
  v_mov_b32 v45, v11
  v_mov_b32 v46, v12
  v_mov_b32 v47, v13
  v_mov_b32 v48, v14
  v_mov_b32 v49, v15
  v_mov_b32 v50, v16
  v_mov_b32 v51, v17
  v_permlane32_swap_b32 v44, v46
  v_permlane32_swap_b32 v45, v47
  v_permlane32_swap_b32 v48, v50
  v_permlane32_swap_b32 v49, v51
  s_add_u32 s3, s58, 0
  s_cmp_lg_u32 s16, 0
  s_cbranch_scc1 HS5
  buffer_store_dwordx4 v[44:47], v7, s[8:11], s3 offen
  buffer_store_dwordx4 v[48:51], v7, s[8:11], s3 offen offset:2048
  s_addk_i32 s3, 4096
  buffer_store_dwordx2 v[18:19], v6, s[8:11], s3 offen
HB5:
  s_mov_b32 s3, 0x3f803f80
  v_mov_b32 v64, 0
  v_mov_b32 v65, 0
  v_add_u32 v20, 1, v20
  v_dot2_f32_bf16 v64, v10, s3, v64
  v_dot2_f32_bf16 v65, v10, v10, v65
  v_dot2_f32_bf16 v64, v11, s3, v64
  v_dot2_f32_bf16 v65, v11, v11, v65
  v_dot2_f32_bf16 v64, v12, s3, v64
  v_dot2_f32_bf16 v65, v12, v12, v65
  v_dot2_f32_bf16 v64, v13, s3, v64
  v_dot2_f32_bf16 v65, v13, v13, v65
  v_dot2_f32_bf16 v64, v14, s3, v64
  v_dot2_f32_bf16 v65, v14, v14, v65
  v_dot2_f32_bf16 v64, v15, s3, v64
  v_dot2_f32_bf16 v65, v15, v15, v65
  v_dot2_f32_bf16 v64, v16, s3, v64
  v_dot2_f32_bf16 v65, v16, v16, v65
  v_dot2_f32_bf16 v64, v17, s3, v64
  v_dot2_f32_bf16 v65, v17, v17, v65
  v_dot2_f32_bf16 v64, v18, s3, v64
  v_dot2_f32_bf16 v65, v18, v18, v65
  v_dot2_f32_bf16 v64, v19, s3, v64
  v_dot2_f32_bf16 v65, v19, v19, v65
  v_mov_b32 v66, v20
  v_mov_b32 v67, v20
  v_mov_b32 v68, v64
  v_mov_b32 v69, v65
  s_nop 0
  v_permlane16_swap_b32 v64, v68
  v_permlane16_swap_b32 v65, v69
  v_add_f32 v64, v64, v68
  v_add_f32 v65, v65, v69
  v_mov_b32 v68, v64
  v_mov_b32 v69, v65
  s_nop 0
  v_permlane32_swap_b32 v64, v68
  v_permlane32_swap_b32 v65, v69
  v_add_f32 v64, v64, v68
  v_add_f32 v65, v65, v69
  s_add_u32 s3, s59, 2621440
  s_waitcnt vmcnt(0)
  s_mov_b64 exec, 0xffff
  s_cmp_lg_u32 s16, 0
  s_cbranch_scc1 HS6
  buffer_store_dwordx4 v[64:67], v1, s[8:11], s3 offen
HB6:
  s_mov_b64 exec, -1
  s_barrier
  s_add_u32 s38, s38, 1114112
  s_add_u32 s39, s39, 1114112
  s_add_u32 s70, s37, 2621440
  buffer_load_dwordx4 v[24:27], v8, s[8:11], s70 offen offset:0 sc1
  buffer_load_dwordx4 v[28:31], v8, s[8:11], s70 offen offset:512 sc1
  buffer_load_dwordx4 v[32:35], v8, s[8:11], s70 offen offset:1024 sc1
  buffer_load_dwordx4 v[36:39], v8, s[8:11], s70 offen offset:1536 sc1
  s_waitcnt vmcnt(1)
  v_max3_u32 v40, v26, v30, v34
  v_min3_u32 v41, v26, v30, v34
  s_waitcnt vmcnt(0)
  v_max_u32 v40, v40, v38
  v_min_u32 v41, v41, v38
  v_cmp_ne_u32 vcc, v20, v40
  v_cmp_ne_u32 s[64:65], v20, v41
  s_nop 3
  s_or_b64 vcc, vcc, s[64:65]
  s_cbranch_vccnz PXI_SPIN_2
PXI_OK_2:
  s_add_u32 s71, s36, 0
  buffer_load_dwordx4 a[0:3], v1, s[8:11], s71 offen offset:0 sc1
  buffer_load_dwordx4 a[4:7], v1, s[8:11], s71 offen offset:1024 sc1
  buffer_load_dwordx4 a[8:11], v1, s[8:11], s71 offen offset:2048 sc1
  buffer_load_dwordx4 a[12:15], v1, s[8:11], s71 offen offset:3072 sc1
  s_add_u32 s35, s71, 4096
  buffer_load_dwordx4 a[16:19], v1, s[8:11], s35 offen offset:0 sc1
  buffer_load_dwordx4 a[20:23], v1, s[8:11], s35 offen offset:1024 sc1
  buffer_load_dwordx4 a[24:27], v1, s[8:11], s35 offen offset:2048 sc1
  buffer_load_dwordx4 a[28:31], v1, s[8:11], s35 offen offset:3072 sc1
  s_add_u32 s35, s71, 8192
  buffer_load_dwordx4 a[32:35], v1, s[8:11], s35 offen offset:0 sc1
  s_barrier
  ds_read_b128 a[160:163], v1 offset:0
  buffer_load_dwordx4 a[36:39], v1, s[8:11], s35 offen offset:1024 sc1
  buffer_load_dwordx4 a[40:43], v1, s[8:11], s35 offen offset:2048 sc1
  ds_read_b128 a[164:167], v1 offset:1024
  buffer_load_dwordx4 a[44:47], v1, s[8:11], s35 offen offset:3072 sc1
  ds_read_b128 a[168:171], v1 offset:2048
  ds_read_b128 a[172:175], v1 offset:3072
  s_add_u32 s35, s71, 12288
  buffer_load_dwordx4 a[48:51], v1, s[8:11], s35 offen offset:0 sc1
  ds_read_b128 a[176:179], v1 offset:4096
  ds_read_b128 a[180:183], v1 offset:5120
  buffer_load_dwordx4 a[52:55], v1, s[8:11], s35 offen offset:1024 sc1
  ds_read_b128 a[184:187], v1 offset:6144
  s_waitcnt vmcnt(13) lgkmcnt(4)
  v_mfma_f32_32x32x16_bf16 v[40:55], a[160:163], a[0:3], 0
  ds_read_b128 a[188:191], v1 offset:7168
  buffer_load_dwordx4 a[56:59], v1, s[8:11], s35 offen offset:2048 sc1
  v_and_b32 v34, 24, v0
  v_cmp_eq_u32 vcc, 24, v34
  v_mfma_f32_32x32x16_bf16 v[56:71], a[164:167], a[0:3], 0
  ds_read_b128 a[160:163], v1 offset:8192
  v_mov_b32 v34, 1073741824
  v_cndmask_b32 v34, v1, v34, vcc
  s_waitcnt vmcnt(13)
  v_mfma_f32_32x32x16_bf16 v[40:55], a[168:171], a[4:7], v[40:55]
  ds_read_b128 a[164:167], v1 offset:9216
  buffer_load_dwordx4 a[60:63], v1, s[8:11], s35 offen offset:3072 sc1
  s_waitcnt lgkmcnt(4)
  v_mfma_f32_32x32x16_bf16 v[56:71], a[172:175], a[4:7], v[56:71]
  ds_read_b128 a[168:171], v1 offset:10240
  s_waitcnt vmcnt(13)
  v_mfma_f32_32x32x16_bf16 v[40:55], a[176:179], a[8:11], v[40:55]
  ds_read_b128 a[172:175], v1 offset:11264
  s_add_u32 s35, s71, 16384
  buffer_load_dwordx4 a[64:67], v1, s[8:11], s35 offen offset:0 sc1
  v_mfma_f32_32x32x16_bf16 v[56:71], a[180:183], a[8:11], v[56:71]
  ds_read_b128 a[176:179], v1 offset:12288
  s_waitcnt vmcnt(13) lgkmcnt(4)
  v_mfma_f32_32x32x16_bf16 v[40:55], a[184:187], a[12:15], v[40:55]
  ds_read_b128 a[180:183], v1 offset:13312
  buffer_load_dwordx4 a[68:71], v1, s[8:11], s35 offen offset:1024 sc1
  v_mfma_f32_32x32x16_bf16 v[56:71], a[188:191], a[12:15], v[56:71]
  ds_read_b128 a[184:187], v1 offset:14336
  s_waitcnt vmcnt(13)
  v_mfma_f32_32x32x16_bf16 v[40:55], a[160:163], a[16:19], v[40:55]
  ds_read_b128 a[188:191], v1 offset:15360
  buffer_load_dwordx4 a[72:75], v1, s[8:11], s35 offen offset:2048 sc1
  s_waitcnt lgkmcnt(4)
  v_mfma_f32_32x32x16_bf16 v[56:71], a[164:167], a[16:19], v[56:71]
  ds_read_b128 a[160:163], v1 offset:16384
  s_waitcnt vmcnt(13)
  v_mfma_f32_32x32x16_bf16 v[40:55], a[168:171], a[20:23], v[40:55]
  ds_read_b128 a[164:167], v1 offset:17408
  buffer_load_dwordx4 a[76:79], v1, s[8:11], s35 offen offset:3072 sc1
  v_mfma_f32_32x32x16_bf16 v[56:71], a[172:175], a[20:23], v[56:71]
  ds_read_b128 a[168:171], v1 offset:18432
  s_waitcnt vmcnt(13) lgkmcnt(4)
  v_mfma_f32_32x32x16_bf16 v[40:55], a[176:179], a[24:27], v[40:55]
  ds_read_b128 a[172:175], v1 offset:19456
  s_add_u32 s35, s71, 20480
  buffer_load_dwordx4 a[80:83], v1, s[8:11], s35 offen offset:0 sc1
  v_add_f32 v24, v24, v28
  v_mfma_f32_32x32x16_bf16 v[56:71], a[180:183], a[24:27], v[56:71]
  ds_read_b128 a[176:179], v1 offset:20480
  v_add_f32 v25, v25, v29
  v_add_f32 v32, v32, v36
  v_add_f32 v33, v33, v37
  v_add_f32 v24, v24, v32
  v_add_f32 v25, v25, v33
  s_waitcnt vmcnt(13)
  v_mfma_f32_32x32x16_bf16 v[40:55], a[184:187], a[28:31], v[40:55]
  ds_read_b128 a[180:183], v1 offset:21504
  buffer_load_dwordx4 a[84:87], v1, s[8:11], s35 offen offset:1024 sc1
  v_mov_b32 v26, v24
  s_waitcnt lgkmcnt(4)
  v_mfma_f32_32x32x16_bf16 v[56:71], a[188:191], a[28:31], v[56:71]
  ds_read_b128 a[184:187], v1 offset:22528
  s_add_u32 m0, s27, 65536
  s_add_u32 s34, s30, 65536
  buffer_load_dwordx4 v1, s[8:11], s34 offen offset:0 sc1 lds
  s_waitcnt vmcnt(14)
  v_mfma_f32_32x32x16_bf16 v[40:55], a[160:163], a[32:35], v[40:55]
  ds_read_b128 a[188:191], v1 offset:23552
  buffer_load_dwordx4 a[88:91], v1, s[8:11], s35 offen offset:2048 sc1
  v_mov_b32 v27, v25
  v_permlane32_swap_b32 v24, v26
  v_mfma_f32_32x32x16_bf16 v[56:71], a[164:167], a[32:35], v[56:71]
  ds_read_b128 a[160:163], v1 offset:24576
  buffer_load_dwordx4 v1, s[8:11], s34 offen offset:1024 sc1 lds
  v_permlane32_swap_b32 v25, v27
  s_waitcnt vmcnt(15) lgkmcnt(4)
  v_mfma_f32_32x32x16_bf16 v[40:55], a[168:171], a[36:39], v[40:55]
  ds_read_b128 a[164:167], v1 offset:25600
  buffer_load_dwordx4 a[92:95], v1, s[8:11], s35 offen offset:3072 sc1
  v_add_f32 v24, v24, v26
  v_add_f32 v25, v25, v27
  v_mfma_f32_32x32x16_bf16 v[56:71], a[172:175], a[36:39], v[56:71]
  ds_read_b128 a[168:171], v1 offset:26624
  buffer_load_dwordx4 v1, s[8:11], s34 offen offset:2048 sc1 lds
  v_mul_f32 v24, 0xbacccccd, v24
  v_mul_f32 v25, 0x3acccccd, v25
  s_waitcnt vmcnt(16)
  v_mfma_f32_32x32x16_bf16 v[40:55], a[176:179], a[40:43], v[40:55]
  ds_read_b128 a[172:175], v1 offset:27648
  s_add_u32 s35, s71, 24576
  buffer_load_dwordx4 a[96:99], v1, s[8:11], s35 offen offset:0 sc1
  s_waitcnt lgkmcnt(4)
  v_mfma_f32_32x32x16_bf16 v[56:71], a[180:183], a[40:43], v[56:71]
  ds_read_b128 a[176:179], v1 offset:28672
  buffer_load_dwordx4 v1, s[8:11], s34 offen offset:3072 sc1 lds
  v_cvt_pk_bf16_f32 v104, v24, v24
  v_fma_f32 v25, -v24, v24, v25
  s_waitcnt vmcnt(17)
  v_mfma_f32_32x32x16_bf16 v[40:55], a[184:187], a[44:47], v[40:55]
  ds_read_b128 a[180:183], v1 offset:29696
  buffer_load_dwordx4 a[100:103], v1, s[8:11], s35 offen offset:1024 sc1
  v_cvt_pk_bf16_f32 v105, v24, v24
  v_max_f32 v25, 0, v25
  v_mfma_f32_32x32x16_bf16 v[56:71], a[188:191], a[44:47], v[56:71]
  ds_read_b128 a[184:187], v1 offset:30720
  s_add_u32 m0, s27, 69632
  s_add_u32 s34, s30, 69632
  buffer_load_dwordx4 v1, s[8:11], s34 offen offset:0 sc1 lds
  s_waitcnt vmcnt(18) lgkmcnt(4)
  v_mfma_f32_32x32x16_bf16 v[40:55], a[160:163], a[48:51], v[40:55]
  ds_read_b128 a[188:191], v1 offset:31744
  buffer_load_dwordx4 a[104:107], v1, s[8:11], s35 offen offset:2048 sc1
  v_cvt_pk_bf16_f32 v106, v24, v24
  v_add_f32 v108, 0x3727c5ac, v25
  v_mfma_f32_32x32x16_bf16 v[56:71], a[164:167], a[48:51], v[56:71]
  ds_read_b128 a[160:163], v1 offset:32768
  buffer_load_dwordx4 v1, s[8:11], s34 offen offset:1024 sc1 lds
  v_cvt_pk_bf16_f32 v107, v24, v24
  s_waitcnt vmcnt(19)
  v_mfma_f32_32x32x16_bf16 v[40:55], a[168:171], a[52:55], v[40:55]
  ds_read_b128 a[164:167], v1 offset:33792
  buffer_load_dwordx4 a[108:111], v1, s[8:11], s35 offen offset:3072 sc1
  s_waitcnt lgkmcnt(4)
  v_mfma_f32_32x32x16_bf16 v[56:71], a[172:175], a[52:55], v[56:71]
  ds_read_b128 a[168:171], v1 offset:34816
  buffer_load_dwordx4 v1, s[8:11], s34 offen offset:2048 sc1 lds
  v_rsq_f32 v111, v108
  s_waitcnt vmcnt(20)
  v_mfma_f32_32x32x16_bf16 v[40:55], a[176:179], a[56:59], v[40:55]
  ds_read_b128 a[172:175], v1 offset:35840
  s_add_u32 s35, s71, 28672
  buffer_load_dwordx4 a[112:115], v1, s[8:11], s35 offen offset:0 sc1
  s_nop 0
  v_mfma_f32_32x32x16_bf16 v[56:71], a[180:183], a[56:59], v[56:71]
  ds_read_b128 a[176:179], v1 offset:36864
  buffer_load_dwordx4 v1, s[8:11], s34 offen offset:3072 sc1 lds
  v_mul_f32 v110, 0x3fb8aa3b, v111
  s_waitcnt vmcnt(21) lgkmcnt(4)
  v_mfma_f32_32x32x16_bf16 v[40:55], a[184:187], a[60:63], v[40:55]
  ds_read_b128 a[180:183], v1 offset:37888
  buffer_load_dwordx4 a[116:119], v1, s[8:11], s35 offen offset:1024 sc1
  v_lshrrev_b32 v112, 5, v0
  v_and_b32 v113, 31, v0
  v_mfma_f32_32x32x16_bf16 v[56:71], a[188:191], a[60:63], v[56:71]
  ds_read_b128 a[184:187], v1 offset:38912
  s_lshl_b32 s3, s12, 5
  v_add_u32 v114, s3, v113
  v_mul_u32_u24 v114, 144, v114
  v_mul_u32_u24 v115, 18432, v112
  v_add_u32 v114, 4096, v114
  s_waitcnt vmcnt(21)
  v_mfma_f32_32x32x16_bf16 v[40:55], a[160:163], a[64:67], v[40:55]
  ds_read_b128 a[188:191], v1 offset:39936
  buffer_load_dwordx4 a[120:123], v1, s[8:11], s35 offen offset:2048 sc1
  v_add_u32 v24, v114, v115
  s_waitcnt lgkmcnt(4)
  v_mfma_f32_32x32x16_bf16 v[56:71], a[164:167], a[64:67], v[56:71]
  ds_read_b128 a[160:163], v1 offset:40960
  v_bfe_u32 v114, v0, 2, 2
  v_lshlrev_b32 v114, 1, v114
  v_add_u32 v114, v114, v112
  v_mul_u32_u24 v114, 288, v114
  s_lshr_b32 s14, s12, 1
  s_waitcnt vmcnt(21)
  v_mfma_f32_32x32x16_bf16 v[40:55], a[168:171], a[68:71], v[40:55]
  ds_read_b128 a[164:167], v1 offset:41984
  buffer_load_dwordx4 a[124:127], v1, s[8:11], s35 offen offset:3072 sc1
  s_mul_i32 s3, s14, 18432
  s_add_u32 s3, s3, 4096
  v_mfma_f32_32x32x16_bf16 v[56:71], a[172:175], a[68:71], v[56:71]
  ds_read_b128 a[168:171], v1 offset:43008
  v_add_u32 v114, s3, v114
  v_bfe_u32 v115, v0, 4, 1
  v_and_b32 v116, 3, v0
  v_lshl_add_u32 v115, v115, 2, v116
  s_waitcnt vmcnt(21) lgkmcnt(4)
  v_mfma_f32_32x32x16_bf16 v[40:55], a[176:179], a[72:75], v[40:55]
  ds_read_b128 a[172:175], v1 offset:44032
  s_add_u32 s35, s71, 32768
  buffer_load_dwordx4 a[128:131], v1, s[8:11], s35 offen offset:0 sc1
  v_min_u32 v116, 4, v115
  v_mfma_f32_32x32x16_bf16 v[56:71], a[180:183], a[72:75], v[56:71]
  ds_read_b128 a[176:179], v1 offset:45056
  v_min_u32 v115, 5, v115
  v_lshl_add_u32 v25, v116, 3, v114
  v_lshl_add_u32 v26, v115, 3, v114
  s_and_b32 s15, s12, 1
  s_mul_i32 s15, s15, 40
  s_waitcnt vmcnt(21)
  v_mfma_f32_32x32x16_bf16 v[40:55], a[184:187], a[76:79], v[40:55]
  ds_read_b128 a[180:183], v1 offset:46080
  buffer_load_dwordx4 a[132:135], v1, s[8:11], s35 offen offset:1024 sc1
  v_add_u32 v25, s15, v25
  s_waitcnt lgkmcnt(4)
  v_mfma_f32_32x32x16_bf16 v[56:71], a[188:191], a[76:79], v[56:71]
  ds_read_b128 a[184:187], v1 offset:47104
  v_add_u32 v26, 80, v26
  s_mul_i32 s3, s14, 1680
  s_add_u32 s3, s3, s15
  s_add_u32 s3, s3, 40960
  v_mul_u32_u24 v114, 80, v113
  s_waitcnt vmcnt(21)
  v_mfma_f32_32x32x16_bf16 v[40:55], a[160:163], a[80:83], v[40:55]
  ds_read_b128 a[188:191], v1 offset:48128
  buffer_load_dwordx4 a[136:139], v1, s[8:11], s35 offen offset:2048 sc1
  v_lshl_add_u32 v114, v112, 3, v114
  v_add_u32 v27, s3, v114
  v_mfma_f32_32x32x16_bf16 v[56:71], a[164:167], a[80:83], v[56:71]
  ds_read_b128 a[160:163], v1 offset:49152
  v_add_u32 v29, s25, v1
  v_add_u32 v28, 40960, v29
  v_mov_b32 v114, 1073741824
  v_cmp_gt_u32 vcc, 3360, v29
  s_waitcnt vmcnt(21) lgkmcnt(4)
  v_mfma_f32_32x32x16_bf16 v[40:55], a[168:171], a[84:87], v[40:55]
  ds_read_b128 a[164:167], v1 offset:50176
  buffer_load_dwordx4 a[140:143], v1, s[8:11], s35 offen offset:3072 sc1
  v_cndmask_b32 v29, v114, v29, vcc
  v_bfe_u32 v114, v0, 2, 1
  v_mfma_f32_32x32x16_bf16 v[56:71], a[172:175], a[84:87], v[56:71]
  ds_read_b128 a[168:171], v1 offset:51200
  v_cmp_eq_u32 s[64:65], v114, v112
  v_lshrrev_b32 v114, 3, v113
  v_and_b32 v115, 3, v0
  v_lshl_add_u32 v114, v114, 2, v115
  v_mul_u32_u24 v115, 21, v112
  s_waitcnt vmcnt(20)
  v_mfma_f32_32x32x16_bf16 v[40:55], a[176:179], a[88:91], v[40:55]
  ds_read_b128 a[172:175], v1 offset:52224
  s_add_u32 s35, s71, 36864
  buffer_load_dwordx4 a[144:147], v1, s[8:11], s35 offen offset:0 sc1
  s_waitcnt lgkmcnt(4)
  v_mfma_f32_32x32x16_bf16 v[56:71], a[180:183], a[88:91], v[56:71]
  ds_read_b128 a[176:179], v1 offset:53248
  v_add_u32 v115, v115, v114
  v_mul_u32_u24 v115, 80, v115
  v_add_u32 v115, 40960, v115
  v_mov_b32 v116, 44320
  v_cndmask_b32 v32, v116, v115, s[64:65]
  s_waitcnt vmcnt(19)
  v_mfma_f32_32x32x16_bf16 v[40:55], a[184:187], a[92:95], v[40:55]
  ds_read_b128 a[180:183], v1 offset:54272
  buffer_load_dwordx4 a[148:151], v1, s[8:11], s35 offen offset:1024 sc1
  v_add_u32 v115, 1280, v32
  v_cmp_gt_u32 vcc, 5, v114
  v_mfma_f32_32x32x16_bf16 v[56:71], a[188:191], a[92:95], v[56:71]
  ds_read_b128 a[184:187], v1 offset:55296
  s_add_u32 m0, s27, 98304
  s_add_u32 s34, s30, 98304
  buffer_load_dwordx4 v1, s[8:11], s34 offen offset:0 sc1 lds
  s_waitcnt vmcnt(19) lgkmcnt(4)
  v_mfma_f32_32x32x16_bf16 v[40:55], a[160:163], a[96:99], v[40:55]
  ds_read_b128 a[188:191], v1 offset:56320
  buffer_load_dwordx4 a[152:155], v1, s[8:11], s35 offen offset:2048 sc1
  s_and_b64 vcc, vcc, s[64:65]
  v_cndmask_b32 v33, v116, v115, vcc
  v_mfma_f32_32x32x16_bf16 v[56:71], a[164:167], a[96:99], v[56:71]
  ds_read_b128 a[160:163], v1 offset:57344
  buffer_load_dwordx4 v1, s[8:11], s34 offen offset:1024 sc1 lds
  v_and_b32 v115, 1, v114
  v_lshlrev_b32 v115, 4, v115
  s_waitcnt vmcnt(19)
  v_mfma_f32_32x32x16_bf16 v[40:55], a[168:171], a[100:103], v[40:55]
  ds_read_b128 a[164:167], v1 offset:58368
  buffer_load_dwordx4 a[156:159], v1, s[8:11], s35 offen offset:3072 sc1
  v_mov_b32 v116, 0x3f80
  s_waitcnt lgkmcnt(4)
  v_mfma_f32_32x32x16_bf16 v[56:71], a[172:175], a[100:103], v[56:71]
  ds_read_b128 a[168:171], v1 offset:59392
  buffer_load_dwordx4 v1, s[8:11], s34 offen offset:2048 sc1 lds
  v_lshlrev_b32 v115, v115, v116
  v_cndmask_b32 v115, 0, v115, s[64:65]
  s_waitcnt vmcnt(19)
  v_mfma_f32_32x32x16_bf16 v[40:55], a[176:179], a[104:107], v[40:55]
  ds_read_b128 a[172:175], v1 offset:60416
  v_lshrrev_b32 v114, 1, v114
  v_cmp_eq_u32 vcc, 0, v114
  s_nop 1
  v_cndmask_b32 v36, 0, v115, vcc
  v_cmp_eq_u32 vcc, 1, v114
  s_nop 1
  v_cndmask_b32 v37, 0, v115, vcc
  v_mfma_f32_32x32x16_bf16 v[56:71], a[180:183], a[104:107], v[56:71]
  ds_read_b128 a[176:179], v1 offset:61440
  buffer_load_dwordx4 v1, s[8:11], s34 offen offset:3072 sc1 lds
  v_cmp_eq_u32 vcc, 2, v114
  s_waitcnt vmcnt(18) lgkmcnt(4)
  v_mfma_f32_32x32x16_bf16 v[40:55], a[184:187], a[108:111], v[40:55]
  ds_read_b128 a[180:183], v1 offset:62464
  v_cndmask_b32 v38, 0, v115, vcc
  v_cmp_eq_u32 vcc, 3, v114
  s_nop 1
  v_cndmask_b32 v39, 0, v115, vcc
  v_bfe_u32 v114, v0, 4, 1
  v_mul_u32_u24 v114, 57344, v114
  v_mfma_f32_32x32x16_bf16 v[56:71], a[188:191], a[108:111], v[56:71]
  ds_read_b128 a[184:187], v1 offset:63488
  s_add_u32 m0, s27, 102400
  s_add_u32 s34, s30, 102400
  buffer_load_dwordx4 v1, s[8:11], s34 offen offset:0 sc1 lds
  s_waitcnt vmcnt(17)
  v_mfma_f32_32x32x16_bf16 v[40:55], a[160:163], a[112:115], v[40:55]
  ds_read_b128 a[188:191], v1 offset:64512
  v_and_b32 v115, 15, v0
  v_lshl_add_u32 v114, v115, 4, v114
  s_waitcnt vmcnt(16)
  s_barrier
  s_waitcnt lgkmcnt(4)
  v_mfma_f32_32x32x16_bf16 v[56:71], a[164:167], a[112:115], v[56:71]
  ds_read_b128 a[160:163], v2 offset:0
  buffer_load_dwordx4 v1, s[8:11], s34 offen offset:1024 sc1 lds
  v_lshl_add_u32 v30, v112, 9, v114
  v_lshl_add_u32 v31, v112, 3, v114
  s_waitcnt vmcnt(16)
  v_mfma_f32_32x32x16_bf16 v[40:55], a[168:171], a[116:119], v[40:55]
  ds_read_b128 a[164:167], v2 offset:1024
  v_mfma_f32_32x32x16_bf16 v[56:71], a[172:175], a[116:119], v[56:71]
  ds_read_b128 a[168:171], v2 offset:2048
  buffer_load_dwordx4 v1, s[8:11], s34 offen offset:2048 sc1 lds
  s_waitcnt vmcnt(16) lgkmcnt(4)
  v_mfma_f32_32x32x16_bf16 v[40:55], a[176:179], a[120:123], v[40:55]
  ds_read_b128 a[172:175], v2 offset:3072
  v_mfma_f32_32x32x16_bf16 v[56:71], a[180:183], a[120:123], v[56:71]
  ds_read_b128 a[176:179], v2 offset:4096
  buffer_load_dwordx4 v1, s[8:11], s34 offen offset:3072 sc1 lds
  s_waitcnt vmcnt(16)
  v_mfma_f32_32x32x16_bf16 v[40:55], a[184:187], a[124:127], v[40:55]
  ds_read_b128 a[180:183], v2 offset:5120
  s_waitcnt lgkmcnt(4)
  v_mfma_f32_32x32x16_bf16 v[56:71], a[188:191], a[124:127], v[56:71]
  ds_read_b128 a[184:187], v2 offset:6144
  s_waitcnt vmcnt(15)
  v_mfma_f32_32x32x16_bf16 v[40:55], a[160:163], a[128:131], v[40:55]
  ds_read_b128 a[188:191], v2 offset:7168
  v_mfma_f32_32x32x16_bf16 v[56:71], a[164:167], a[128:131], v[56:71]
  ds_read_b128 a[160:163], v2 offset:8192
  s_waitcnt vmcnt(14) lgkmcnt(4)
  v_mfma_f32_32x32x16_bf16 v[40:55], a[168:171], a[132:135], v[40:55]
  ds_read_b128 a[164:167], v2 offset:9216
  v_mfma_f32_32x32x16_bf16 v[56:71], a[172:175], a[132:135], v[56:71]
  ds_read_b128 a[168:171], v2 offset:10240
  s_waitcnt vmcnt(13)
  v_mfma_f32_32x32x16_bf16 v[40:55], a[176:179], a[136:139], v[40:55]
  ds_read_b128 a[172:175], v2 offset:11264
  s_waitcnt lgkmcnt(4)
  v_mfma_f32_32x32x16_bf16 v[56:71], a[180:183], a[136:139], v[56:71]
  ds_read_b128 a[176:179], v2 offset:12288
  s_waitcnt vmcnt(12)
  v_mfma_f32_32x32x16_bf16 v[40:55], a[184:187], a[140:143], v[40:55]
  ds_read_b128 a[180:183], v2 offset:13312
  v_mfma_f32_32x32x16_bf16 v[56:71], a[188:191], a[140:143], v[56:71]
  ds_read_b128 a[184:187], v2 offset:14336
  s_waitcnt vmcnt(11) lgkmcnt(4)
  v_mfma_f32_32x32x16_bf16 v[40:55], a[160:163], a[144:147], v[40:55]
  ds_read_b128 a[188:191], v2 offset:15360
  v_mfma_f32_32x32x16_bf16 v[56:71], a[164:167], a[144:147], v[56:71]
  ds_read_b128 a[160:163], v2 offset:16384
  s_waitcnt vmcnt(10)
  v_mfma_f32_32x32x16_bf16 v[40:55], a[168:171], a[148:151], v[40:55]
  ds_read_b128 a[164:167], v2 offset:17408
  s_waitcnt lgkmcnt(4)
  v_mfma_f32_32x32x16_bf16 v[56:71], a[172:175], a[148:151], v[56:71]
  ds_read_b128 a[168:171], v2 offset:18432
  s_waitcnt vmcnt(8)
  v_mfma_f32_32x32x16_bf16 v[40:55], a[176:179], a[152:155], v[40:55]
  ds_read_b128 a[172:175], v2 offset:19456
  v_mfma_f32_32x32x16_bf16 v[56:71], a[180:183], a[152:155], v[56:71]
  ds_read_b128 a[176:179], v2 offset:20480
  s_waitcnt vmcnt(6) lgkmcnt(4)
  v_mfma_f32_32x32x16_bf16 v[40:55], a[184:187], a[156:159], v[40:55]
  ds_read_b128 a[180:183], v2 offset:21504
  v_mfma_f32_32x32x16_bf16 v[56:71], a[188:191], a[156:159], v[56:71]
  ds_read_b128 a[184:187], v2 offset:22528
  s_add_u32 m0, s27, 131072
  s_add_u32 s34, s30, 131072
  buffer_load_dwordx4 v34, s[8:11], s34 offen offset:0 sc1 lds
  v_mfma_f32_32x32x16_bf16 v[40:55], a[160:163], v[104:107], v[40:55]
  ds_read_b128 a[188:191], v2 offset:23552
  s_waitcnt lgkmcnt(4)
  v_mfma_f32_32x32x16_bf16 v[56:71], a[164:167], v[104:107], v[56:71]
  ds_read_b128 a[160:163], v2 offset:24576
  buffer_load_dwordx4 v34, s[8:11], s34 offen offset:1024 sc1 lds
  v_mfma_f32_32x32x16_bf16 v[72:87], a[168:171], a[0:3], 0
  ds_read_b128 a[164:167], v2 offset:25600
  v_mfma_f32_32x32x16_bf16 v[72:87], a[172:175], a[4:7], v[72:87]
  ds_read_b128 a[168:171], v2 offset:26624
  buffer_load_dwordx4 v34, s[8:11], s34 offen offset:2048 sc1 lds
  s_waitcnt lgkmcnt(4)
  v_mfma_f32_32x32x16_bf16 v[72:87], a[176:179], a[8:11], v[72:87]
  ds_read_b128 a[172:175], v2 offset:27648
  v_max3_f32 v112, v40, v41, v42
  v_min3_f32 v113, v40, v41, v42
  v_max3_f32 v112, v112, v43, v44
  v_min3_f32 v113, v113, v43, v44
  v_max3_f32 v112, v112, v45, v46
  v_mfma_f32_32x32x16_bf16 v[72:87], a[180:183], a[12:15], v[72:87]
  ds_read_b128 a[176:179], v2 offset:28672
  buffer_load_dwordx4 v34, s[8:11], s34 offen offset:3072 sc1 lds
  v_min3_f32 v113, v113, v45, v46
  v_max3_f32 v112, v112, v47, v48
  v_mfma_f32_32x32x16_bf16 v[72:87], a[184:187], a[16:19], v[72:87]
  ds_read_b128 a[180:183], v2 offset:29696
  v_min3_f32 v113, v113, v47, v48
  v_max3_f32 v112, v112, v49, v50
  v_min3_f32 v113, v113, v49, v50
  v_max3_f32 v112, v112, v51, v52
  s_waitcnt lgkmcnt(4)
  v_mfma_f32_32x32x16_bf16 v[72:87], a[188:191], a[20:23], v[72:87]
  ds_read_b128 a[184:187], v2 offset:30720
  s_add_u32 m0, s27, 135168
  s_add_u32 s34, s30, 135168
  buffer_load_dwordx4 v34, s[8:11], s34 offen offset:0 sc1 lds
  v_mfma_f32_32x32x16_bf16 v[72:87], a[160:163], a[24:27], v[72:87]
  ds_read_b128 a[188:191], v2 offset:31744
  v_min3_f32 v113, v113, v51, v52
  v_max3_f32 v112, v112, v53, v54
  v_min3_f32 v113, v113, v53, v54
  s_waitcnt vmcnt(5)
  s_barrier
  v_mfma_f32_32x32x16_bf16 v[72:87], a[164:167], a[28:31], v[72:87]
  ds_read_b128 a[160:163], v2 offset:32768
  buffer_load_dwordx4 v34, s[8:11], s34 offen offset:1024 sc1 lds
  v_max3_f32 v112, v112, v55, v56
  s_waitcnt lgkmcnt(4)
  v_mfma_f32_32x32x16_bf16 v[72:87], a[168:171], a[32:35], v[72:87]
  ds_read_b128 a[164:167], v2 offset:33792
  v_min3_f32 v113, v113, v55, v56
  v_max3_f32 v112, v112, v57, v58
  v_min3_f32 v113, v113, v57, v58
  v_max_f32 v112, v112, v59
  v_min_f32 v113, v113, v59
  v_mfma_f32_32x32x16_bf16 v[72:87], a[172:175], a[36:39], v[72:87]
  ds_read_b128 a[168:171], v2 offset:34816
  buffer_load_dwordx4 v34, s[8:11], s34 offen offset:2048 sc1 lds
  v_mul_f32 v112, v112, v110
  v_mul_f32 v113, v113, v110
  v_mfma_f32_32x32x16_bf16 v[72:87], a[176:179], a[40:43], v[72:87]
  ds_read_b128 a[172:175], v2 offset:35840
  v_fma_f32 v118, v40, v110, -v112
  v_fma_f32 v119, v41, v110, -v112
  v_fma_f32 v40, -v40, v110, v113
  v_fma_f32 v41, -v41, v110, v113
  s_waitcnt lgkmcnt(4)
  v_mfma_f32_32x32x16_bf16 v[72:87], a[180:183], a[44:47], v[72:87]
  ds_read_b128 a[176:179], v2 offset:36864
  buffer_load_dwordx4 v34, s[8:11], s34 offen offset:3072 sc1 lds
  v_exp_f32 v118, v118
  v_mfma_f32_32x32x16_bf16 v[72:87], a[184:187], a[48:51], v[72:87]
  ds_read_b128 a[180:183], v2 offset:37888
  v_exp_f32 v119, v119
  v_exp_f32 v40, v40
  v_mfma_f32_32x32x16_bf16 v[72:87], a[188:191], a[52:55], v[72:87]
  ds_read_b128 a[184:187], v2 offset:38912
  v_exp_f32 v41, v41
  v_fma_f32 v120, v42, v110, -v112
  v_fma_f32 v121, v43, v110, -v112
  s_waitcnt lgkmcnt(4)
  v_mfma_f32_32x32x16_bf16 v[72:87], a[160:163], a[56:59], v[72:87]
  ds_read_b128 a[188:191], v2 offset:39936
  v_fma_f32 v42, -v42, v110, v113
  v_fma_f32 v43, -v43, v110, v113
  v_exp_f32 v120, v120
  v_mfma_f32_32x32x16_bf16 v[72:87], a[164:167], a[60:63], v[72:87]
  ds_read_b128 a[160:163], v2 offset:40960
  v_exp_f32 v121, v121
  v_exp_f32 v42, v42
  v_mfma_f32_32x32x16_bf16 v[72:87], a[168:171], a[64:67], v[72:87]
  ds_read_b128 a[164:167], v2 offset:41984
  v_exp_f32 v43, v43
  v_add_f32 v114, v118, v119
  v_add_f32 v115, v40, v41
  s_waitcnt lgkmcnt(4)
  v_mfma_f32_32x32x16_bf16 v[72:87], a[172:175], a[68:71], v[72:87]
  ds_read_b128 a[168:171], v2 offset:43008
  v_fma_f32 v122, v44, v110, -v112
  v_fma_f32 v123, v45, v110, -v112
  v_fma_f32 v44, -v44, v110, v113
  v_fma_f32 v45, -v45, v110, v113
  v_mfma_f32_32x32x16_bf16 v[72:87], a[176:179], a[72:75], v[72:87]
  ds_read_b128 a[172:175], v2 offset:44032
  v_exp_f32 v122, v122
  v_exp_f32 v123, v123
  v_mfma_f32_32x32x16_bf16 v[72:87], a[180:183], a[76:79], v[72:87]
  ds_read_b128 a[176:179], v2 offset:45056
  v_exp_f32 v44, v44
  v_exp_f32 v45, v45
  s_waitcnt lgkmcnt(4)
  v_mfma_f32_32x32x16_bf16 v[72:87], a[184:187], a[80:83], v[72:87]
  ds_read_b128 a[180:183], v2 offset:46080
  v_add_f32 v114, v114, v120
  v_add_f32 v115, v115, v42
  v_add_f32 v114, v114, v121
  v_add_f32 v115, v115, v43
  v_fma_f32 v124, v46, v110, -v112
  v_mfma_f32_32x32x16_bf16 v[72:87], a[188:191], a[84:87], v[72:87]
  ds_read_b128 a[184:187], v2 offset:47104
  v_fma_f32 v125, v47, v110, -v112
  v_fma_f32 v46, -v46, v110, v113
  v_fma_f32 v47, -v47, v110, v113
  v_exp_f32 v124, v124
  v_mfma_f32_32x32x16_bf16 v[72:87], a[160:163], a[88:91], v[72:87]
  ds_read_b128 a[188:191], v2 offset:48128
  v_exp_f32 v125, v125
  v_exp_f32 v46, v46
  s_waitcnt lgkmcnt(4)
  v_mfma_f32_32x32x16_bf16 v[72:87], a[164:167], a[92:95], v[72:87]
  ds_read_b128 a[160:163], v2 offset:49152
  v_exp_f32 v47, v47
  v_add_f32 v114, v114, v122
  v_add_f32 v115, v115, v44
  v_add_f32 v114, v114, v123
  v_mfma_f32_32x32x16_bf16 v[72:87], a[168:171], a[96:99], v[72:87]
  ds_read_b128 a[164:167], v2 offset:50176
  v_add_f32 v115, v115, v45
  v_fma_f32 v126, v48, v110, -v112
  v_fma_f32 v127, v49, v110, -v112
  v_fma_f32 v48, -v48, v110, v113
  v_fma_f32 v49, -v49, v110, v113
  v_mfma_f32_32x32x16_bf16 v[72:87], a[172:175], a[100:103], v[72:87]
  ds_read_b128 a[168:171], v2 offset:51200
  v_exp_f32 v126, v126
  v_exp_f32 v127, v127
  s_waitcnt lgkmcnt(4)
  v_mfma_f32_32x32x16_bf16 v[72:87], a[176:179], a[104:107], v[72:87]
  ds_read_b128 a[172:175], v2 offset:52224
  v_exp_f32 v48, v48
  v_exp_f32 v49, v49
  v_add_f32 v114, v114, v124
  v_mfma_f32_32x32x16_bf16 v[72:87], a[180:183], a[108:111], v[72:87]
  ds_read_b128 a[176:179], v2 offset:53248
  v_add_f32 v115, v115, v46
  v_add_f32 v114, v114, v125
  v_add_f32 v115, v115, v47
  v_fma_f32 v128, v50, v110, -v112
  v_fma_f32 v129, v51, v110, -v112
  v_mfma_f32_32x32x16_bf16 v[72:87], a[184:187], a[112:115], v[72:87]
  ds_read_b128 a[180:183], v2 offset:54272
  v_fma_f32 v50, -v50, v110, v113
  v_fma_f32 v51, -v51, v110, v113
  v_exp_f32 v128, v128
  s_waitcnt lgkmcnt(4)
  v_mfma_f32_32x32x16_bf16 v[72:87], a[188:191], a[116:119], v[72:87]
  ds_read_b128 a[184:187], v2 offset:55296
  v_exp_f32 v129, v129
  v_exp_f32 v50, v50
  v_mfma_f32_32x32x16_bf16 v[72:87], a[160:163], a[120:123], v[72:87]
  ds_read_b128 a[188:191], v2 offset:56320
  v_exp_f32 v51, v51
  v_add_f32 v114, v114, v126
  v_add_f32 v115, v115, v48
  v_add_f32 v114, v114, v127
  v_mfma_f32_32x32x16_bf16 v[72:87], a[164:167], a[124:127], v[72:87]
  ds_read_b128 a[160:163], v2 offset:57344
  v_add_f32 v115, v115, v49
  v_fma_f32 v130, v52, v110, -v112
  v_fma_f32 v131, v53, v110, -v112
  v_fma_f32 v52, -v52, v110, v113
  s_waitcnt lgkmcnt(4)
  v_mfma_f32_32x32x16_bf16 v[72:87], a[168:171], a[128:131], v[72:87]
  ds_read_b128 a[164:167], v2 offset:58368
  v_fma_f32 v53, -v53, v110, v113
  v_exp_f32 v130, v130
  v_exp_f32 v131, v131
  v_mfma_f32_32x32x16_bf16 v[72:87], a[172:175], a[132:135], v[72:87]
  ds_read_b128 a[168:171], v2 offset:59392
  v_exp_f32 v52, v52
  v_exp_f32 v53, v53
  v_add_f32 v114, v114, v128
  v_mfma_f32_32x32x16_bf16 v[72:87], a[176:179], a[136:139], v[72:87]
  ds_read_b128 a[172:175], v2 offset:60416
  v_add_f32 v115, v115, v50
  v_add_f32 v114, v114, v129
  v_add_f32 v115, v115, v51
  v_fma_f32 v132, v54, v110, -v112
  s_waitcnt lgkmcnt(4)
  v_mfma_f32_32x32x16_bf16 v[72:87], a[180:183], a[140:143], v[72:87]
  ds_read_b128 a[176:179], v2 offset:61440
  v_fma_f32 v133, v55, v110, -v112
  v_fma_f32 v54, -v54, v110, v113
  v_fma_f32 v55, -v55, v110, v113
  v_exp_f32 v132, v132
  v_mfma_f32_32x32x16_bf16 v[72:87], a[184:187], a[144:147], v[72:87]
  ds_read_b128 a[180:183], v2 offset:62464
  v_exp_f32 v133, v133
  v_exp_f32 v54, v54
  v_mfma_f32_32x32x16_bf16 v[72:87], a[188:191], a[148:151], v[72:87]
  ds_read_b128 a[184:187], v2 offset:63488
  v_exp_f32 v55, v55
  v_add_f32 v114, v114, v130
  v_add_f32 v115, v115, v52
  s_waitcnt lgkmcnt(4)
  v_mfma_f32_32x32x16_bf16 v[72:87], a[160:163], a[152:155], v[72:87]
  ds_read_b128 a[188:191], v2 offset:64512
  v_add_f32 v114, v114, v131
  v_add_f32 v115, v115, v53
  v_fma_f32 v134, v56, v110, -v112
  s_waitcnt vmcnt(0)
  s_barrier
  v_mfma_f32_32x32x16_bf16 v[72:87], a[164:167], a[156:159], v[72:87]
  ds_read_b128 a[160:163], v3 offset:0
  v_fma_f32 v135, v57, v110, -v112
  v_fma_f32 v56, -v56, v110, v113
  v_fma_f32 v57, -v57, v110, v113
  v_exp_f32 v134, v134
  v_mfma_f32_32x32x16_bf16 v[72:87], a[168:171], v[104:107], v[72:87]
  ds_read_b128 a[164:167], v3 offset:1024
  v_exp_f32 v135, v135
  v_exp_f32 v56, v56
  s_waitcnt lgkmcnt(4)
  v_mfma_f32_32x32x16_bf16 v[88:103], a[172:175], a[0:3], 0
  ds_read_b128 a[168:171], v3 offset:2048
  v_exp_f32 v57, v57
  v_add_f32 v114, v114, v132
  v_add_f32 v115, v115, v54
  v_add_f32 v114, v114, v133
  v_mfma_f32_32x32x16_bf16 v[88:103], a[176:179], a[4:7], v[88:103]
  ds_read_b128 a[172:175], v3 offset:3072
  v_add_f32 v115, v115, v55
  v_fma_f32 v136, v58, v110, -v112
  v_fma_f32 v137, v59, v110, -v112
  v_fma_f32 v58, -v58, v110, v113
  v_fma_f32 v59, -v59, v110, v113
  v_mfma_f32_32x32x16_bf16 v[88:103], a[180:183], a[8:11], v[88:103]
  ds_read_b128 a[176:179], v3 offset:4096
  s_add_u32 m0, s25, 0
  s_add_u32 s34, s28, 163840
  buffer_load_dwordx4 v34, s[8:11], s34 offen offset:0 sc1 lds
  s_waitcnt lgkmcnt(4)
  v_mfma_f32_32x32x16_bf16 v[88:103], a[184:187], a[12:15], v[88:103]
  ds_read_b128 a[180:183], v3 offset:5120
  buffer_load_dwordx4 a[0:3], v1, s[8:11], s55 offen offset:0 sc1
  v_exp_f32 v136, v136
  v_mfma_f32_32x32x16_bf16 v[88:103], a[188:191], a[16:19], v[88:103]
  ds_read_b128 a[184:187], v3 offset:6144
  buffer_load_dwordx4 a[4:7], v1, s[8:11], s55 offen offset:1024 sc1
  v_exp_f32 v137, v137
  v_mfma_f32_32x32x16_bf16 v[88:103], a[160:163], a[20:23], v[88:103]
  ds_read_b128 a[188:191], v3 offset:7168
  buffer_load_dwordx4 a[8:11], v1, s[8:11], s55 offen offset:2048 sc1
  s_waitcnt lgkmcnt(4)
  v_mfma_f32_32x32x16_bf16 v[88:103], a[164:167], a[24:27], v[88:103]
  ds_read_b128 a[160:163], v3 offset:8192
  buffer_load_dwordx4 a[12:15], v1, s[8:11], s55 offen offset:3072 sc1
  v_exp_f32 v58, v58
  v_mfma_f32_32x32x16_bf16 v[88:103], a[168:171], a[28:31], v[88:103]
  ds_read_b128 a[164:167], v3 offset:9216
  s_add_u32 s57, s55, 4096
  buffer_load_dwordx4 a[16:19], v1, s[8:11], s57 offen offset:0 sc1
  v_mfma_f32_32x32x16_bf16 v[88:103], a[172:175], a[32:35], v[88:103]
  ds_read_b128 a[168:171], v3 offset:10240
  buffer_load_dwordx4 a[20:23], v1, s[8:11], s57 offen offset:1024 sc1
  s_waitcnt lgkmcnt(4)
  v_mfma_f32_32x32x16_bf16 v[88:103], a[176:179], a[36:39], v[88:103]
  ds_read_b128 a[172:175], v3 offset:11264
  buffer_load_dwordx4 a[24:27], v1, s[8:11], s57 offen offset:2048 sc1
  v_exp_f32 v59, v59
  v_mfma_f32_32x32x16_bf16 v[88:103], a[180:183], a[40:43], v[88:103]
  ds_read_b128 a[176:179], v3 offset:12288
  buffer_load_dwordx4 a[28:31], v1, s[8:11], s57 offen offset:3072 sc1
  v_add_f32 v114, v114, v134
  v_add_f32 v115, v115, v56
  v_mfma_f32_32x32x16_bf16 v[88:103], a[184:187], a[44:47], v[88:103]
  ds_read_b128 a[180:183], v3 offset:13312
  s_add_u32 s57, s55, 8192
  buffer_load_dwordx4 a[32:35], v1, s[8:11], s57 offen offset:0 sc1
  s_waitcnt lgkmcnt(4)
  v_mfma_f32_32x32x16_bf16 v[88:103], a[188:191], a[48:51], v[88:103]
  ds_read_b128 a[184:187], v3 offset:14336
  buffer_load_dwordx4 a[36:39], v1, s[8:11], s57 offen offset:1024 sc1
  v_add_f32 v114, v114, v135
  v_add_f32 v115, v115, v57
  v_mfma_f32_32x32x16_bf16 v[88:103], a[160:163], a[52:55], v[88:103]
  ds_read_b128 a[188:191], v3 offset:15360
  buffer_load_dwordx4 a[40:43], v1, s[8:11], s57 offen offset:2048 sc1
  v_add_f32 v114, v114, v136
  v_add_f32 v115, v115, v58
  v_mfma_f32_32x32x16_bf16 v[88:103], a[164:167], a[56:59], v[88:103]
  ds_read_b128 a[160:163], v3 offset:16384
  buffer_load_dwordx4 a[44:47], v1, s[8:11], s57 offen offset:3072 sc1
  v_add_f32 v114, v114, v137
  s_waitcnt lgkmcnt(4)
  v_mfma_f32_32x32x16_bf16 v[88:103], a[168:171], a[60:63], v[88:103]
  ds_read_b128 a[164:167], v3 offset:17408
  s_add_u32 s57, s55, 12288
  buffer_load_dwordx4 a[48:51], v1, s[8:11], s57 offen offset:0 sc1
  v_add_f32 v115, v115, v59
  v_mfma_f32_32x32x16_bf16 v[88:103], a[172:175], a[64:67], v[88:103]
  ds_read_b128 a[168:171], v3 offset:18432
  buffer_load_dwordx4 a[52:55], v1, s[8:11], s57 offen offset:1024 sc1
  v_rcp_f32 v114, v114
  v_mfma_f32_32x32x16_bf16 v[88:103], a[176:179], a[68:71], v[88:103]
  ds_read_b128 a[172:175], v3 offset:19456
  buffer_load_dwordx4 a[56:59], v1, s[8:11], s57 offen offset:2048 sc1
  s_waitcnt lgkmcnt(4)
  v_mfma_f32_32x32x16_bf16 v[88:103], a[180:183], a[72:75], v[88:103]
  ds_read_b128 a[176:179], v3 offset:20480
  buffer_load_dwordx4 a[60:63], v1, s[8:11], s57 offen offset:3072 sc1
  v_rcp_f32 v115, v115
  v_mfma_f32_32x32x16_bf16 v[88:103], a[184:187], a[76:79], v[88:103]
  ds_read_b128 a[180:183], v3 offset:21504
  s_add_u32 s57, s55, 16384
  buffer_load_dwordx4 a[64:67], v1, s[8:11], s57 offen offset:0 sc1
  v_mul_f32 v118, v118, v114
  v_mfma_f32_32x32x16_bf16 v[88:103], a[188:191], a[80:83], v[88:103]
  ds_read_b128 a[184:187], v3 offset:22528
  buffer_load_dwordx4 a[68:71], v1, s[8:11], s57 offen offset:1024 sc1
  v_mul_f32 v119, v119, v114
  s_waitcnt lgkmcnt(4)
  v_mfma_f32_32x32x16_bf16 v[88:103], a[160:163], a[84:87], v[88:103]
  ds_read_b128 a[188:191], v3 offset:23552
  buffer_load_dwordx4 a[72:75], v1, s[8:11], s57 offen offset:2048 sc1
  v_mul_f32 v120, v120, v114
  v_mul_f32 v121, v121, v114
  v_mfma_f32_32x32x16_bf16 v[88:103], a[164:167], a[88:91], v[88:103]
  ds_read_b128 a[160:163], v3 offset:24576
  buffer_load_dwordx4 a[76:79], v1, s[8:11], s57 offen offset:3072 sc1
  v_cvt_pk_bf16_f32 v140, v118, v119
  v_cvt_pk_bf16_f32 v141, v120, v121
  v_mfma_f32_32x32x16_bf16 v[88:103], a[168:171], a[92:95], v[88:103]
  ds_read_b128 a[164:167], v3 offset:25600
  s_add_u32 s57, s55, 20480
  buffer_load_dwordx4 a[80:83], v1, s[8:11], s57 offen offset:0 sc1
  s_waitcnt lgkmcnt(4)
  v_mfma_f32_32x32x16_bf16 v[88:103], a[172:175], a[96:99], v[88:103]
  ds_read_b128 a[168:171], v3 offset:26624
  buffer_load_dwordx4 a[84:87], v1, s[8:11], s57 offen offset:1024 sc1
  v_mul_f32 v122, v122, v114
  v_mul_f32 v123, v123, v114
  v_mfma_f32_32x32x16_bf16 v[88:103], a[176:179], a[100:103], v[88:103]
  ds_read_b128 a[172:175], v3 offset:27648
  buffer_load_dwordx4 a[88:91], v1, s[8:11], s57 offen offset:2048 sc1
  v_mul_f32 v124, v124, v114
  v_mul_f32 v125, v125, v114
  v_mfma_f32_32x32x16_bf16 v[88:103], a[180:183], a[104:107], v[88:103]
  ds_read_b128 a[176:179], v3 offset:28672
  buffer_load_dwordx4 a[92:95], v1, s[8:11], s57 offen offset:3072 sc1
  v_cvt_pk_bf16_f32 v142, v122, v123
  s_waitcnt lgkmcnt(4)
  v_mfma_f32_32x32x16_bf16 v[88:103], a[184:187], a[108:111], v[88:103]
  ds_read_b128 a[180:183], v3 offset:29696
  s_add_u32 s57, s55, 24576
  buffer_load_dwordx4 a[96:99], v1, s[8:11], s57 offen offset:0 sc1
  v_cvt_pk_bf16_f32 v143, v124, v125
  v_mfma_f32_32x32x16_bf16 v[88:103], a[188:191], a[112:115], v[88:103]
  ds_read_b128 a[184:187], v3 offset:30720
  v_mul_f32 v126, v126, v114
  v_mul_f32 v127, v127, v114
  v_mul_f32 v128, v128, v114
  v_mul_f32 v129, v129, v114
  v_cvt_pk_bf16_f32 v144, v126, v127
  v_mfma_f32_32x32x16_bf16 v[88:103], a[160:163], a[116:119], v[88:103]
  ds_read_b128 a[188:191], v3 offset:31744
  v_cvt_pk_bf16_f32 v145, v128, v129
  v_mul_f32 v130, v130, v114
  s_waitcnt vmcnt(25)
  s_barrier
  s_waitcnt lgkmcnt(4)
  v_mfma_f32_32x32x16_bf16 v[88:103], a[164:167], a[120:123], v[88:103]
  ds_read_b128 a[160:163], v1 offset:0
  v_mul_f32 v131, v131, v114
  v_mul_f32 v132, v132, v114
  v_mul_f32 v133, v133, v114
  v_cvt_pk_bf16_f32 v146, v130, v131
  v_cvt_pk_bf16_f32 v147, v132, v133
  v_mfma_f32_32x32x16_bf16 v[88:103], a[168:171], a[124:127], v[88:103]
  ds_read_b128 a[164:167], v1 offset:1024
  v_mul_f32 v134, v134, v114
  v_mul_f32 v135, v135, v114
  v_mul_f32 v136, v136, v114
  v_mul_f32 v137, v137, v114
  v_cvt_pk_bf16_f32 v148, v134, v135
  v_mfma_f32_32x32x16_bf16 v[88:103], a[172:175], a[128:131], v[88:103]
  ds_read_b128 a[168:171], v1 offset:2048
  v_cvt_pk_bf16_f32 v149, v136, v137
  v_mul_f32 v40, v40, v115
  v_mul_f32 v41, v41, v115
  v_mul_f32 v42, v42, v115
  s_waitcnt lgkmcnt(4)
  v_mfma_f32_32x32x16_bf16 v[88:103], a[176:179], a[132:135], v[88:103]
  ds_read_b128 a[172:175], v1 offset:3072
  v_mul_f32 v43, v43, v115
  v_cvt_pk_bf16_f32 v150, v40, v41
  v_cvt_pk_bf16_f32 v151, v42, v43
  v_mul_f32 v44, v44, v115
  v_mul_f32 v45, v45, v115
  v_mfma_f32_32x32x16_bf16 v[88:103], a[180:183], a[136:139], v[88:103]
  v_mul_f32 v46, v46, v115
  v_mul_f32 v47, v47, v115
  v_cvt_pk_bf16_f32 v152, v44, v45
  v_cvt_pk_bf16_f32 v153, v46, v47
  v_mul_f32 v48, v48, v115
  v_mul_f32 v49, v49, v115
  v_mfma_f32_32x32x16_bf16 v[88:103], a[184:187], a[140:143], v[88:103]
  v_mul_f32 v50, v50, v115
  v_mul_f32 v51, v51, v115
  v_cvt_pk_bf16_f32 v154, v48, v49
  v_cvt_pk_bf16_f32 v155, v50, v51
  v_mul_f32 v52, v52, v115
  s_waitcnt lgkmcnt(2)
  v_mfma_f32_32x32x16_bf16 v[88:103], a[188:191], a[144:147], v[88:103]
  v_mul_f32 v53, v53, v115
  v_mul_f32 v54, v54, v115
  v_mul_f32 v55, v55, v115
  v_cvt_pk_bf16_f32 v156, v52, v53
  v_cvt_pk_bf16_f32 v157, v54, v55
  v_mul_f32 v56, v56, v115
  v_mfma_f32_32x32x16_bf16 v[88:103], a[160:163], a[148:151], v[88:103]
  v_mul_f32 v57, v57, v115
  v_mul_f32 v58, v58, v115
  v_mul_f32 v59, v59, v115
  v_cvt_pk_bf16_f32 v158, v56, v57
  v_cvt_pk_bf16_f32 v159, v58, v59
  v_mfma_f32_32x32x16_bf16 v[88:103], a[164:167], a[152:155], v[88:103]
  ds_write_b128 v24, v[140:143] offset:0
  ds_write_b128 v24, v[144:147] offset:16
  s_waitcnt lgkmcnt(2)
  v_mfma_f32_32x32x16_bf16 v[88:103], a[168:171], a[156:159], v[88:103]
  ds_write_b128 v24, v[148:151] offset:32
  ds_write_b128 v24, v[152:155] offset:48
  ds_write_b128 v24, v[156:159] offset:64
  v_mfma_f32_32x32x16_bf16 v[88:103], a[172:175], v[104:107], v[88:103]
  v_mul_f32 v60, v60, v111
  v_mul_f32 v61, v61, v111
  v_mul_f32 v62, v62, v111
  v_mul_f32 v63, v63, v111
  v_cvt_pk_bf16_f32 v40, v60, v61
  v_cvt_pk_bf16_f32 v41, v62, v63
  v_mul_f32 v64, v64, v111
  v_mul_f32 v65, v65, v111
  v_mul_f32 v66, v66, v111
  v_mul_f32 v67, v67, v111
  v_cvt_pk_bf16_f32 v42, v64, v65
  v_cvt_pk_bf16_f32 v43, v66, v67
  v_mul_f32 v68, v68, v111
  v_mul_f32 v69, v69, v111
  v_mul_f32 v70, v70, v111
  v_mul_f32 v71, v71, v111
  v_cvt_pk_bf16_f32 v44, v68, v69
  v_cvt_pk_bf16_f32 v45, v70, v71
  v_mul_f32 v72, v72, v111
  v_mul_f32 v73, v73, v111
  v_mul_f32 v74, v74, v111
  v_mul_f32 v75, v75, v111
  v_cvt_pk_bf16_f32 v46, v72, v73
  v_cvt_pk_bf16_f32 v47, v74, v75
  v_mul_f32 v76, v76, v111
  v_mul_f32 v77, v77, v111
  v_mul_f32 v78, v78, v111
  v_mul_f32 v79, v79, v111
  v_cvt_pk_bf16_f32 v48, v76, v77
  v_cvt_pk_bf16_f32 v49, v78, v79
  v_mov_b32 v50, 0x3f80
  v_mov_b32 v51, 0
  ds_write_b128 v24, v[40:43] offset:80
  ds_write_b128 v24, v[44:47] offset:96
  ds_write_b128 v24, v[48:51] offset:112
  s_waitcnt lgkmcnt(0)
  s_barrier
  ds_read_b64_tr_b16 a[100:101], v25 offset:0
  ds_read_b64_tr_b16 a[132:133], v26 offset:0
  ds_read_b64_tr_b16 a[102:103], v25 offset:144
  ds_read_b64_tr_b16 a[134:135], v26 offset:144
  ds_read_b64_tr_b16 a[104:105], v25 offset:2304
  ds_read_b64_tr_b16 a[136:137], v26 offset:2304
  ds_read_b64_tr_b16 a[106:107], v25 offset:2448
  ds_read_b64_tr_b16 a[138:139], v26 offset:2448
  ds_read_b64_tr_b16 a[108:109], v25 offset:4608
  ds_read_b64_tr_b16 a[140:141], v26 offset:4608
  ds_read_b64_tr_b16 a[110:111], v25 offset:4752
  ds_read_b64_tr_b16 a[142:143], v26 offset:4752
  s_waitcnt lgkmcnt(8)
  v_mfma_f32_32x32x16_bf16 v[40:55], a[100:103], a[132:135], 0
  ds_read_b64_tr_b16 a[112:113], v25 offset:6912
  ds_read_b64_tr_b16 a[144:145], v26 offset:6912
  ds_read_b64_tr_b16 a[114:115], v25 offset:7056
  ds_read_b64_tr_b16 a[146:147], v26 offset:7056
  s_add_u32 m0, s27, 65536
  s_add_u32 s34, s33, 0
  buffer_load_dwordx4 v1, s[20:23], s34 offen offset:0 sc1 lds
  s_waitcnt lgkmcnt(8)
  v_mfma_f32_32x32x16_bf16 v[40:55], a[104:107], a[136:139], v[40:55]
  ds_read_b64_tr_b16 a[116:117], v25 offset:9216
  ds_read_b64_tr_b16 a[148:149], v26 offset:9216
  ds_read_b64_tr_b16 a[118:119], v25 offset:9360
  ds_read_b64_tr_b16 a[150:151], v26 offset:9360
  buffer_load_dwordx4 v1, s[20:23], s34 offen offset:1024 sc1 lds
  s_waitcnt lgkmcnt(8)
  v_mfma_f32_32x32x16_bf16 v[40:55], a[108:111], a[140:143], v[40:55]
  ds_read_b64_tr_b16 a[120:121], v25 offset:11520
  ds_read_b64_tr_b16 a[152:153], v26 offset:11520
  ds_read_b64_tr_b16 a[122:123], v25 offset:11664
  ds_read_b64_tr_b16 a[154:155], v26 offset:11664
  buffer_load_dwordx4 v1, s[20:23], s34 offen offset:2048 sc1 lds
  s_waitcnt lgkmcnt(8)
  v_mfma_f32_32x32x16_bf16 v[40:55], a[112:115], a[144:147], v[40:55]
  ds_read_b64_tr_b16 a[124:125], v25 offset:13824
  ds_read_b64_tr_b16 a[156:157], v26 offset:13824
  ds_read_b64_tr_b16 a[126:127], v25 offset:13968
  ds_read_b64_tr_b16 a[158:159], v26 offset:13968
  buffer_load_dwordx4 v1, s[20:23], s34 offen offset:3072 sc1 lds
  s_waitcnt lgkmcnt(8)
  v_mfma_f32_32x32x16_bf16 v[40:55], a[116:119], a[148:151], v[40:55]
  ds_read_b64_tr_b16 a[128:129], v25 offset:16128
  ds_read_b64_tr_b16 a[160:161], v26 offset:16128
  ds_read_b64_tr_b16 a[130:131], v25 offset:16272
  ds_read_b64_tr_b16 a[162:163], v26 offset:16272
  s_add_u32 m0, s27, 69632
  s_add_u32 s34, s33, 4096
  buffer_load_dwordx4 v1, s[20:23], s34 offen offset:0 sc1 lds
  s_waitcnt lgkmcnt(8)
  v_mfma_f32_32x32x16_bf16 v[40:55], a[120:123], a[152:155], v[40:55]
  buffer_load_dwordx4 v1, s[20:23], s34 offen offset:1024 sc1 lds
  s_waitcnt lgkmcnt(4)
  v_mfma_f32_32x32x16_bf16 v[40:55], a[124:127], a[156:159], v[40:55]
  buffer_load_dwordx4 v1, s[20:23], s34 offen offset:2048 sc1 lds
  s_waitcnt lgkmcnt(0)
  v_mfma_f32_32x32x16_bf16 v[40:55], a[128:131], a[160:163], v[40:55]
  buffer_load_dwordx4 v1, s[20:23], s34 offen offset:3072 sc1 lds
  v_max3_f32 v112, v80, v81, v82
  v_min3_f32 v113, v80, v81, v82
  v_max3_f32 v112, v112, v83, v84
  v_min3_f32 v113, v113, v83, v84
  v_max3_f32 v112, v112, v85, v86
  v_min3_f32 v113, v113, v85, v86
  v_max3_f32 v112, v112, v87, v88
  v_min3_f32 v113, v113, v87, v88
  v_max3_f32 v112, v112, v89, v90
  v_min3_f32 v113, v113, v89, v90
  v_max3_f32 v112, v112, v91, v92
  v_min3_f32 v113, v113, v91, v92
  v_cvt_pk_bf16_f32 v60, v40, v41
  v_cvt_pk_bf16_f32 v61, v42, v43
  v_cvt_pk_bf16_f32 v62, v44, v45
  v_cvt_pk_bf16_f32 v63, v46, v47
  v_cvt_pk_bf16_f32 v64, v48, v49
  v_cvt_pk_bf16_f32 v65, v50, v51
  s_mov_b32 exec_lo, 0x1fffff
  s_mov_b32 exec_hi, 0x1fffff
  ds_write_b64 v27, v[60:61]
  ds_write_b64 v27, v[62:63] offset:16
  s_mov_b32 exec_hi, 0
  ds_write_b64 v27, v[64:65] offset:32
  s_mov_b64 exec, -1
  v_max3_f32 v112, v112, v93, v94
  v_min3_f32 v113, v113, v93, v94
  v_max3_f32 v112, v112, v95, v96
  v_min3_f32 v113, v113, v95, v96
  v_max3_f32 v112, v112, v97, v98
  v_min3_f32 v113, v113, v97, v98
  v_max_f32 v112, v112, v99
  v_min_f32 v113, v113, v99
  v_mul_f32 v112, v112, v110
  v_mul_f32 v113, v113, v110
  s_waitcnt lgkmcnt(0)
  s_barrier
  ds_read_b128 v[68:71], v28
  v_pk_fma_f32 v[118:119], v[80:81], v[110:111], v[112:113] op_sel:[0,0,0] op_sel_hi:[1,0,0] neg_lo:[0,0,1] neg_hi:[0,0,1]
  v_pk_fma_f32 v[80:81], v[80:81], v[110:111], v[112:113] op_sel:[0,0,1] op_sel_hi:[1,0,1] neg_lo:[1,0,0] neg_hi:[1,0,0]
  v_pk_fma_f32 v[120:121], v[82:83], v[110:111], v[112:113] op_sel:[0,0,0] op_sel_hi:[1,0,0] neg_lo:[0,0,1] neg_hi:[0,0,1]
  v_pk_fma_f32 v[82:83], v[82:83], v[110:111], v[112:113] op_sel:[0,0,1] op_sel_hi:[1,0,1] neg_lo:[1,0,0] neg_hi:[1,0,0]
  v_pk_fma_f32 v[122:123], v[84:85], v[110:111], v[112:113] op_sel:[0,0,0] op_sel_hi:[1,0,0] neg_lo:[0,0,1] neg_hi:[0,0,1]
  v_pk_fma_f32 v[84:85], v[84:85], v[110:111], v[112:113] op_sel:[0,0,1] op_sel_hi:[1,0,1] neg_lo:[1,0,0] neg_hi:[1,0,0]
  v_pk_fma_f32 v[124:125], v[86:87], v[110:111], v[112:113] op_sel:[0,0,0] op_sel_hi:[1,0,0] neg_lo:[0,0,1] neg_hi:[0,0,1]
  v_pk_fma_f32 v[86:87], v[86:87], v[110:111], v[112:113] op_sel:[0,0,1] op_sel_hi:[1,0,1] neg_lo:[1,0,0] neg_hi:[1,0,0]
  v_pk_fma_f32 v[126:127], v[88:89], v[110:111], v[112:113] op_sel:[0,0,0] op_sel_hi:[1,0,0] neg_lo:[0,0,1] neg_hi:[0,0,1]
  v_pk_fma_f32 v[88:89], v[88:89], v[110:111], v[112:113] op_sel:[0,0,1] op_sel_hi:[1,0,1] neg_lo:[1,0,0] neg_hi:[1,0,0]
  v_pk_fma_f32 v[128:129], v[90:91], v[110:111], v[112:113] op_sel:[0,0,0] op_sel_hi:[1,0,0] neg_lo:[0,0,1] neg_hi:[0,0,1]
  v_pk_fma_f32 v[90:91], v[90:91], v[110:111], v[112:113] op_sel:[0,0,1] op_sel_hi:[1,0,1] neg_lo:[1,0,0] neg_hi:[1,0,0]
  v_pk_fma_f32 v[130:131], v[92:93], v[110:111], v[112:113] op_sel:[0,0,0] op_sel_hi:[1,0,0] neg_lo:[0,0,1] neg_hi:[0,0,1]
  v_pk_fma_f32 v[92:93], v[92:93], v[110:111], v[112:113] op_sel:[0,0,1] op_sel_hi:[1,0,1] neg_lo:[1,0,0] neg_hi:[1,0,0]
  v_pk_fma_f32 v[132:133], v[94:95], v[110:111], v[112:113] op_sel:[0,0,0] op_sel_hi:[1,0,0] neg_lo:[0,0,1] neg_hi:[0,0,1]
  v_pk_fma_f32 v[94:95], v[94:95], v[110:111], v[112:113] op_sel:[0,0,1] op_sel_hi:[1,0,1] neg_lo:[1,0,0] neg_hi:[1,0,0]
  v_pk_fma_f32 v[134:135], v[96:97], v[110:111], v[112:113] op_sel:[0,0,0] op_sel_hi:[1,0,0] neg_lo:[0,0,1] neg_hi:[0,0,1]
  v_pk_fma_f32 v[96:97], v[96:97], v[110:111], v[112:113] op_sel:[0,0,1] op_sel_hi:[1,0,1] neg_lo:[1,0,0] neg_hi:[1,0,0]
  v_pk_fma_f32 v[136:137], v[98:99], v[110:111], v[112:113] op_sel:[0,0,0] op_sel_hi:[1,0,0] neg_lo:[0,0,1] neg_hi:[0,0,1]
  v_pk_fma_f32 v[98:99], v[98:99], v[110:111], v[112:113] op_sel:[0,0,1] op_sel_hi:[1,0,1] neg_lo:[1,0,0] neg_hi:[1,0,0]
  s_waitcnt lgkmcnt(0)
  buffer_store_dwordx4 v[68:71], v29, s[8:11], s38 offen sc1
  v_exp_f32 v118, v118
  v_exp_f32 v119, v119
  v_exp_f32 v80, v80
  v_exp_f32 v81, v81
  v_cvt_pk_bf16_f32 v140, v118, v119
  v_exp_f32 v120, v120
  v_exp_f32 v121, v121
  v_exp_f32 v82, v82
  v_exp_f32 v83, v83
  v_pk_add_f32 v[114:115], v[118:119], v[120:121]
  v_cvt_pk_bf16_f32 v141, v120, v121
  v_exp_f32 v122, v122
  v_exp_f32 v123, v123
  v_exp_f32 v84, v84
  v_exp_f32 v85, v85
  v_pk_add_f32 v[116:117], v[80:81], v[82:83]
  v_pk_add_f32 v[114:115], v[114:115], v[122:123]
  v_cvt_pk_bf16_f32 v142, v122, v123
  v_exp_f32 v124, v124
  v_exp_f32 v125, v125
  v_exp_f32 v86, v86
  v_exp_f32 v87, v87
  v_pk_add_f32 v[114:115], v[114:115], v[124:125]
  v_pk_add_f32 v[116:117], v[116:117], v[84:85]
  v_cvt_pk_bf16_f32 v143, v124, v125
  v_exp_f32 v126, v126
  v_exp_f32 v127, v127
  v_exp_f32 v88, v88
  v_exp_f32 v89, v89
  v_pk_add_f32 v[114:115], v[114:115], v[126:127]
  v_pk_add_f32 v[116:117], v[116:117], v[86:87]
  v_cvt_pk_bf16_f32 v144, v126, v127
  v_exp_f32 v128, v128
  v_exp_f32 v129, v129
  v_exp_f32 v90, v90
  v_exp_f32 v91, v91
  v_pk_add_f32 v[114:115], v[114:115], v[128:129]
  v_pk_add_f32 v[116:117], v[116:117], v[88:89]
  v_cvt_pk_bf16_f32 v145, v128, v129
  v_exp_f32 v130, v130
  v_exp_f32 v131, v131
  v_exp_f32 v92, v92
  v_exp_f32 v93, v93
  v_pk_add_f32 v[114:115], v[114:115], v[130:131]
  v_pk_add_f32 v[116:117], v[116:117], v[90:91]
  v_cvt_pk_bf16_f32 v146, v130, v131
  v_exp_f32 v132, v132
  v_exp_f32 v133, v133
  v_exp_f32 v94, v94
  v_exp_f32 v95, v95
  v_pk_add_f32 v[114:115], v[114:115], v[132:133]
  v_pk_add_f32 v[116:117], v[116:117], v[92:93]
  v_cvt_pk_bf16_f32 v147, v132, v133
  v_exp_f32 v134, v134
  v_exp_f32 v135, v135
  v_exp_f32 v96, v96
  v_exp_f32 v97, v97
  v_pk_add_f32 v[114:115], v[114:115], v[134:135]
  v_pk_add_f32 v[116:117], v[116:117], v[94:95]
  v_cvt_pk_bf16_f32 v148, v134, v135
  v_exp_f32 v136, v136
  v_exp_f32 v137, v137
  v_exp_f32 v98, v98
  v_exp_f32 v99, v99
  v_pk_add_f32 v[114:115], v[114:115], v[136:137]
  v_pk_add_f32 v[116:117], v[116:117], v[96:97]
  v_cvt_pk_bf16_f32 v149, v136, v137
  v_pk_add_f32 v[116:117], v[116:117], v[98:99]
  v_add_f32 v114, v114, v115
  v_add_f32 v116, v116, v117
  v_rcp_f32 v116, v116
  s_nop 0
  v_mul_f32 v116, v116, v114
  v_pk_mul_f32 v[80:81], v[80:81], v[116:117] op_sel:[0,0] op_sel_hi:[1,0]
  v_pk_mul_f32 v[82:83], v[82:83], v[116:117] op_sel:[0,0] op_sel_hi:[1,0]
  v_pk_mul_f32 v[84:85], v[84:85], v[116:117] op_sel:[0,0] op_sel_hi:[1,0]
  v_pk_mul_f32 v[86:87], v[86:87], v[116:117] op_sel:[0,0] op_sel_hi:[1,0]
  v_pk_mul_f32 v[88:89], v[88:89], v[116:117] op_sel:[0,0] op_sel_hi:[1,0]
  v_pk_mul_f32 v[90:91], v[90:91], v[116:117] op_sel:[0,0] op_sel_hi:[1,0]
  v_pk_mul_f32 v[92:93], v[92:93], v[116:117] op_sel:[0,0] op_sel_hi:[1,0]
  v_pk_mul_f32 v[94:95], v[94:95], v[116:117] op_sel:[0,0] op_sel_hi:[1,0]
  v_pk_mul_f32 v[96:97], v[96:97], v[116:117] op_sel:[0,0] op_sel_hi:[1,0]
  v_pk_mul_f32 v[98:99], v[98:99], v[116:117] op_sel:[0,0] op_sel_hi:[1,0]
  v_cvt_pk_bf16_f32 v150, v80, v81
  v_cvt_pk_bf16_f32 v151, v82, v83
  v_cvt_pk_bf16_f32 v152, v84, v85
  v_cvt_pk_bf16_f32 v153, v86, v87
  v_cvt_pk_bf16_f32 v154, v88, v89
  v_cvt_pk_bf16_f32 v155, v90, v91
  v_cvt_pk_bf16_f32 v156, v92, v93
  v_cvt_pk_bf16_f32 v157, v94, v95
  v_cvt_pk_bf16_f32 v158, v96, v97
  v_cvt_pk_bf16_f32 v159, v98, v99
  s_mov_b32 s3, s39
  buffer_load_dwordx4 a[100:103], v29, s[8:11], s3 offen sc1
  s_addk_i32 s3, 4096
  buffer_load_dwordx4 a[104:107], v29, s[8:11], s3 offen sc1
  s_addk_i32 s3, 4096
  buffer_load_dwordx4 a[108:111], v29, s[8:11], s3 offen sc1
  s_addk_i32 s3, 4096
  buffer_load_dwordx4 a[112:115], v29, s[8:11], s3 offen sc1
  s_addk_i32 s3, 4096
  buffer_load_dwordx4 a[116:119], v29, s[8:11], s3 offen sc1
  s_addk_i32 s3, 4096
  buffer_load_dwordx4 a[120:123], v29, s[8:11], s3 offen sc1
  s_addk_i32 s3, 4096
  buffer_load_dwordx4 a[124:127], v29, s[8:11], s3 offen sc1
  s_addk_i32 s3, 4096
  buffer_load_dwordx4 a[128:131], v29, s[8:11], s3 offen sc1
  s_addk_i32 s3, 4096
  buffer_load_dwordx4 a[132:135], v29, s[8:11], s3 offen sc1
  s_addk_i32 s3, 4096
  buffer_load_dwordx4 a[136:139], v29, s[8:11], s3 offen sc1
  s_addk_i32 s3, 4096
  buffer_load_dwordx4 a[140:143], v29, s[8:11], s3 offen sc1
  s_addk_i32 s3, 4096
  buffer_load_dwordx4 a[144:147], v29, s[8:11], s3 offen sc1
  s_addk_i32 s3, 4096
  buffer_load_dwordx4 a[148:151], v29, s[8:11], s3 offen sc1
  s_addk_i32 s3, 4096
  buffer_load_dwordx4 a[152:155], v29, s[8:11], s3 offen sc1
  s_addk_i32 s3, 4096
  buffer_load_dwordx4 a[156:159], v29, s[8:11], s3 offen sc1
  s_addk_i32 s3, 4096
  buffer_load_dwordx4 a[160:163], v29, s[8:11], s3 offen sc1
  s_addk_i32 s3, 4096
  s_waitcnt vmcnt(15)
  v_mfma_f32_32x32x16_bf16 v[40:55], v[36:39], a[100:103], 0
  s_waitcnt vmcnt(14)
  v_mfma_f32_32x32x16_bf16 v[40:55], v[36:39], a[104:107], v[40:55]
  s_add_u32 m0, s27, 98304
  s_add_u32 s34, s33, 32768
  buffer_load_dwordx4 v1, s[20:23], s34 offen offset:0 sc1 lds
  s_waitcnt vmcnt(14)
  v_mfma_f32_32x32x16_bf16 v[40:55], v[36:39], a[108:111], v[40:55]
  s_waitcnt vmcnt(13)
  v_mfma_f32_32x32x16_bf16 v[40:55], v[36:39], a[112:115], v[40:55]
  buffer_load_dwordx4 v1, s[20:23], s34 offen offset:1024 sc1 lds
  s_waitcnt vmcnt(13)
  v_mfma_f32_32x32x16_bf16 v[40:55], v[36:39], a[116:119], v[40:55]
  s_waitcnt vmcnt(12)
  v_mfma_f32_32x32x16_bf16 v[40:55], v[36:39], a[120:123], v[40:55]
  buffer_load_dwordx4 v1, s[20:23], s34 offen offset:2048 sc1 lds
  s_waitcnt vmcnt(12)
  v_mfma_f32_32x32x16_bf16 v[40:55], v[36:39], a[124:127], v[40:55]
  s_waitcnt vmcnt(11)
  v_mfma_f32_32x32x16_bf16 v[40:55], v[36:39], a[128:131], v[40:55]
  buffer_load_dwordx4 v1, s[20:23], s34 offen offset:3072 sc1 lds
  s_waitcnt vmcnt(11)
  v_mfma_f32_32x32x16_bf16 v[40:55], v[36:39], a[132:135], v[40:55]
  s_add_u32 m0, s27, 102400
  s_add_u32 s34, s33, 36864
  buffer_load_dwordx4 v1, s[20:23], s34 offen offset:0 sc1 lds
  s_waitcnt vmcnt(11)
  v_mfma_f32_32x32x16_bf16 v[40:55], v[36:39], a[136:139], v[40:55]
  s_waitcnt vmcnt(10)
  v_mfma_f32_32x32x16_bf16 v[40:55], v[36:39], a[140:143], v[40:55]
  buffer_load_dwordx4 v1, s[20:23], s34 offen offset:1024 sc1 lds
  s_waitcnt vmcnt(10)
  v_mfma_f32_32x32x16_bf16 v[40:55], v[36:39], a[144:147], v[40:55]
  s_waitcnt vmcnt(9)
  v_mfma_f32_32x32x16_bf16 v[40:55], v[36:39], a[148:151], v[40:55]
  buffer_load_dwordx4 v1, s[20:23], s34 offen offset:2048 sc1 lds
  s_waitcnt vmcnt(9)
  v_mfma_f32_32x32x16_bf16 v[40:55], v[36:39], a[152:155], v[40:55]
  s_waitcnt vmcnt(8)
  v_mfma_f32_32x32x16_bf16 v[40:55], v[36:39], a[156:159], v[40:55]
  buffer_load_dwordx4 v1, s[20:23], s34 offen offset:3072 sc1 lds
  s_waitcnt vmcnt(8)
  v_mfma_f32_32x32x16_bf16 v[40:55], v[36:39], a[160:163], v[40:55]
  s_add_u32 m0, s27, 131072
  s_add_u32 s34, s33, 65536
  buffer_load_dwordx4 v1, s[20:23], s34 offen offset:0 sc1 lds
  s_nop 8
  v_cmp_u_f32 vcc, v40, v40
  s_nop 3
  s_cbranch_vccnz P1_RETRY_2
P1_SUMMED_2:
  v_cvt_pk_bf16_f32 v68, v40, v41
  v_cvt_pk_bf16_f32 v69, v42, v43
  v_cvt_pk_bf16_f32 v70, v44, v45
  v_cvt_pk_bf16_f32 v71, v46, v47
  ds_write_b128 v28, v[68:71]
  s_waitcnt lgkmcnt(0)
  s_barrier
  ds_read_b128 a[100:103], v32 offset:0
  ds_read_b128 a[104:107], v33 offset:0
  ds_read_b128 a[108:111], v32 offset:16
  ds_read_b128 a[112:115], v33 offset:16
  ds_read_b128 a[116:119], v32 offset:32
  ds_read_b128 a[120:123], v33 offset:32
  ds_read_b128 a[124:127], v32 offset:48
  ds_read_b128 a[128:131], v33 offset:48
  ds_read_b128 a[132:135], v32 offset:64
  ds_read_b128 a[136:139], v33 offset:64
  s_waitcnt lgkmcnt(8)
  v_mfma_f32_32x32x16_bf16 v[56:71], a[104:107], v[140:143], 0
  v_mfma_f32_32x32x16_bf16 v[40:55], a[100:103], v[140:143], 0
  s_waitcnt lgkmcnt(6)
  v_mfma_f32_32x32x16_bf16 v[56:71], a[112:115], v[144:147], v[56:71]
  v_mfma_f32_32x32x16_bf16 v[40:55], a[108:111], v[144:147], v[40:55]
  s_waitcnt lgkmcnt(4)
  v_mfma_f32_32x32x16_bf16 v[56:71], a[120:123], v[148:151], v[56:71]
  v_mfma_f32_32x32x16_bf16 v[40:55], a[116:119], v[148:151], v[40:55]
  s_waitcnt lgkmcnt(2)
  v_mfma_f32_32x32x16_bf16 v[56:71], a[128:131], v[152:155], v[56:71]
  v_mfma_f32_32x32x16_bf16 v[40:55], a[124:127], v[152:155], v[40:55]
  s_waitcnt lgkmcnt(0)
  v_mfma_f32_32x32x16_bf16 v[56:71], a[136:139], v[156:159], v[56:71]
  v_mfma_f32_32x32x16_bf16 v[40:55], a[132:135], v[156:159], v[40:55]
  v_mul_f32 v114, 0x358637bd, v114
  s_nop 9
  v_add_f32 v114, v114, v60
  v_rcp_f32 v114, v114
  s_nop 0
  v_pk_mul_f32 v[56:57], v[56:57], v[114:115] op_sel:[0,0] op_sel_hi:[1,0]
  v_pk_mul_f32 v[58:59], v[58:59], v[114:115] op_sel:[0,0] op_sel_hi:[1,0]
  v_pk_mul_f32 v[40:41], v[40:41], v[114:115] op_sel:[0,0] op_sel_hi:[1,0]
  v_pk_mul_f32 v[42:43], v[42:43], v[114:115] op_sel:[0,0] op_sel_hi:[1,0]
  v_pk_mul_f32 v[44:45], v[44:45], v[114:115] op_sel:[0,0] op_sel_hi:[1,0]
  v_pk_mul_f32 v[46:47], v[46:47], v[114:115] op_sel:[0,0] op_sel_hi:[1,0]
  v_pk_mul_f32 v[48:49], v[48:49], v[114:115] op_sel:[0,0] op_sel_hi:[1,0]
  v_pk_mul_f32 v[50:51], v[50:51], v[114:115] op_sel:[0,0] op_sel_hi:[1,0]
  v_pk_mul_f32 v[52:53], v[52:53], v[114:115] op_sel:[0,0] op_sel_hi:[1,0]
  v_pk_mul_f32 v[54:55], v[54:55], v[114:115] op_sel:[0,0] op_sel_hi:[1,0]
  v_cvt_pk_bf16_f32 v148, v56, v57
  v_cvt_pk_bf16_f32 v149, v58, v59
  v_cvt_pk_bf16_f32 v140, v40, v41
  v_cvt_pk_bf16_f32 v141, v42, v43
  v_cvt_pk_bf16_f32 v142, v44, v45
  v_cvt_pk_bf16_f32 v143, v46, v47
  v_cvt_pk_bf16_f32 v144, v48, v49
  v_cvt_pk_bf16_f32 v145, v50, v51
  v_cvt_pk_bf16_f32 v146, v52, v53
  v_cvt_pk_bf16_f32 v147, v54, v55
  s_cmp_lg_u32 s16, 0
  s_cbranch_scc1 HS7_2
  buffer_store_dwordx2 v[148:149], v31, s[8:11], s41 offen
  buffer_store_dwordx4 v[140:143], v30, s[8:11], s40 offen
  buffer_store_dwordx4 v[144:147], v30, s[8:11], s40 offen offset:256
HB7_2:
  s_barrier
  s_waitcnt vmcnt(0)
  s_add_u32 s3, s42, 12455936
  s_mov_b64 exec, 1
  s_cmp_lg_u32 s16, 0
  s_cbranch_scc1 HS8_2
  buffer_store_dword v20, v1, s[8:11], s3 offen
HB8_2:
  s_mov_b64 exec, -1
  s_add_u32 s70, s45, 12455936
  s_mov_b64 exec, 0xff
  buffer_load_dword v21, v5, s[8:11], s70 offen sc1
  s_mov_b64 exec, -1
  s_waitcnt vmcnt(0)
  v_cmp_ne_u32 vcc, v20, v21
  s_nop 3
  s_and_b64 vcc, vcc, 0xff
  s_cbranch_vccnz PO_SPIN_2
PO_OK_2:
  buffer_load_dwordx4 a[100:103], v1, s[8:11], s46 offen offset:0 sc1
  buffer_load_dwordx4 a[104:107], v1, s[8:11], s46 offen offset:1024 sc1
  buffer_load_dwordx4 a[108:111], v1, s[8:11], s46 offen offset:2048 sc1
  buffer_load_dwordx4 a[112:115], v1, s[8:11], s46 offen offset:3072 sc1
  s_add_u32 s54, s46, 4096
  buffer_load_dwordx4 a[116:119], v1, s[8:11], s54 offen offset:0 sc1
  buffer_load_dwordx4 a[120:123], v1, s[8:11], s47 offen offset:0 sc1
  buffer_load_dwordx4 a[124:127], v1, s[8:11], s47 offen offset:1024 sc1
  buffer_load_dwordx4 a[128:131], v1, s[8:11], s47 offen offset:2048 sc1
  buffer_load_dwordx4 a[132:135], v1, s[8:11], s47 offen offset:3072 sc1
  s_add_u32 s54, s47, 4096
  buffer_load_dwordx4 a[136:139], v1, s[8:11], s54 offen offset:0 sc1
  buffer_load_dwordx4 a[140:143], v1, s[8:11], s48 offen offset:0 sc1
  buffer_load_dwordx4 a[144:147], v1, s[8:11], s48 offen offset:1024 sc1
  s_add_u32 s3, s12, 1
  s_and_b32 s3, s3, 3
  s_mul_i32 s3, s3, 15360
  s_add_u32 s3, s3, 4096
  v_add_u32 v86, s3, v1
  s_add_u32 s3, s12, 2
  s_and_b32 s3, s3, 3
  s_mul_i32 s3, s3, 15360
  s_add_u32 s3, s3, 9216
  v_add_u32 v87, s3, v1
  s_add_u32 s3, s12, 3
  s_and_b32 s3, s3, 3
  s_mul_i32 s3, s3, 15360
  s_add_u32 s3, s3, 14336
  v_add_u32 v88, s3, v1
  s_mul_i32 s3, s12, 15360
  s_add_u32 s3, s3, 4096
  v_add_u32 v89, s3, v1
  v_lshlrev_b32 v64, 16, v10
  v_and_b32 v65, 0xffff0000, v10
  v_lshlrev_b32 v66, 16, v11
  v_and_b32 v67, 0xffff0000, v11
  v_lshlrev_b32 v68, 16, v12
  v_and_b32 v69, 0xffff0000, v12
  v_lshlrev_b32 v70, 16, v13
  v_and_b32 v71, 0xffff0000, v13
  v_lshlrev_b32 v72, 16, v14
  v_and_b32 v73, 0xffff0000, v14
  v_lshlrev_b32 v74, 16, v15
  v_and_b32 v75, 0xffff0000, v15
  v_lshlrev_b32 v76, 16, v16
  v_and_b32 v77, 0xffff0000, v16
  v_lshlrev_b32 v78, 16, v17
  v_and_b32 v79, 0xffff0000, v17
  v_lshlrev_b32 v80, 16, v18
  v_and_b32 v81, 0xffff0000, v18
  v_lshlrev_b32 v82, 16, v19
  v_and_b32 v83, 0xffff0000, v19
  s_waitcnt vmcnt(11)
  v_mfma_f32_16x16x32_bf16 v[24:27], a[0:3], a[100:103], 0
  buffer_load_dwordx4 a[148:151], v1, s[8:11], s48 offen offset:2048 sc1
  v_mfma_f32_16x16x32_bf16 v[28:31], a[4:7], a[100:103], 0
  buffer_load_dwordx4 a[152:155], v1, s[8:11], s48 offen offset:3072 sc1
  v_mfma_f32_16x16x32_bf16 v[32:35], a[8:11], a[100:103], 0
  s_add_u32 s54, s48, 4096
  buffer_load_dwordx4 a[156:159], v1, s[8:11], s54 offen offset:0 sc1
  v_mfma_f32_16x16x32_bf16 v[36:39], a[12:15], a[100:103], 0
  buffer_load_dwordx4 a[160:163], v1, s[8:11], s49 offen offset:0 sc1
  v_mfma_f32_16x16x32_bf16 v[40:43], a[16:19], a[100:103], 0
  buffer_load_dwordx4 a[164:167], v1, s[8:11], s49 offen offset:1024 sc1
  s_waitcnt vmcnt(15)
  v_mfma_f32_16x16x32_bf16 v[24:27], a[20:23], a[104:107], v[24:27]
  buffer_load_dwordx4 a[168:171], v1, s[8:11], s49 offen offset:2048 sc1
  v_mfma_f32_16x16x32_bf16 v[28:31], a[24:27], a[104:107], v[28:31]
  buffer_load_dwordx4 a[172:175], v1, s[8:11], s49 offen offset:3072 sc1
  v_mfma_f32_16x16x32_bf16 v[32:35], a[28:31], a[104:107], v[32:35]
  s_add_u32 s54, s49, 4096
  buffer_load_dwordx4 a[176:179], v1, s[8:11], s54 offen offset:0 sc1
  v_mfma_f32_16x16x32_bf16 v[36:39], a[32:35], a[104:107], v[36:39]
  v_mfma_f32_16x16x32_bf16 v[40:43], a[36:39], a[104:107], v[40:43]
  s_waitcnt vmcnt(17)
  v_mfma_f32_16x16x32_bf16 v[24:27], a[40:43], a[108:111], v[24:27]
  v_mfma_f32_16x16x32_bf16 v[28:31], a[44:47], a[108:111], v[28:31]
  v_mfma_f32_16x16x32_bf16 v[32:35], a[48:51], a[108:111], v[32:35]
  v_mfma_f32_16x16x32_bf16 v[36:39], a[52:55], a[108:111], v[36:39]
  v_mfma_f32_16x16x32_bf16 v[40:43], a[56:59], a[108:111], v[40:43]
  s_waitcnt vmcnt(16)
  v_mfma_f32_16x16x32_bf16 v[24:27], a[60:63], a[112:115], v[24:27]
  v_mfma_f32_16x16x32_bf16 v[28:31], a[64:67], a[112:115], v[28:31]
  v_mfma_f32_16x16x32_bf16 v[32:35], a[68:71], a[112:115], v[32:35]
  v_mfma_f32_16x16x32_bf16 v[36:39], a[72:75], a[112:115], v[36:39]
  v_mfma_f32_16x16x32_bf16 v[40:43], a[76:79], a[112:115], v[40:43]
  s_waitcnt vmcnt(15)
  v_mfma_f32_16x16x32_bf16 v[24:27], a[80:83], a[116:119], v[24:27]
  buffer_load_dwordx4 v1, s[20:23], s34 offen offset:1024 sc1 lds
  v_mfma_f32_16x16x32_bf16 v[28:31], a[84:87], a[116:119], v[28:31]
  v_mfma_f32_16x16x32_bf16 v[32:35], a[88:91], a[116:119], v[32:35]
  v_mfma_f32_16x16x32_bf16 v[36:39], a[92:95], a[116:119], v[36:39]
  buffer_load_dwordx4 v1, s[20:23], s34 offen offset:2048 sc1 lds
  v_mfma_f32_16x16x32_bf16 v[40:43], a[96:99], a[116:119], v[40:43]
  s_waitcnt vmcnt(16)
  v_mfma_f32_16x16x32_bf16 v[44:47], a[0:3], a[120:123], 0
  v_mfma_f32_16x16x32_bf16 v[48:51], a[4:7], a[120:123], 0
  buffer_load_dwordx4 v1, s[20:23], s34 offen offset:3072 sc1 lds
  v_mfma_f32_16x16x32_bf16 v[52:55], a[8:11], a[120:123], 0
  ds_write_b128 v86, v[24:27] offset:0
  v_mfma_f32_16x16x32_bf16 v[56:59], a[12:15], a[120:123], 0
  v_mfma_f32_16x16x32_bf16 v[60:63], a[16:19], a[120:123], 0
  s_add_u32 m0, s27, 135168
  s_add_u32 s34, s33, 69632
  buffer_load_dwordx4 v1, s[20:23], s34 offen offset:0 sc1 lds
  s_waitcnt vmcnt(17)
  v_mfma_f32_16x16x32_bf16 v[44:47], a[20:23], a[124:127], v[44:47]
  ds_write_b128 v86, v[28:31] offset:1024
  v_mfma_f32_16x16x32_bf16 v[48:51], a[24:27], a[124:127], v[48:51]
  ds_write_b128 v86, v[32:35] offset:2048
  v_mfma_f32_16x16x32_bf16 v[52:55], a[28:31], a[124:127], v[52:55]
  buffer_load_dwordx4 v1, s[20:23], s34 offen offset:1024 sc1 lds
  v_mfma_f32_16x16x32_bf16 v[56:59], a[32:35], a[124:127], v[56:59]
  ds_write_b128 v86, v[36:39] offset:3072
  v_mfma_f32_16x16x32_bf16 v[60:63], a[36:39], a[124:127], v[60:63]
  s_waitcnt vmcnt(17)
  v_mfma_f32_16x16x32_bf16 v[44:47], a[40:43], a[128:131], v[44:47]
  buffer_load_dwordx4 v1, s[20:23], s34 offen offset:2048 sc1 lds
  v_mfma_f32_16x16x32_bf16 v[48:51], a[44:47], a[128:131], v[48:51]
  ds_write_b128 v86, v[40:43] offset:4096
  v_mfma_f32_16x16x32_bf16 v[52:55], a[48:51], a[128:131], v[52:55]
  v_mfma_f32_16x16x32_bf16 v[56:59], a[52:55], a[128:131], v[56:59]
  buffer_load_dwordx4 v1, s[20:23], s34 offen offset:3072 sc1 lds
  v_mfma_f32_16x16x32_bf16 v[60:63], a[56:59], a[128:131], v[60:63]
  s_waitcnt vmcnt(18)
  v_mfma_f32_16x16x32_bf16 v[44:47], a[60:63], a[132:135], v[44:47]
  v_mfma_f32_16x16x32_bf16 v[48:51], a[64:67], a[132:135], v[48:51]
  s_add_u32 m0, s25, 0
  s_add_u32 s34, s31, 98304
  buffer_load_dwordx4 v1, s[20:23], s34 offen offset:0 sc1 lds
  v_mfma_f32_16x16x32_bf16 v[52:55], a[68:71], a[132:135], v[52:55]
  v_mfma_f32_16x16x32_bf16 v[56:59], a[72:75], a[132:135], v[56:59]
  v_mfma_f32_16x16x32_bf16 v[60:63], a[76:79], a[132:135], v[60:63]
  s_add_u32 s77, s56, 40960
  buffer_load_dwordx4 v[112:115], v1, s[8:11], s77 offen offset:0 sc1
  s_waitcnt vmcnt(19)
  v_mfma_f32_16x16x32_bf16 v[44:47], a[80:83], a[136:139], v[44:47]
  v_mfma_f32_16x16x32_bf16 v[48:51], a[84:87], a[136:139], v[48:51]
  v_mfma_f32_16x16x32_bf16 v[52:55], a[88:91], a[136:139], v[52:55]
  buffer_load_dwordx4 v[116:119], v1, s[8:11], s77 offen offset:1024 sc1
  v_mfma_f32_16x16x32_bf16 v[56:59], a[92:95], a[136:139], v[56:59]
  v_mfma_f32_16x16x32_bf16 v[60:63], a[96:99], a[136:139], v[60:63]
  s_waitcnt vmcnt(19)
  v_mfma_f32_16x16x32_bf16 v[24:27], a[0:3], a[140:143], 0
  buffer_load_dwordx4 v[120:123], v1, s[8:11], s77 offen offset:2048 sc1
  v_mfma_f32_16x16x32_bf16 v[28:31], a[4:7], a[140:143], 0
  v_mfma_f32_16x16x32_bf16 v[32:35], a[8:11], a[140:143], 0
  ds_write_b128 v87, v[44:47] offset:0
  v_mfma_f32_16x16x32_bf16 v[36:39], a[12:15], a[140:143], 0
  buffer_load_dwordx4 v[124:127], v1, s[8:11], s77 offen offset:3072 sc1
  v_mfma_f32_16x16x32_bf16 v[40:43], a[16:19], a[140:143], 0
  ds_write_b128 v87, v[48:51] offset:1024
  s_waitcnt vmcnt(20)
  v_mfma_f32_16x16x32_bf16 v[24:27], a[20:23], a[144:147], v[24:27]
  v_mfma_f32_16x16x32_bf16 v[28:31], a[24:27], a[144:147], v[28:31]
  s_add_u32 s77, s56, 45056
  buffer_load_dwordx4 v[128:131], v1, s[8:11], s77 offen offset:0 sc1
  v_mfma_f32_16x16x32_bf16 v[32:35], a[28:31], a[144:147], v[32:35]
  ds_write_b128 v87, v[52:55] offset:2048
  v_mfma_f32_16x16x32_bf16 v[36:39], a[32:35], a[144:147], v[36:39]
  ds_write_b128 v87, v[56:59] offset:3072
  v_mfma_f32_16x16x32_bf16 v[40:43], a[36:39], a[144:147], v[40:43]
  buffer_load_dwordx4 v[132:135], v4, s[8:11], s77 offen offset:1024 sc1
  s_waitcnt vmcnt(21)
  v_mfma_f32_16x16x32_bf16 v[24:27], a[40:43], a[148:151], v[24:27]
  ds_write_b128 v87, v[60:63] offset:4096
  v_mfma_f32_16x16x32_bf16 v[28:31], a[44:47], a[148:151], v[28:31]
  v_mfma_f32_16x16x32_bf16 v[32:35], a[48:51], a[148:151], v[32:35]
  buffer_load_dwordx4 v[136:139], v4, s[8:11], s77 offen offset:2048 sc1
  v_mfma_f32_16x16x32_bf16 v[36:39], a[52:55], a[148:151], v[36:39]
  v_mfma_f32_16x16x32_bf16 v[40:43], a[56:59], a[148:151], v[40:43]
  s_waitcnt vmcnt(21)
  v_mfma_f32_16x16x32_bf16 v[24:27], a[60:63], a[152:155], v[24:27]
  buffer_load_dwordx4 v[140:143], v4, s[8:11], s77 offen offset:3072 sc1
  v_mfma_f32_16x16x32_bf16 v[28:31], a[64:67], a[152:155], v[28:31]
  v_mfma_f32_16x16x32_bf16 v[32:35], a[68:71], a[152:155], v[32:35]
  v_mfma_f32_16x16x32_bf16 v[36:39], a[72:75], a[152:155], v[36:39]
  s_add_u32 s77, s56, 49152
  buffer_load_dwordx4 v[144:147], v4, s[8:11], s77 offen offset:0 sc1
  v_mfma_f32_16x16x32_bf16 v[40:43], a[76:79], a[152:155], v[40:43]
  s_waitcnt vmcnt(22)
  v_mfma_f32_16x16x32_bf16 v[24:27], a[80:83], a[156:159], v[24:27]
  v_mfma_f32_16x16x32_bf16 v[28:31], a[84:87], a[156:159], v[28:31]
  buffer_load_dwordx4 v[148:151], v4, s[8:11], s77 offen offset:1024 sc1
  v_mfma_f32_16x16x32_bf16 v[32:35], a[88:91], a[156:159], v[32:35]
  v_mfma_f32_16x16x32_bf16 v[36:39], a[92:95], a[156:159], v[36:39]
  v_mfma_f32_16x16x32_bf16 v[40:43], a[96:99], a[156:159], v[40:43]
  buffer_load_dwordx4 v[152:155], v1, s[8:11], s77 offen offset:2048 sc1
  s_waitcnt vmcnt(23)
  v_mfma_f32_16x16x32_bf16 v[44:47], a[0:3], a[160:163], 0
  v_mfma_f32_16x16x32_bf16 v[48:51], a[4:7], a[160:163], 0
  v_mfma_f32_16x16x32_bf16 v[52:55], a[8:11], a[160:163], 0
  buffer_load_dwordx4 v[156:159], v1, s[8:11], s77 offen offset:3072 sc1
  v_mfma_f32_16x16x32_bf16 v[56:59], a[12:15], a[160:163], 0
  ds_write_b128 v88, v[24:27] offset:0
  v_mfma_f32_16x16x32_bf16 v[60:63], a[16:19], a[160:163], 0
  ds_write_b128 v88, v[28:31] offset:1024
  s_waitcnt vmcnt(23)
  v_mfma_f32_16x16x32_bf16 v[44:47], a[20:23], a[164:167], v[44:47]
  v_mfma_f32_16x16x32_bf16 v[48:51], a[24:27], a[164:167], v[48:51]
  ds_write_b128 v88, v[32:35] offset:2048
  v_mfma_f32_16x16x32_bf16 v[52:55], a[28:31], a[164:167], v[52:55]
  v_mfma_f32_16x16x32_bf16 v[56:59], a[32:35], a[164:167], v[56:59]
  ds_write_b128 v88, v[36:39] offset:3072
  v_mfma_f32_16x16x32_bf16 v[60:63], a[36:39], a[164:167], v[60:63]
  s_waitcnt vmcnt(22)
  v_mfma_f32_16x16x32_bf16 v[44:47], a[40:43], a[168:171], v[44:47]
  ds_write_b128 v88, v[40:43] offset:4096
  v_mfma_f32_16x16x32_bf16 v[48:51], a[44:47], a[168:171], v[48:51]
  v_mfma_f32_16x16x32_bf16 v[52:55], a[48:51], a[168:171], v[52:55]
  v_mfma_f32_16x16x32_bf16 v[56:59], a[52:55], a[168:171], v[56:59]
  v_mfma_f32_16x16x32_bf16 v[60:63], a[56:59], a[168:171], v[60:63]
  s_waitcnt vmcnt(21)
  v_mfma_f32_16x16x32_bf16 v[44:47], a[60:63], a[172:175], v[44:47]
  v_mfma_f32_16x16x32_bf16 v[48:51], a[64:67], a[172:175], v[48:51]
  v_mfma_f32_16x16x32_bf16 v[52:55], a[68:71], a[172:175], v[52:55]
  v_mfma_f32_16x16x32_bf16 v[56:59], a[72:75], a[172:175], v[56:59]
  s_waitcnt lgkmcnt(0)
  s_barrier
  v_mfma_f32_16x16x32_bf16 v[60:63], a[76:79], a[172:175], v[60:63]
  ds_read_b128 v[24:27], v89 offset:0
  ds_read_b128 v[28:31], v89 offset:1024
  s_waitcnt vmcnt(20)
  v_mfma_f32_16x16x32_bf16 v[44:47], a[80:83], a[176:179], v[44:47]
  ds_read_b128 v[32:35], v89 offset:2048
  ds_read_b128 v[36:39], v89 offset:3072
  v_mfma_f32_16x16x32_bf16 v[48:51], a[84:87], a[176:179], v[48:51]
  ds_read_b128 v[40:43], v89 offset:4096
  ds_read_b128 v[92:95], v89 offset:5120
  v_mfma_f32_16x16x32_bf16 v[52:55], a[88:91], a[176:179], v[52:55]
  ds_read_b128 v[96:99], v89 offset:6144
  ds_read_b128 v[100:103], v89 offset:7168
  v_mfma_f32_16x16x32_bf16 v[56:59], a[92:95], a[176:179], v[56:59]
  ds_read_b128 v[104:107], v89 offset:8192
  ds_read_b128 v[108:111], v89 offset:9216
  v_mfma_f32_16x16x32_bf16 v[60:63], a[96:99], a[176:179], v[60:63]
  s_waitcnt lgkmcnt(9)
  v_pk_add_f32 v[64:65], v[64:65], v[24:25]
  v_pk_add_f32 v[66:67], v[66:67], v[26:27]
  s_waitcnt lgkmcnt(8)
  v_pk_add_f32 v[68:69], v[68:69], v[28:29]
  v_pk_add_f32 v[70:71], v[70:71], v[30:31]
  s_waitcnt lgkmcnt(7)
  v_pk_add_f32 v[72:73], v[72:73], v[32:33]
  v_pk_add_f32 v[74:75], v[74:75], v[34:35]
  s_waitcnt lgkmcnt(6)
  v_pk_add_f32 v[76:77], v[76:77], v[36:37]
  v_pk_add_f32 v[78:79], v[78:79], v[38:39]
  s_waitcnt lgkmcnt(5)
  v_pk_add_f32 v[80:81], v[80:81], v[40:41]
  v_pk_add_f32 v[82:83], v[82:83], v[42:43]
  ds_read_b128 v[24:27], v89 offset:10240
  ds_read_b128 v[28:31], v89 offset:11264
  ds_read_b128 v[32:35], v89 offset:12288
  ds_read_b128 v[36:39], v89 offset:13312
  ds_read_b128 v[40:43], v89 offset:14336
  s_waitcnt lgkmcnt(9)
  v_pk_add_f32 v[64:65], v[64:65], v[92:93]
  v_pk_add_f32 v[66:67], v[66:67], v[94:95]
  s_waitcnt lgkmcnt(8)
  v_pk_add_f32 v[68:69], v[68:69], v[96:97]
  v_pk_add_f32 v[70:71], v[70:71], v[98:99]
  s_waitcnt lgkmcnt(7)
  v_pk_add_f32 v[72:73], v[72:73], v[100:101]
  v_pk_add_f32 v[74:75], v[74:75], v[102:103]
  s_waitcnt lgkmcnt(6)
  v_pk_add_f32 v[76:77], v[76:77], v[104:105]
  v_pk_add_f32 v[78:79], v[78:79], v[106:107]
  s_waitcnt lgkmcnt(5)
  v_pk_add_f32 v[80:81], v[80:81], v[108:109]
  v_pk_add_f32 v[82:83], v[82:83], v[110:111]
  s_waitcnt lgkmcnt(4)
  v_pk_add_f32 v[64:65], v[64:65], v[24:25]
  v_pk_add_f32 v[66:67], v[66:67], v[26:27]
  s_waitcnt lgkmcnt(3)
  v_pk_add_f32 v[68:69], v[68:69], v[28:29]
  v_pk_add_f32 v[70:71], v[70:71], v[30:31]
  s_waitcnt lgkmcnt(2)
  v_pk_add_f32 v[72:73], v[72:73], v[32:33]
  v_pk_add_f32 v[74:75], v[74:75], v[34:35]
  s_waitcnt lgkmcnt(1)
  v_pk_add_f32 v[76:77], v[76:77], v[36:37]
  v_pk_add_f32 v[78:79], v[78:79], v[38:39]
  s_waitcnt lgkmcnt(0)
  v_pk_add_f32 v[80:81], v[80:81], v[40:41]
  v_pk_add_f32 v[82:83], v[82:83], v[42:43]
  v_pk_add_f32 v[64:65], v[64:65], v[44:45]
  v_pk_add_f32 v[66:67], v[66:67], v[46:47]
  v_pk_add_f32 v[68:69], v[68:69], v[48:49]
  v_pk_add_f32 v[70:71], v[70:71], v[50:51]
  v_pk_add_f32 v[72:73], v[72:73], v[52:53]
  v_pk_add_f32 v[74:75], v[74:75], v[54:55]
  v_pk_add_f32 v[76:77], v[76:77], v[56:57]
  v_pk_add_f32 v[78:79], v[78:79], v[58:59]
  v_pk_add_f32 v[80:81], v[80:81], v[60:61]
  v_pk_add_f32 v[82:83], v[82:83], v[62:63]
  v_cvt_pk_bf16_f32 v10, v64, v65
  v_cvt_pk_bf16_f32 v11, v66, v67
  v_cvt_pk_bf16_f32 v12, v68, v69
  v_cvt_pk_bf16_f32 v13, v70, v71
  v_cvt_pk_bf16_f32 v14, v72, v73
  v_cvt_pk_bf16_f32 v15, v74, v75
  v_cvt_pk_bf16_f32 v16, v76, v77
  v_cvt_pk_bf16_f32 v17, v78, v79
  v_cvt_pk_bf16_f32 v18, v80, v81
  v_cvt_pk_bf16_f32 v19, v82, v83
  v_mov_b32 v24, v10
  v_mov_b32 v25, v11
  v_mov_b32 v26, v12
  v_mov_b32 v27, v13
  v_mov_b32 v28, v14
  v_mov_b32 v29, v15
  v_mov_b32 v30, v16
  v_mov_b32 v31, v17
  v_permlane32_swap_b32 v24, v26
  v_permlane32_swap_b32 v25, v27
  v_permlane32_swap_b32 v28, v30
  v_permlane32_swap_b32 v29, v31
  s_add_u32 s3, s58, 0
  s_cmp_lg_u32 s16, 0
  s_cbranch_scc1 HS9_2
  buffer_store_dwordx4 v[24:27], v7, s[8:11], s3 offen
  buffer_store_dwordx4 v[28:31], v7, s[8:11], s3 offen offset:2048
  s_addk_i32 s3, 4096
  buffer_store_dwordx2 v[18:19], v6, s[8:11], s3 offen
HB9_2:
  s_mov_b32 s3, 0x3f803f80
  v_mov_b32 v92, 0
  v_mov_b32 v93, 0
  v_add_u32 v20, 1, v20
  v_dot2_f32_bf16 v92, v10, s3, v92
  v_dot2_f32_bf16 v93, v10, v10, v93
  v_dot2_f32_bf16 v92, v11, s3, v92
  v_dot2_f32_bf16 v93, v11, v11, v93
  v_dot2_f32_bf16 v92, v12, s3, v92
  v_dot2_f32_bf16 v93, v12, v12, v93
  v_dot2_f32_bf16 v92, v13, s3, v92
  v_dot2_f32_bf16 v93, v13, v13, v93
  v_dot2_f32_bf16 v92, v14, s3, v92
  v_dot2_f32_bf16 v93, v14, v14, v93
  v_dot2_f32_bf16 v92, v15, s3, v92
  v_dot2_f32_bf16 v93, v15, v15, v93
  v_dot2_f32_bf16 v92, v16, s3, v92
  v_dot2_f32_bf16 v93, v16, v16, v93
  v_dot2_f32_bf16 v92, v17, s3, v92
  v_dot2_f32_bf16 v93, v17, v17, v93
  v_dot2_f32_bf16 v92, v18, s3, v92
  v_dot2_f32_bf16 v93, v18, v18, v93
  v_dot2_f32_bf16 v92, v19, s3, v92
  v_dot2_f32_bf16 v93, v19, v19, v93
  v_mov_b32 v94, v20
  v_mov_b32 v95, v20
  v_mov_b32 v90, v92
  v_mov_b32 v91, v93
  s_nop 0
  v_permlane16_swap_b32 v92, v90
  v_permlane16_swap_b32 v93, v91
  v_add_f32 v92, v92, v90
  v_add_f32 v93, v93, v91
  v_mov_b32 v90, v92
  v_mov_b32 v91, v93
  s_nop 0
  v_permlane32_swap_b32 v92, v90
  v_permlane32_swap_b32 v93, v91
  v_add_f32 v92, v92, v90
  v_add_f32 v93, v93, v91
  s_add_u32 s3, s59, 2621440
  s_waitcnt vmcnt(0)
  s_mov_b64 exec, 0xffff
  s_cmp_lg_u32 s16, 0
  s_cbranch_scc1 HS10_2
  buffer_store_dwordx4 v[92:95], v1, s[8:11], s3 offen
HB10_2:
  s_mov_b64 exec, -1
  s_barrier
  s_add_u32 s70, s37, 2621440
  buffer_load_dwordx4 v[24:27], v8, s[8:11], s70 offen offset:0 sc1
  buffer_load_dwordx4 v[28:31], v8, s[8:11], s70 offen offset:512 sc1
  buffer_load_dwordx4 v[32:35], v8, s[8:11], s70 offen offset:1024 sc1
  buffer_load_dwordx4 v[36:39], v8, s[8:11], s70 offen offset:1536 sc1
  s_waitcnt vmcnt(1)
  v_max3_u32 v40, v26, v30, v34
  v_min3_u32 v41, v26, v30, v34
  s_waitcnt vmcnt(0)
  v_max_u32 v40, v40, v38
  v_min_u32 v41, v41, v38
  v_cmp_ne_u32 vcc, v20, v40
  v_cmp_ne_u32 s[64:65], v20, v41
  s_nop 3
  s_or_b64 vcc, vcc, s[64:65]
  s_cbranch_vccnz PXM_SPIN_2
PXM_OK_2:
  s_add_u32 s71, s36, 0
  buffer_load_dwordx4 a[0:3], v1, s[8:11], s71 offen offset:0 sc1
  buffer_load_dwordx4 a[4:7], v1, s[8:11], s71 offen offset:1024 sc1
  buffer_load_dwordx4 a[8:11], v1, s[8:11], s71 offen offset:2048 sc1
  buffer_load_dwordx4 a[12:15], v1, s[8:11], s71 offen offset:3072 sc1
  s_add_u32 s35, s71, 4096
  buffer_load_dwordx4 a[16:19], v1, s[8:11], s35 offen offset:0 sc1
  buffer_load_dwordx4 a[20:23], v1, s[8:11], s35 offen offset:1024 sc1
  buffer_load_dwordx4 a[24:27], v1, s[8:11], s35 offen offset:2048 sc1
  s_barrier
  ds_read_b128 a[160:163], v2 offset:0
  buffer_load_dwordx4 a[28:31], v1, s[8:11], s35 offen offset:3072 sc1
  ds_read_b128 a[164:167], v2 offset:1024
  ds_read_b128 a[168:171], v2 offset:2048
  ds_read_b128 a[172:175], v2 offset:3072
  s_add_u32 s35, s71, 8192
  buffer_load_dwordx4 a[32:35], v1, s[8:11], s35 offen offset:0 sc1
  ds_read_b128 a[176:179], v2 offset:4096
  ds_read_b128 a[180:183], v2 offset:5120
  ds_read_b128 a[184:187], v2 offset:6144
  buffer_load_dwordx4 a[36:39], v1, s[8:11], s35 offen offset:1024 sc1
  s_waitcnt vmcnt(9) lgkmcnt(4)
  v_mfma_f32_32x32x16_bf16 v[40:55], a[160:163], a[0:3], 0
  ds_read_b128 a[188:191], v2 offset:7168
  v_mfma_f32_32x32x16_bf16 v[56:71], a[164:167], a[0:3], 0
  ds_read_b128 a[160:163], v2 offset:8192
  v_mfma_f32_32x32x16_bf16 v[72:87], a[168:171], a[0:3], 0
  ds_read_b128 a[164:167], v2 offset:9216
  buffer_load_dwordx4 a[40:43], v1, s[8:11], s35 offen offset:2048 sc1
  s_waitcnt vmcnt(9) lgkmcnt(4)
  v_mfma_f32_32x32x16_bf16 v[40:55], a[172:175], a[4:7], v[40:55]
  ds_read_b128 a[168:171], v2 offset:10240
  v_mfma_f32_32x32x16_bf16 v[56:71], a[176:179], a[4:7], v[56:71]
  ds_read_b128 a[172:175], v2 offset:11264
  v_mfma_f32_32x32x16_bf16 v[72:87], a[180:183], a[4:7], v[72:87]
  ds_read_b128 a[176:179], v2 offset:12288
  buffer_load_dwordx4 a[44:47], v1, s[8:11], s35 offen offset:3072 sc1
  s_waitcnt vmcnt(9) lgkmcnt(4)
  v_mfma_f32_32x32x16_bf16 v[40:55], a[184:187], a[8:11], v[40:55]
  ds_read_b128 a[180:183], v2 offset:13312
  v_mfma_f32_32x32x16_bf16 v[56:71], a[188:191], a[8:11], v[56:71]
  ds_read_b128 a[184:187], v2 offset:14336
  v_mfma_f32_32x32x16_bf16 v[72:87], a[160:163], a[8:11], v[72:87]
  ds_read_b128 a[188:191], v2 offset:15360
  s_add_u32 s35, s71, 12288
  buffer_load_dwordx4 a[48:51], v1, s[8:11], s35 offen offset:0 sc1
  s_waitcnt vmcnt(9) lgkmcnt(4)
  v_mfma_f32_32x32x16_bf16 v[40:55], a[164:167], a[12:15], v[40:55]
  ds_read_b128 a[160:163], v2 offset:16384
  v_mfma_f32_32x32x16_bf16 v[56:71], a[168:171], a[12:15], v[56:71]
  ds_read_b128 a[164:167], v2 offset:17408
  s_add_u32 m0, s27, 4096
  s_add_u32 s34, s33, 102400
  buffer_load_dwordx4 v1, s[20:23], s34 offen offset:0 sc1 lds
  v_mfma_f32_32x32x16_bf16 v[72:87], a[172:175], a[12:15], v[72:87]
  ds_read_b128 a[168:171], v2 offset:18432
  buffer_load_dwordx4 a[52:55], v1, s[8:11], s35 offen offset:1024 sc1
  s_waitcnt vmcnt(10) lgkmcnt(4)
  v_mfma_f32_32x32x16_bf16 v[40:55], a[176:179], a[16:19], v[40:55]
  ds_read_b128 a[172:175], v2 offset:19456
  v_add_f32 v24, v24, v28
  v_add_f32 v25, v25, v29
  v_add_f32 v32, v32, v36
  v_add_f32 v33, v33, v37
  v_add_f32 v24, v24, v32
  v_mfma_f32_32x32x16_bf16 v[56:71], a[180:183], a[16:19], v[56:71]
  ds_read_b128 a[176:179], v2 offset:20480
  v_add_f32 v25, v25, v33
  v_mov_b32 v26, v24
  v_mov_b32 v27, v25
  s_nop 0
  v_permlane32_swap_b32 v24, v26
  v_permlane32_swap_b32 v25, v27
  v_mfma_f32_32x32x16_bf16 v[72:87], a[184:187], a[16:19], v[72:87]
  ds_read_b128 a[180:183], v2 offset:21504
  buffer_load_dwordx4 a[56:59], v1, s[8:11], s35 offen offset:2048 sc1
  v_add_f32 v24, v24, v26
  s_waitcnt vmcnt(10) lgkmcnt(4)
  v_mfma_f32_32x32x16_bf16 v[40:55], a[188:191], a[20:23], v[40:55]
  ds_read_b128 a[184:187], v2 offset:22528
  buffer_load_dwordx4 v1, s[20:23], s34 offen offset:1024 sc1 lds
  v_add_f32 v25, v25, v27
  v_mul_f32 v24, 0xbacccccd, v24
  v_mfma_f32_32x32x16_bf16 v[56:71], a[160:163], a[20:23], v[56:71]
  ds_read_b128 a[188:191], v2 offset:23552
  v_mul_f32 v25, 0x3acccccd, v25
  v_cvt_pk_bf16_f32 v104, v24, v24
  v_fma_f32 v25, -v24, v24, v25
  v_cvt_pk_bf16_f32 v105, v24, v24
  v_max_f32 v25, 0, v25
  v_mfma_f32_32x32x16_bf16 v[72:87], a[164:167], a[20:23], v[72:87]
  ds_read_b128 a[160:163], v2 offset:24576
  buffer_load_dwordx4 a[60:63], v1, s[8:11], s35 offen offset:3072 sc1
  v_cvt_pk_bf16_f32 v106, v24, v24
  s_waitcnt vmcnt(11) lgkmcnt(4)
  v_mfma_f32_32x32x16_bf16 v[40:55], a[168:171], a[24:27], v[40:55]
  ds_read_b128 a[164:167], v2 offset:25600
  buffer_load_dwordx4 v1, s[20:23], s34 offen offset:2048 sc1 lds
  v_add_f32 v108, 0x3727c5ac, v25
  v_cvt_pk_bf16_f32 v107, v24, v24
  v_mfma_f32_32x32x16_bf16 v[56:71], a[172:175], a[24:27], v[56:71]
  ds_read_b128 a[168:171], v2 offset:26624
  v_rsq_f32 v110, v108
  s_nop 0
  v_mul_f32 v111, 0xc0135761, v110
  v_mul_f32 v110, v110, v110
  v_mfma_f32_32x32x16_bf16 v[72:87], a[176:179], a[24:27], v[72:87]
  ds_read_b128 a[172:175], v2 offset:27648
  s_add_u32 s35, s71, 16384
  buffer_load_dwordx4 a[64:67], v1, s[8:11], s35 offen offset:0 sc1
  s_waitcnt vmcnt(12) lgkmcnt(4)
  v_mfma_f32_32x32x16_bf16 v[40:55], a[180:183], a[28:31], v[40:55]
  ds_read_b128 a[176:179], v2 offset:28672
  v_mul_f32 v110, 0x3d372713, v110
  v_mul_f32 v110, v111, v110
  v_mfma_f32_32x32x16_bf16 v[56:71], a[184:187], a[28:31], v[56:71]
  ds_read_b128 a[180:183], v2 offset:29696
  buffer_load_dwordx4 v1, s[20:23], s34 offen offset:3072 sc1 lds
  v_mfma_f32_32x32x16_bf16 v[72:87], a[188:191], a[28:31], v[72:87]
  ds_read_b128 a[184:187], v2 offset:30720
  buffer_load_dwordx4 a[68:71], v1, s[8:11], s35 offen offset:1024 sc1
  s_waitcnt vmcnt(13) lgkmcnt(4)
  v_mfma_f32_32x32x16_bf16 v[40:55], a[160:163], a[32:35], v[40:55]
  ds_read_b128 a[188:191], v2 offset:31744
  v_mfma_f32_32x32x16_bf16 v[56:71], a[164:167], a[32:35], v[56:71]
  ds_read_b128 a[160:163], v2 offset:32768
  v_mfma_f32_32x32x16_bf16 v[72:87], a[168:171], a[32:35], v[72:87]
  ds_read_b128 a[164:167], v2 offset:33792
  buffer_load_dwordx4 a[72:75], v1, s[8:11], s35 offen offset:2048 sc1
  s_waitcnt vmcnt(13) lgkmcnt(4)
  v_mfma_f32_32x32x16_bf16 v[40:55], a[172:175], a[36:39], v[40:55]
  ds_read_b128 a[168:171], v2 offset:34816
  s_add_u32 m0, s27, 8192
  s_add_u32 s34, s33, 106496
  buffer_load_dwordx4 v1, s[20:23], s34 offen offset:0 sc1 lds
  v_mfma_f32_32x32x16_bf16 v[56:71], a[176:179], a[36:39], v[56:71]
  ds_read_b128 a[172:175], v2 offset:35840
  v_mfma_f32_32x32x16_bf16 v[72:87], a[180:183], a[36:39], v[72:87]
  ds_read_b128 a[176:179], v2 offset:36864
  buffer_load_dwordx4 a[76:79], v1, s[8:11], s35 offen offset:3072 sc1
  s_waitcnt vmcnt(14) lgkmcnt(4)
  v_mfma_f32_32x32x16_bf16 v[40:55], a[184:187], a[40:43], v[40:55]
  ds_read_b128 a[180:183], v2 offset:37888
  buffer_load_dwordx4 v1, s[20:23], s34 offen offset:1024 sc1 lds
  v_mfma_f32_32x32x16_bf16 v[56:71], a[188:191], a[40:43], v[56:71]
  ds_read_b128 a[184:187], v2 offset:38912
  v_mfma_f32_32x32x16_bf16 v[72:87], a[160:163], a[40:43], v[72:87]
  ds_read_b128 a[188:191], v2 offset:39936
  s_add_u32 s35, s71, 20480
  buffer_load_dwordx4 a[80:83], v1, s[8:11], s35 offen offset:0 sc1
  s_waitcnt vmcnt(15) lgkmcnt(4)
  v_mfma_f32_32x32x16_bf16 v[40:55], a[164:167], a[44:47], v[40:55]
  ds_read_b128 a[160:163], v2 offset:40960
  v_mfma_f32_32x32x16_bf16 v[56:71], a[168:171], a[44:47], v[56:71]
  ds_read_b128 a[164:167], v2 offset:41984
  buffer_load_dwordx4 v1, s[20:23], s34 offen offset:2048 sc1 lds
  v_mfma_f32_32x32x16_bf16 v[72:87], a[172:175], a[44:47], v[72:87]
  ds_read_b128 a[168:171], v2 offset:43008
  buffer_load_dwordx4 a[84:87], v1, s[8:11], s35 offen offset:1024 sc1
  s_waitcnt vmcnt(16) lgkmcnt(4)
  v_mfma_f32_32x32x16_bf16 v[40:55], a[176:179], a[48:51], v[40:55]
  ds_read_b128 a[172:175], v2 offset:44032
  v_mfma_f32_32x32x16_bf16 v[56:71], a[180:183], a[48:51], v[56:71]
  ds_read_b128 a[176:179], v2 offset:45056
  v_mfma_f32_32x32x16_bf16 v[72:87], a[184:187], a[48:51], v[72:87]
  ds_read_b128 a[180:183], v2 offset:46080
  buffer_load_dwordx4 a[88:91], v1, s[8:11], s35 offen offset:2048 sc1
  s_waitcnt vmcnt(15) lgkmcnt(4)
  v_mfma_f32_32x32x16_bf16 v[40:55], a[188:191], a[52:55], v[40:55]
  ds_read_b128 a[184:187], v2 offset:47104
  buffer_load_dwordx4 v1, s[20:23], s34 offen offset:3072 sc1 lds
  v_mfma_f32_32x32x16_bf16 v[56:71], a[160:163], a[52:55], v[56:71]
  ds_read_b128 a[188:191], v2 offset:48128
  v_mfma_f32_32x32x16_bf16 v[72:87], a[164:167], a[52:55], v[72:87]
  ds_read_b128 a[160:163], v2 offset:49152
  buffer_load_dwordx4 a[92:95], v1, s[8:11], s35 offen offset:3072 sc1
  s_waitcnt vmcnt(16) lgkmcnt(4)
  v_mfma_f32_32x32x16_bf16 v[40:55], a[168:171], a[56:59], v[40:55]
  ds_read_b128 a[164:167], v2 offset:50176
  s_add_u32 m0, s26, 36864
  s_add_u32 s34, s32, 135168
  buffer_load_dwordx4 v1, s[20:23], s34 offen offset:0 sc1 lds
  v_mfma_f32_32x32x16_bf16 v[56:71], a[172:175], a[56:59], v[56:71]
  ds_read_b128 a[168:171], v2 offset:51200
  v_mfma_f32_32x32x16_bf16 v[72:87], a[176:179], a[56:59], v[72:87]
  ds_read_b128 a[172:175], v2 offset:52224
  s_add_u32 s35, s71, 24576
  buffer_load_dwordx4 a[96:99], v1, s[8:11], s35 offen offset:0 sc1
  s_waitcnt vmcnt(16) lgkmcnt(4)
  v_mfma_f32_32x32x16_bf16 v[40:55], a[180:183], a[60:63], v[40:55]
  ds_read_b128 a[176:179], v2 offset:53248
  v_mfma_f32_32x32x16_bf16 v[56:71], a[184:187], a[60:63], v[56:71]
  ds_read_b128 a[180:183], v2 offset:54272
  buffer_load_dwordx4 v1, s[20:23], s34 offen offset:1024 sc1 lds
  v_mfma_f32_32x32x16_bf16 v[72:87], a[188:191], a[60:63], v[72:87]
  ds_read_b128 a[184:187], v2 offset:55296
  buffer_load_dwordx4 a[100:103], v1, s[8:11], s35 offen offset:1024 sc1
  s_waitcnt vmcnt(16) lgkmcnt(4)
  v_mfma_f32_32x32x16_bf16 v[40:55], a[160:163], a[64:67], v[40:55]
  ds_read_b128 a[188:191], v2 offset:56320
  v_mfma_f32_32x32x16_bf16 v[56:71], a[164:167], a[64:67], v[56:71]
  ds_read_b128 a[160:163], v2 offset:57344
  v_mfma_f32_32x32x16_bf16 v[72:87], a[168:171], a[64:67], v[72:87]
  ds_read_b128 a[164:167], v2 offset:58368
  buffer_load_dwordx4 a[104:107], v1, s[8:11], s35 offen offset:2048 sc1
  s_waitcnt vmcnt(15) lgkmcnt(4)
  v_mfma_f32_32x32x16_bf16 v[40:55], a[172:175], a[68:71], v[40:55]
  ds_read_b128 a[168:171], v2 offset:59392
  buffer_load_dwordx4 v1, s[20:23], s34 offen offset:2048 sc1 lds
  v_mfma_f32_32x32x16_bf16 v[56:71], a[176:179], a[68:71], v[56:71]
  ds_read_b128 a[172:175], v2 offset:60416
  v_mfma_f32_32x32x16_bf16 v[72:87], a[180:183], a[68:71], v[72:87]
  ds_read_b128 a[176:179], v2 offset:61440
  buffer_load_dwordx4 a[108:111], v1, s[8:11], s35 offen offset:3072 sc1
  s_waitcnt vmcnt(16) lgkmcnt(4)
  v_mfma_f32_32x32x16_bf16 v[40:55], a[184:187], a[72:75], v[40:55]
  ds_read_b128 a[180:183], v2 offset:62464
  buffer_load_dwordx4 v1, s[20:23], s34 offen offset:3072 sc1 lds
  v_mfma_f32_32x32x16_bf16 v[56:71], a[188:191], a[72:75], v[56:71]
  ds_read_b128 a[184:187], v2 offset:63488
  v_mfma_f32_32x32x16_bf16 v[72:87], a[160:163], a[72:75], v[72:87]
  ds_read_b128 a[188:191], v2 offset:64512
  s_add_u32 s35, s71, 28672
  buffer_load_dwordx4 a[112:115], v1, s[8:11], s35 offen offset:0 sc1
  s_waitcnt vmcnt(16) lgkmcnt(4)
  v_mfma_f32_32x32x16_bf16 v[40:55], a[164:167], a[76:79], v[40:55]
  ds_read_b128 a[160:163], v3 offset:0
  v_mfma_f32_32x32x16_bf16 v[56:71], a[168:171], a[76:79], v[56:71]
  ds_read_b128 a[164:167], v3 offset:1024
  s_add_u32 m0, s26, 40960
  s_add_u32 s34, s32, 139264
  buffer_load_dwordx4 v1, s[20:23], s34 offen offset:0 sc1 lds
  v_mfma_f32_32x32x16_bf16 v[72:87], a[172:175], a[76:79], v[72:87]
  ds_read_b128 a[168:171], v3 offset:2048
  buffer_load_dwordx4 a[116:119], v1, s[8:11], s35 offen offset:1024 sc1
  s_waitcnt vmcnt(16) lgkmcnt(4)
  v_mfma_f32_32x32x16_bf16 v[40:55], a[176:179], a[80:83], v[40:55]
  ds_read_b128 a[172:175], v3 offset:3072
  v_mfma_f32_32x32x16_bf16 v[56:71], a[180:183], a[80:83], v[56:71]
  ds_read_b128 a[176:179], v3 offset:4096
  v_mfma_f32_32x32x16_bf16 v[72:87], a[184:187], a[80:83], v[72:87]
  ds_read_b128 a[180:183], v3 offset:5120
  buffer_load_dwordx4 a[120:123], v1, s[8:11], s35 offen offset:2048 sc1
  s_waitcnt vmcnt(15) lgkmcnt(4)
  v_mfma_f32_32x32x16_bf16 v[40:55], a[188:191], a[84:87], v[40:55]
  ds_read_b128 a[184:187], v3 offset:6144
  buffer_load_dwordx4 v1, s[20:23], s34 offen offset:1024 sc1 lds
  v_mfma_f32_32x32x16_bf16 v[56:71], a[160:163], a[84:87], v[56:71]
  ds_read_b128 a[188:191], v3 offset:7168
  v_mfma_f32_32x32x16_bf16 v[72:87], a[164:167], a[84:87], v[72:87]
  ds_read_b128 a[160:163], v3 offset:8192
  buffer_load_dwordx4 a[124:127], v1, s[8:11], s35 offen offset:3072 sc1
  s_waitcnt vmcnt(16) lgkmcnt(4)
  v_mfma_f32_32x32x16_bf16 v[40:55], a[168:171], a[88:91], v[40:55]
  ds_read_b128 a[164:167], v3 offset:9216
  buffer_load_dwordx4 v1, s[20:23], s34 offen offset:2048 sc1 lds
  v_mfma_f32_32x32x16_bf16 v[56:71], a[172:175], a[88:91], v[56:71]
  ds_read_b128 a[168:171], v3 offset:10240
  v_mfma_f32_32x32x16_bf16 v[72:87], a[176:179], a[88:91], v[72:87]
  ds_read_b128 a[172:175], v3 offset:11264
  s_add_u32 s35, s71, 32768
  buffer_load_dwordx4 a[128:131], v1, s[8:11], s35 offen offset:0 sc1
  s_waitcnt vmcnt(16) lgkmcnt(4)
  v_mfma_f32_32x32x16_bf16 v[40:55], a[180:183], a[92:95], v[40:55]
  ds_read_b128 a[176:179], v3 offset:12288
  v_mfma_f32_32x32x16_bf16 v[56:71], a[184:187], a[92:95], v[56:71]
  ds_read_b128 a[180:183], v3 offset:13312
  v_mfma_f32_32x32x16_bf16 v[72:87], a[188:191], a[92:95], v[72:87]
  ds_read_b128 a[184:187], v3 offset:14336
  buffer_load_dwordx4 a[132:135], v1, s[8:11], s35 offen offset:1024 sc1
  s_waitcnt vmcnt(15) lgkmcnt(4)
  v_mfma_f32_32x32x16_bf16 v[40:55], a[160:163], a[96:99], v[40:55]
  ds_read_b128 a[188:191], v3 offset:15360
  v_mfma_f32_32x32x16_bf16 v[56:71], a[164:167], a[96:99], v[56:71]
  ds_read_b128 a[160:163], v3 offset:16384
  v_mfma_f32_32x32x16_bf16 v[72:87], a[168:171], a[96:99], v[72:87]
  ds_read_b128 a[164:167], v3 offset:17408
  buffer_load_dwordx4 a[136:139], v1, s[8:11], s35 offen offset:2048 sc1
  s_waitcnt vmcnt(14) lgkmcnt(4)
  v_mfma_f32_32x32x16_bf16 v[40:55], a[172:175], a[100:103], v[40:55]
  ds_read_b128 a[168:171], v3 offset:18432
  v_mfma_f32_32x32x16_bf16 v[56:71], a[176:179], a[100:103], v[56:71]
  ds_read_b128 a[172:175], v3 offset:19456
  v_mfma_f32_32x32x16_bf16 v[72:87], a[180:183], a[100:103], v[72:87]
  ds_read_b128 a[176:179], v3 offset:20480
  buffer_load_dwordx4 a[140:143], v1, s[8:11], s35 offen offset:3072 sc1
  s_waitcnt vmcnt(14) lgkmcnt(4)
  v_mfma_f32_32x32x16_bf16 v[40:55], a[184:187], a[104:107], v[40:55]
  ds_read_b128 a[180:183], v3 offset:21504
  v_mfma_f32_32x32x16_bf16 v[56:71], a[188:191], a[104:107], v[56:71]
  ds_read_b128 a[184:187], v3 offset:22528
  v_mfma_f32_32x32x16_bf16 v[72:87], a[160:163], a[104:107], v[72:87]
  ds_read_b128 a[188:191], v3 offset:23552
  s_add_u32 s35, s71, 36864
  buffer_load_dwordx4 a[144:147], v1, s[8:11], s35 offen offset:0 sc1
  s_waitcnt vmcnt(13) lgkmcnt(4)
  v_mfma_f32_32x32x16_bf16 v[40:55], a[164:167], a[108:111], v[40:55]
  ds_read_b128 a[160:163], v3 offset:24576
  v_mfma_f32_32x32x16_bf16 v[56:71], a[168:171], a[108:111], v[56:71]
  ds_read_b128 a[164:167], v3 offset:25600
  v_mfma_f32_32x32x16_bf16 v[72:87], a[172:175], a[108:111], v[72:87]
  ds_read_b128 a[168:171], v3 offset:26624
  buffer_load_dwordx4 a[148:151], v1, s[8:11], s35 offen offset:1024 sc1
  s_waitcnt vmcnt(12) lgkmcnt(4)
  v_mfma_f32_32x32x16_bf16 v[40:55], a[176:179], a[112:115], v[40:55]
  ds_read_b128 a[172:175], v3 offset:27648
  v_mfma_f32_32x32x16_bf16 v[56:71], a[180:183], a[112:115], v[56:71]
  ds_read_b128 a[176:179], v3 offset:28672
  v_mfma_f32_32x32x16_bf16 v[72:87], a[184:187], a[112:115], v[72:87]
  ds_read_b128 a[180:183], v3 offset:29696
  buffer_load_dwordx4 a[152:155], v1, s[8:11], s35 offen offset:2048 sc1
  s_waitcnt vmcnt(11) lgkmcnt(4)
  v_mfma_f32_32x32x16_bf16 v[40:55], a[188:191], a[116:119], v[40:55]
  ds_read_b128 a[184:187], v3 offset:30720
  v_mfma_f32_32x32x16_bf16 v[56:71], a[160:163], a[116:119], v[56:71]
  ds_read_b128 a[188:191], v3 offset:31744
  v_mfma_f32_32x32x16_bf16 v[72:87], a[164:167], a[116:119], v[72:87]
  ds_read_b128 a[160:163], v1 offset:0
  buffer_load_dwordx4 a[156:159], v1, s[8:11], s35 offen offset:3072 sc1
  s_waitcnt vmcnt(11) lgkmcnt(4)
  v_mfma_f32_32x32x16_bf16 v[40:55], a[168:171], a[120:123], v[40:55]
  ds_read_b128 a[164:167], v1 offset:1024
  v_mfma_f32_32x32x16_bf16 v[56:71], a[172:175], a[120:123], v[56:71]
  ds_read_b128 a[168:171], v1 offset:2048
  v_mfma_f32_32x32x16_bf16 v[72:87], a[176:179], a[120:123], v[72:87]
  ds_read_b128 a[172:175], v1 offset:3072
  s_waitcnt vmcnt(8)
  s_barrier
  s_waitcnt lgkmcnt(4)
  v_mfma_f32_32x32x16_bf16 v[40:55], a[180:183], a[124:127], v[40:55]
  ds_read_b128 a[176:179], v1 offset:4096
  s_add_u32 m0, s27, 65536
  s_add_u32 s34, s33, 163840
  buffer_load_dwordx4 v1, s[20:23], s34 offen offset:0 sc1 lds
  v_mfma_f32_32x32x16_bf16 v[56:71], a[184:187], a[124:127], v[56:71]
  ds_read_b128 a[180:183], v1 offset:5120
  buffer_load_dwordx4 v1, s[20:23], s34 offen offset:1024 sc1 lds
  v_mfma_f32_32x32x16_bf16 v[72:87], a[188:191], a[124:127], v[72:87]
  ds_read_b128 a[184:187], v1 offset:6144
  buffer_load_dwordx4 v1, s[20:23], s34 offen offset:2048 sc1 lds
  s_waitcnt vmcnt(10) lgkmcnt(4)
  v_mfma_f32_32x32x16_bf16 v[40:55], a[160:163], a[128:131], v[40:55]
  ds_read_b128 a[188:191], v1 offset:7168
  buffer_load_dwordx4 v1, s[20:23], s34 offen offset:3072 sc1 lds
  v_mfma_f32_32x32x16_bf16 v[56:71], a[164:167], a[128:131], v[56:71]
  ds_read_b128 a[160:163], v1 offset:8192
  v_mfma_f32_32x32x16_bf16 v[72:87], a[168:171], a[128:131], v[72:87]
  ds_read_b128 a[164:167], v1 offset:9216
  s_waitcnt vmcnt(10) lgkmcnt(4)
  v_mfma_f32_32x32x16_bf16 v[40:55], a[172:175], a[132:135], v[40:55]
  ds_read_b128 a[168:171], v1 offset:10240
  s_add_u32 m0, s27, 69632
  s_add_u32 s34, s33, 167936
  buffer_load_dwordx4 v1, s[20:23], s34 offen offset:0 sc1 lds
  v_mfma_f32_32x32x16_bf16 v[56:71], a[176:179], a[132:135], v[56:71]
  ds_read_b128 a[172:175], v1 offset:11264
  v_mfma_f32_32x32x16_bf16 v[72:87], a[180:183], a[132:135], v[72:87]
  ds_read_b128 a[176:179], v1 offset:12288
  s_waitcnt vmcnt(10) lgkmcnt(4)
  v_mfma_f32_32x32x16_bf16 v[40:55], a[184:187], a[136:139], v[40:55]
  ds_read_b128 a[180:183], v1 offset:13312
  v_mfma_f32_32x32x16_bf16 v[56:71], a[188:191], a[136:139], v[56:71]
  ds_read_b128 a[184:187], v1 offset:14336
  v_mfma_f32_32x32x16_bf16 v[72:87], a[160:163], a[136:139], v[72:87]
  ds_read_b128 a[188:191], v1 offset:15360
  s_waitcnt vmcnt(9) lgkmcnt(4)
  v_mfma_f32_32x32x16_bf16 v[40:55], a[164:167], a[140:143], v[40:55]
  ds_read_b128 a[160:163], v1 offset:16384
  buffer_load_dwordx4 v1, s[20:23], s34 offen offset:1024 sc1 lds
  v_mfma_f32_32x32x16_bf16 v[56:71], a[168:171], a[140:143], v[56:71]
  ds_read_b128 a[164:167], v1 offset:17408
  v_mfma_f32_32x32x16_bf16 v[72:87], a[172:175], a[140:143], v[72:87]
  ds_read_b128 a[168:171], v1 offset:18432
  buffer_load_dwordx4 v1, s[20:23], s34 offen offset:2048 sc1 lds
  s_waitcnt vmcnt(10) lgkmcnt(4)
  v_mfma_f32_32x32x16_bf16 v[40:55], a[176:179], a[144:147], v[40:55]
  ds_read_b128 a[172:175], v1 offset:19456
  buffer_load_dwordx4 v1, s[20:23], s34 offen offset:3072 sc1 lds
  v_mfma_f32_32x32x16_bf16 v[56:71], a[180:183], a[144:147], v[56:71]
  ds_read_b128 a[176:179], v1 offset:20480
  s_add_u32 m0, s27, 98304
  s_add_u32 s34, s33, 196608
  buffer_load_dwordx4 v1, s[20:23], s34 offen offset:0 sc1 lds
  v_mfma_f32_32x32x16_bf16 v[72:87], a[184:187], a[144:147], v[72:87]
  ds_read_b128 a[180:183], v1 offset:21504
  s_waitcnt vmcnt(11) lgkmcnt(4)
  v_mfma_f32_32x32x16_bf16 v[40:55], a[188:191], a[148:151], v[40:55]
  ds_read_b128 a[184:187], v1 offset:22528
  v_mfma_f32_32x32x16_bf16 v[56:71], a[160:163], a[148:151], v[56:71]
  ds_read_b128 a[188:191], v1 offset:23552
  v_mfma_f32_32x32x16_bf16 v[72:87], a[164:167], a[148:151], v[72:87]
  ds_read_b128 a[160:163], v1 offset:24576
  buffer_load_dwordx4 v1, s[20:23], s34 offen offset:1024 sc1 lds
  s_waitcnt vmcnt(11) lgkmcnt(4)
  v_mfma_f32_32x32x16_bf16 v[40:55], a[168:171], a[152:155], v[40:55]
  ds_read_b128 a[164:167], v1 offset:25600
  v_mfma_f32_32x32x16_bf16 v[56:71], a[172:175], a[152:155], v[56:71]
  ds_read_b128 a[168:171], v1 offset:26624
  v_mfma_f32_32x32x16_bf16 v[72:87], a[176:179], a[152:155], v[72:87]
  ds_read_b128 a[172:175], v1 offset:27648
  s_waitcnt vmcnt(10) lgkmcnt(4)
  v_mfma_f32_32x32x16_bf16 v[40:55], a[180:183], a[156:159], v[40:55]
  ds_read_b128 a[176:179], v1 offset:28672
  v_mfma_f32_32x32x16_bf16 v[56:71], a[184:187], a[156:159], v[56:71]
  ds_read_b128 a[180:183], v1 offset:29696
  v_mfma_f32_32x32x16_bf16 v[72:87], a[188:191], a[156:159], v[72:87]
  ds_read_b128 a[184:187], v1 offset:30720
  buffer_load_dwordx4 v1, s[20:23], s34 offen offset:2048 sc1 lds
  s_waitcnt lgkmcnt(4)
  v_mfma_f32_32x32x16_bf16 v[40:55], a[160:163], v[104:107], v[40:55]
  ds_read_b128 a[188:191], v1 offset:31744
  v_mfma_f32_32x32x16_bf16 v[56:71], a[164:167], v[104:107], v[56:71]
  ds_read_b128 a[160:163], v1 offset:32768
  v_mfma_f32_32x32x16_bf16 v[72:87], a[168:171], v[104:107], v[72:87]
  ds_read_b128 a[164:167], v1 offset:33792
  s_waitcnt lgkmcnt(4)
  v_mfma_f32_32x32x16_bf16 v[88:103], a[172:175], a[0:3], 0
  ds_read_b128 a[168:171], v1 offset:34816
  v_mfma_f32_32x32x16_bf16 v[88:103], a[176:179], a[4:7], v[88:103]
  ds_read_b128 a[172:175], v1 offset:35840
  v_mfma_f32_32x32x16_bf16 v[88:103], a[180:183], a[8:11], v[88:103]
  ds_read_b128 a[176:179], v1 offset:36864
  buffer_load_dwordx4 v1, s[20:23], s34 offen offset:3072 sc1 lds
  v_mul_f32 v24, v40, v40
  s_waitcnt lgkmcnt(4)
  v_mfma_f32_32x32x16_bf16 v[88:103], a[184:187], a[12:15], v[88:103]
  ds_read_b128 a[180:183], v1 offset:37888
  v_mul_f32 v25, v41, v41
  v_mul_f32 v26, v42, v42
  v_mul_f32 v27, v43, v43
  s_barrier
  v_mfma_f32_32x32x16_bf16 v[88:103], a[188:191], a[16:19], v[88:103]
  ds_read_b128 a[184:187], v1 offset:38912
  v_fma_f32 v24, v24, v110, v111
  v_fma_f32 v25, v25, v110, v111
  v_fma_f32 v26, v26, v110, v111
  v_fma_f32 v27, v27, v110, v111
  v_mul_f32 v24, v24, v40
  v_mfma_f32_32x32x16_bf16 v[88:103], a[160:163], a[20:23], v[88:103]
  ds_read_b128 a[188:191], v1 offset:39936
  v_mul_f32 v25, v25, v41
  v_mul_f32 v26, v26, v42
  v_mul_f32 v27, v27, v43
  s_waitcnt lgkmcnt(4)
  v_mfma_f32_32x32x16_bf16 v[88:103], a[164:167], a[24:27], v[88:103]
  ds_read_b128 a[160:163], v1 offset:40960
  v_exp_f32 v24, v24
  v_mul_f32 v48, v40, v48
  v_exp_f32 v25, v25
  v_mfma_f32_32x32x16_bf16 v[88:103], a[168:171], a[28:31], v[88:103]
  ds_read_b128 a[164:167], v1 offset:41984
  v_mul_f32 v49, v41, v49
  v_exp_f32 v26, v26
  v_mul_f32 v50, v42, v50
  v_mfma_f32_32x32x16_bf16 v[88:103], a[172:175], a[32:35], v[88:103]
  ds_read_b128 a[168:171], v1 offset:43008
  s_add_u32 m0, s27, 102400
  s_add_u32 s34, s33, 200704
  buffer_load_dwordx4 v1, s[20:23], s34 offen offset:0 sc1 lds
  s_waitcnt lgkmcnt(4)
  v_mfma_f32_32x32x16_bf16 v[88:103], a[176:179], a[36:39], v[88:103]
  ds_read_b128 a[172:175], v1 offset:44032
  v_exp_f32 v27, v27
  v_mul_f32 v51, v43, v51
  v_fma_f32 v24, v24, v108, v108
  v_fma_f32 v25, v25, v108, v108
  v_mfma_f32_32x32x16_bf16 v[88:103], a[180:183], a[40:43], v[88:103]
  ds_read_b128 a[176:179], v1 offset:45056
  v_fma_f32 v26, v26, v108, v108
  v_fma_f32 v27, v27, v108, v108
  v_rcp_f32 v24, v24
  v_mfma_f32_32x32x16_bf16 v[88:103], a[184:187], a[44:47], v[88:103]
  ds_read_b128 a[180:183], v1 offset:46080
  v_rcp_f32 v25, v25
  v_rcp_f32 v26, v26
  s_waitcnt lgkmcnt(4)
  v_mfma_f32_32x32x16_bf16 v[88:103], a[188:191], a[48:51], v[88:103]
  ds_read_b128 a[184:187], v1 offset:47104
  v_rcp_f32 v27, v27
  v_mul_f32 v48, v48, v24
  v_mul_f32 v49, v49, v25
  v_mul_f32 v50, v50, v26
  v_mfma_f32_32x32x16_bf16 v[88:103], a[160:163], a[52:55], v[88:103]
  ds_read_b128 a[188:191], v1 offset:48128
  v_mul_f32 v51, v51, v27
  v_cvt_pk_bf16_f32 v28, v48, v49
  v_cvt_pk_bf16_f32 v29, v50, v51
  v_mul_f32 v24, v44, v44
  v_mul_f32 v25, v45, v45
  v_mfma_f32_32x32x16_bf16 v[88:103], a[164:167], a[56:59], v[88:103]
  ds_read_b128 a[160:163], v1 offset:49152
  buffer_load_dwordx4 v1, s[20:23], s34 offen offset:1024 sc1 lds
  v_mul_f32 v26, v46, v46
  s_waitcnt lgkmcnt(4)
  v_mfma_f32_32x32x16_bf16 v[88:103], a[168:171], a[60:63], v[88:103]
  ds_read_b128 a[164:167], v1 offset:50176
  v_mul_f32 v27, v47, v47
  v_fma_f32 v24, v24, v110, v111
  v_fma_f32 v25, v25, v110, v111
  v_fma_f32 v26, v26, v110, v111
  v_fma_f32 v27, v27, v110, v111
  v_mfma_f32_32x32x16_bf16 v[88:103], a[172:175], a[64:67], v[88:103]
  ds_read_b128 a[168:171], v1 offset:51200
  buffer_load_dwordx4 v1, s[20:23], s34 offen offset:2048 sc1 lds
  v_mul_f32 v24, v24, v44
  v_mul_f32 v25, v25, v45
  v_mfma_f32_32x32x16_bf16 v[88:103], a[176:179], a[68:71], v[88:103]
  ds_read_b128 a[172:175], v1 offset:52224
  buffer_load_dwordx4 v1, s[20:23], s34 offen offset:3072 sc1 lds
  v_mul_f32 v26, v26, v46
  s_waitcnt lgkmcnt(4)
  v_mfma_f32_32x32x16_bf16 v[88:103], a[180:183], a[72:75], v[88:103]
  ds_read_b128 a[176:179], v1 offset:53248
  s_add_u32 m0, s27, 131072
  s_add_u32 s34, s33, 229376
  buffer_load_dwordx4 v1, s[20:23], s34 offen offset:0 sc1 lds
  v_mfma_f32_32x32x16_bf16 v[88:103], a[184:187], a[76:79], v[88:103]
  ds_read_b128 a[180:183], v1 offset:54272
  v_mul_f32 v27, v27, v47
  v_exp_f32 v24, v24
  v_mul_f32 v52, v44, v52
  v_mfma_f32_32x32x16_bf16 v[88:103], a[188:191], a[80:83], v[88:103]
  ds_read_b128 a[184:187], v1 offset:55296
  v_exp_f32 v25, v25
  v_mul_f32 v53, v45, v53
  s_waitcnt lgkmcnt(4)
  v_mfma_f32_32x32x16_bf16 v[88:103], a[160:163], a[84:87], v[88:103]
  ds_read_b128 a[188:191], v1 offset:56320
  v_exp_f32 v26, v26
  v_mul_f32 v54, v46, v54
  v_exp_f32 v27, v27
  v_mfma_f32_32x32x16_bf16 v[88:103], a[164:167], a[88:91], v[88:103]
  ds_read_b128 a[160:163], v1 offset:57344
  buffer_load_dwordx4 v1, s[20:23], s34 offen offset:1024 sc1 lds
  v_mul_f32 v55, v47, v55
  v_fma_f32 v24, v24, v108, v108
  v_mfma_f32_32x32x16_bf16 v[88:103], a[168:171], a[92:95], v[88:103]
  ds_read_b128 a[164:167], v1 offset:58368
  v_fma_f32 v25, v25, v108, v108
  v_fma_f32 v26, v26, v108, v108
  v_fma_f32 v27, v27, v108, v108
  s_waitcnt lgkmcnt(4)
  v_mfma_f32_32x32x16_bf16 v[88:103], a[172:175], a[96:99], v[88:103]
  ds_read_b128 a[168:171], v1 offset:59392
  v_rcp_f32 v24, v24
  v_rcp_f32 v25, v25
  v_mfma_f32_32x32x16_bf16 v[88:103], a[176:179], a[100:103], v[88:103]
  ds_read_b128 a[172:175], v1 offset:60416
  v_rcp_f32 v26, v26
  v_rcp_f32 v27, v27
  v_mul_f32 v52, v52, v24
  v_mfma_f32_32x32x16_bf16 v[88:103], a[180:183], a[104:107], v[88:103]
  ds_read_b128 a[176:179], v1 offset:61440
  v_mul_f32 v53, v53, v25
  v_mul_f32 v54, v54, v26
  v_mul_f32 v55, v55, v27
  v_cvt_pk_bf16_f32 v30, v52, v53
  s_waitcnt lgkmcnt(4)
  v_mfma_f32_32x32x16_bf16 v[88:103], a[184:187], a[108:111], v[88:103]
  ds_read_b128 a[180:183], v1 offset:62464
  v_cvt_pk_bf16_f32 v31, v54, v55
  buffer_store_dwordx4 v[28:31], v9, s[8:11], s60 offen offset:0 sc1
  v_mul_f32 v24, v56, v56
  v_mfma_f32_32x32x16_bf16 v[88:103], a[188:191], a[112:115], v[88:103]
  ds_read_b128 a[184:187], v1 offset:63488
  buffer_load_dwordx4 v1, s[20:23], s34 offen offset:2048 sc1 lds
  v_mul_f32 v25, v57, v57
  v_mul_f32 v26, v58, v58
  v_mfma_f32_32x32x16_bf16 v[88:103], a[160:163], a[116:119], v[88:103]
  ds_read_b128 a[188:191], v1 offset:64512
  v_mul_f32 v27, v59, v59
  v_fma_f32 v24, v24, v110, v111
  s_waitcnt vmcnt(12)
  s_barrier
  s_waitcnt lgkmcnt(4)
  v_mfma_f32_32x32x16_bf16 v[88:103], a[164:167], a[120:123], v[88:103]
  ds_read_b128 a[160:163], v2 offset:0
  v_fma_f32 v25, v25, v110, v111
  v_fma_f32 v26, v26, v110, v111
  v_fma_f32 v27, v27, v110, v111
  v_mul_f32 v24, v24, v56
  v_mul_f32 v25, v25, v57
  v_mfma_f32_32x32x16_bf16 v[88:103], a[168:171], a[124:127], v[88:103]
  ds_read_b128 a[164:167], v2 offset:1024
  v_mul_f32 v26, v26, v58
  v_mul_f32 v27, v27, v59
  v_exp_f32 v24, v24
  v_mul_f32 v64, v56, v64
  v_mfma_f32_32x32x16_bf16 v[88:103], a[172:175], a[128:131], v[88:103]
  ds_read_b128 a[168:171], v2 offset:2048
  v_exp_f32 v25, v25
  v_mul_f32 v65, v57, v65
  s_waitcnt lgkmcnt(4)
  v_mfma_f32_32x32x16_bf16 v[88:103], a[176:179], a[132:135], v[88:103]
  ds_read_b128 a[172:175], v2 offset:3072
  v_exp_f32 v26, v26
  v_mul_f32 v66, v58, v66
  v_exp_f32 v27, v27
  v_mfma_f32_32x32x16_bf16 v[88:103], a[180:183], a[136:139], v[88:103]
  ds_read_b128 a[176:179], v2 offset:4096
  buffer_load_dwordx4 v1, s[20:23], s34 offen offset:3072 sc1 lds
  v_mul_f32 v67, v59, v67
  v_fma_f32 v24, v24, v108, v108
  v_mfma_f32_32x32x16_bf16 v[88:103], a[184:187], a[140:143], v[88:103]
  ds_read_b128 a[180:183], v2 offset:5120
  v_fma_f32 v25, v25, v108, v108
  v_fma_f32 v26, v26, v108, v108
  v_fma_f32 v27, v27, v108, v108
  s_waitcnt lgkmcnt(4)
  v_mfma_f32_32x32x16_bf16 v[88:103], a[188:191], a[144:147], v[88:103]
  ds_read_b128 a[184:187], v2 offset:6144
  v_rcp_f32 v24, v24
  v_rcp_f32 v25, v25
  v_mfma_f32_32x32x16_bf16 v[88:103], a[160:163], a[148:151], v[88:103]
  ds_read_b128 a[188:191], v2 offset:7168
  v_rcp_f32 v26, v26
  v_rcp_f32 v27, v27
  v_mul_f32 v64, v64, v24
  v_mfma_f32_32x32x16_bf16 v[88:103], a[164:167], a[152:155], v[88:103]
  ds_read_b128 a[160:163], v2 offset:8192
  v_mul_f32 v65, v65, v25
  v_mul_f32 v66, v66, v26
  v_mul_f32 v67, v67, v27
  v_cvt_pk_bf16_f32 v32, v64, v65
  s_waitcnt lgkmcnt(4)
  v_mfma_f32_32x32x16_bf16 v[88:103], a[168:171], a[156:159], v[88:103]
  ds_read_b128 a[164:167], v2 offset:9216
  v_cvt_pk_bf16_f32 v33, v66, v67
  v_mul_f32 v24, v60, v60
  v_mul_f32 v25, v61, v61
  v_mul_f32 v26, v62, v62
  v_mul_f32 v27, v63, v63
  v_mfma_f32_32x32x16_bf16 v[88:103], a[172:175], v[104:107], v[88:103]
  ds_read_b128 a[168:171], v2 offset:10240
  s_add_u32 m0, s27, 135168
  s_add_u32 s34, s33, 233472
  buffer_load_dwordx4 v1, s[20:23], s34 offen offset:0 sc1 lds
  v_mfma_f32_32x32x16_bf16 v[40:55], a[176:179], a[0:3], 0
  ds_read_b128 a[172:175], v2 offset:11264
  v_fma_f32 v24, v24, v110, v111
  v_fma_f32 v25, v25, v110, v111
  v_fma_f32 v26, v26, v110, v111
  v_fma_f32 v27, v27, v110, v111
  s_waitcnt lgkmcnt(4)
  v_mfma_f32_32x32x16_bf16 v[40:55], a[180:183], a[4:7], v[40:55]
  ds_read_b128 a[176:179], v2 offset:12288
  v_mul_f32 v24, v24, v60
  v_mul_f32 v25, v25, v61
  v_mul_f32 v26, v26, v62
  v_mul_f32 v27, v27, v63
  v_mfma_f32_32x32x16_bf16 v[40:55], a[184:187], a[8:11], v[40:55]
  ds_read_b128 a[180:183], v2 offset:13312
  v_exp_f32 v24, v24
  v_mul_f32 v68, v60, v68
  v_exp_f32 v25, v25
  v_mfma_f32_32x32x16_bf16 v[40:55], a[188:191], a[12:15], v[40:55]
  ds_read_b128 a[184:187], v2 offset:14336
  v_mul_f32 v69, v61, v69
  v_exp_f32 v26, v26
  v_mul_f32 v70, v62, v70
  s_waitcnt lgkmcnt(4)
  v_mfma_f32_32x32x16_bf16 v[40:55], a[160:163], a[16:19], v[40:55]
  ds_read_b128 a[188:191], v2 offset:15360
  v_exp_f32 v27, v27
  v_mul_f32 v71, v63, v71
  v_fma_f32 v24, v24, v108, v108
  v_fma_f32 v25, v25, v108, v108
  v_mfma_f32_32x32x16_bf16 v[40:55], a[164:167], a[20:23], v[40:55]
  ds_read_b128 a[160:163], v2 offset:16384
  buffer_load_dwordx4 v1, s[20:23], s34 offen offset:1024 sc1 lds
  v_fma_f32 v26, v26, v108, v108
  v_fma_f32 v27, v27, v108, v108
  v_mfma_f32_32x32x16_bf16 v[40:55], a[168:171], a[24:27], v[40:55]
  ds_read_b128 a[164:167], v2 offset:17408
  v_rcp_f32 v24, v24
  v_rcp_f32 v25, v25
  s_waitcnt lgkmcnt(4)
  v_mfma_f32_32x32x16_bf16 v[40:55], a[172:175], a[28:31], v[40:55]
  ds_read_b128 a[168:171], v2 offset:18432
  buffer_load_dwordx4 v1, s[20:23], s34 offen offset:2048 sc1 lds
  v_rcp_f32 v26, v26
  v_mfma_f32_32x32x16_bf16 v[40:55], a[176:179], a[32:35], v[40:55]
  ds_read_b128 a[172:175], v2 offset:19456
  buffer_load_dwordx4 v1, s[20:23], s34 offen offset:3072 sc1 lds
  v_rcp_f32 v27, v27
  v_mfma_f32_32x32x16_bf16 v[40:55], a[180:183], a[36:39], v[40:55]
  ds_read_b128 a[176:179], v2 offset:20480
  s_add_u32 m0, s27, 0
  s_add_u32 s34, s33, 262144
  buffer_load_dwordx4 v1, s[20:23], s34 offen offset:0 sc1 lds
  s_waitcnt lgkmcnt(4)
  v_mfma_f32_32x32x16_bf16 v[40:55], a[184:187], a[40:43], v[40:55]
  ds_read_b128 a[180:183], v2 offset:21504
  v_mul_f32 v68, v68, v24
  v_mul_f32 v69, v69, v25
  v_mul_f32 v70, v70, v26
  v_mul_f32 v71, v71, v27
  v_cvt_pk_bf16_f32 v34, v68, v69
  v_mfma_f32_32x32x16_bf16 v[40:55], a[188:191], a[44:47], v[40:55]
  ds_read_b128 a[184:187], v2 offset:22528
  v_cvt_pk_bf16_f32 v35, v70, v71
  buffer_store_dwordx4 v[32:35], v9, s[8:11], s60 offen offset:512 sc1
  v_mul_f32 v24, v72, v72
  v_mfma_f32_32x32x16_bf16 v[40:55], a[160:163], a[48:51], v[40:55]
  ds_read_b128 a[188:191], v2 offset:23552
  v_mul_f32 v25, v73, v73
  v_mul_f32 v26, v74, v74
  v_mul_f32 v27, v75, v75
  v_fma_f32 v24, v24, v110, v111
  s_waitcnt lgkmcnt(4)
  v_mfma_f32_32x32x16_bf16 v[40:55], a[164:167], a[52:55], v[40:55]
  ds_read_b128 a[160:163], v2 offset:24576
  buffer_load_dwordx4 v1, s[20:23], s34 offen offset:1024 sc1 lds
  v_fma_f32 v25, v25, v110, v111
  v_fma_f32 v26, v26, v110, v111
  v_mfma_f32_32x32x16_bf16 v[40:55], a[168:171], a[56:59], v[40:55]
  ds_read_b128 a[164:167], v2 offset:25600
  v_fma_f32 v27, v27, v110, v111
  v_mul_f32 v24, v24, v72
  v_mul_f32 v25, v25, v73
  v_mul_f32 v26, v26, v74
  v_mul_f32 v27, v27, v75
  v_mfma_f32_32x32x16_bf16 v[40:55], a[172:175], a[60:63], v[40:55]
  ds_read_b128 a[168:171], v2 offset:26624
  v_exp_f32 v24, v24
  v_mul_f32 v80, v72, v80
  s_waitcnt lgkmcnt(4)
  v_mfma_f32_32x32x16_bf16 v[40:55], a[176:179], a[64:67], v[40:55]
  ds_read_b128 a[172:175], v2 offset:27648
  v_exp_f32 v25, v25
  v_mul_f32 v81, v73, v81
  v_exp_f32 v26, v26
  v_mfma_f32_32x32x16_bf16 v[40:55], a[180:183], a[68:71], v[40:55]
  ds_read_b128 a[176:179], v2 offset:28672
  v_mul_f32 v82, v74, v82
  v_exp_f32 v27, v27
  v_mul_f32 v83, v75, v83
  v_fma_f32 v24, v24, v108, v108
  v_mfma_f32_32x32x16_bf16 v[40:55], a[184:187], a[72:75], v[40:55]
  ds_read_b128 a[180:183], v2 offset:29696
  v_fma_f32 v25, v25, v108, v108
  v_fma_f32 v26, v26, v108, v108
  v_fma_f32 v27, v27, v108, v108
  s_waitcnt lgkmcnt(4)
  v_mfma_f32_32x32x16_bf16 v[40:55], a[188:191], a[76:79], v[40:55]
  ds_read_b128 a[184:187], v2 offset:30720
  buffer_load_dwordx4 v1, s[20:23], s34 offen offset:2048 sc1 lds
  v_rcp_f32 v24, v24
  v_mfma_f32_32x32x16_bf16 v[40:55], a[160:163], a[80:83], v[40:55]
  ds_read_b128 a[188:191], v2 offset:31744
  v_rcp_f32 v25, v25
  s_waitcnt vmcnt(13)
  s_barrier
  v_mfma_f32_32x32x16_bf16 v[40:55], a[164:167], a[84:87], v[40:55]
  ds_read_b128 a[160:163], v2 offset:32768
  v_rcp_f32 v26, v26
  v_rcp_f32 v27, v27
  s_waitcnt lgkmcnt(4)
  v_mfma_f32_32x32x16_bf16 v[40:55], a[168:171], a[88:91], v[40:55]
  ds_read_b128 a[164:167], v2 offset:33792
  v_mul_f32 v80, v80, v24
  v_mul_f32 v81, v81, v25
  v_mul_f32 v82, v82, v26
  v_mul_f32 v83, v83, v27
  v_cvt_pk_bf16_f32 v28, v80, v81
  v_mfma_f32_32x32x16_bf16 v[40:55], a[172:175], a[92:95], v[40:55]
  ds_read_b128 a[168:171], v2 offset:34816
  v_cvt_pk_bf16_f32 v29, v82, v83
  v_mul_f32 v24, v76, v76
  v_mul_f32 v25, v77, v77
  v_mul_f32 v26, v78, v78
  v_mul_f32 v27, v79, v79
  v_mfma_f32_32x32x16_bf16 v[40:55], a[176:179], a[96:99], v[40:55]
  ds_read_b128 a[172:175], v2 offset:35840
  v_fma_f32 v24, v24, v110, v111
  v_fma_f32 v25, v25, v110, v111
  v_fma_f32 v26, v26, v110, v111
  v_fma_f32 v27, v27, v110, v111
  s_waitcnt lgkmcnt(4)
  v_mfma_f32_32x32x16_bf16 v[40:55], a[180:183], a[100:103], v[40:55]
  ds_read_b128 a[176:179], v2 offset:36864
  buffer_load_dwordx4 v1, s[20:23], s34 offen offset:3072 sc1 lds
  v_mul_f32 v24, v24, v76
  v_mul_f32 v25, v25, v77
  v_mfma_f32_32x32x16_bf16 v[40:55], a[184:187], a[104:107], v[40:55]
  ds_read_b128 a[180:183], v2 offset:37888
  v_mul_f32 v26, v26, v78
  v_mul_f32 v27, v27, v79
  v_exp_f32 v24, v24
  v_mul_f32 v84, v76, v84
  v_mfma_f32_32x32x16_bf16 v[40:55], a[188:191], a[108:111], v[40:55]
  ds_read_b128 a[184:187], v2 offset:38912
  v_exp_f32 v25, v25
  v_mul_f32 v85, v77, v85
  s_waitcnt lgkmcnt(4)
  v_mfma_f32_32x32x16_bf16 v[40:55], a[160:163], a[112:115], v[40:55]
  ds_read_b128 a[188:191], v2 offset:39936
  v_exp_f32 v26, v26
  v_mul_f32 v86, v78, v86
  v_exp_f32 v27, v27
  v_mfma_f32_32x32x16_bf16 v[40:55], a[164:167], a[116:119], v[40:55]
  ds_read_b128 a[160:163], v2 offset:40960
  v_mul_f32 v87, v79, v87
  v_fma_f32 v24, v24, v108, v108
  v_fma_f32 v25, v25, v108, v108
  v_fma_f32 v26, v26, v108, v108
  v_fma_f32 v27, v27, v108, v108
  v_mfma_f32_32x32x16_bf16 v[40:55], a[168:171], a[120:123], v[40:55]
  ds_read_b128 a[164:167], v2 offset:41984
  v_rcp_f32 v24, v24
  v_rcp_f32 v25, v25
  s_waitcnt lgkmcnt(4)
  v_mfma_f32_32x32x16_bf16 v[40:55], a[172:175], a[124:127], v[40:55]
  ds_read_b128 a[168:171], v2 offset:43008
  s_add_u32 m0, s27, 4096
  s_add_u32 s34, s33, 266240
  buffer_load_dwordx4 v1, s[20:23], s34 offen offset:0 sc1 lds
  v_mfma_f32_32x32x16_bf16 v[40:55], a[176:179], a[128:131], v[40:55]
  ds_read_b128 a[172:175], v2 offset:44032
  v_rcp_f32 v26, v26
  v_rcp_f32 v27, v27
  v_mul_f32 v84, v84, v24
  v_mfma_f32_32x32x16_bf16 v[40:55], a[180:183], a[132:135], v[40:55]
  ds_read_b128 a[176:179], v2 offset:45056
  v_mul_f32 v85, v85, v25
  v_mul_f32 v86, v86, v26
  v_mul_f32 v87, v87, v27
  v_cvt_pk_bf16_f32 v30, v84, v85
  s_waitcnt lgkmcnt(4)
  v_mfma_f32_32x32x16_bf16 v[40:55], a[184:187], a[136:139], v[40:55]
  ds_read_b128 a[180:183], v2 offset:46080
  v_cvt_pk_bf16_f32 v31, v86, v87
  buffer_store_dwordx4 v[28:31], v9, s[8:11], s60 offen offset:1024 sc1
  v_mul_f32 v24, v88, v88
  v_mfma_f32_32x32x16_bf16 v[40:55], a[188:191], a[140:143], v[40:55]
  ds_read_b128 a[184:187], v2 offset:47104
  v_mul_f32 v25, v89, v89
  v_mul_f32 v26, v90, v90
  v_mul_f32 v27, v91, v91
  v_fma_f32 v24, v24, v110, v111
  v_fma_f32 v25, v25, v110, v111
  v_mfma_f32_32x32x16_bf16 v[40:55], a[160:163], a[144:147], v[40:55]
  ds_read_b128 a[188:191], v2 offset:48128
  v_fma_f32 v26, v26, v110, v111
  v_fma_f32 v27, v27, v110, v111
  v_mul_f32 v24, v24, v88
  v_mul_f32 v25, v25, v89
  s_waitcnt lgkmcnt(4)
  v_mfma_f32_32x32x16_bf16 v[40:55], a[164:167], a[148:151], v[40:55]
  ds_read_b128 a[160:163], v2 offset:49152
  buffer_load_dwordx4 v1, s[20:23], s34 offen offset:1024 sc1 lds
  v_mul_f32 v26, v26, v90
  v_mul_f32 v27, v27, v91
  v_mfma_f32_32x32x16_bf16 v[40:55], a[168:171], a[152:155], v[40:55]
  ds_read_b128 a[164:167], v2 offset:50176
  v_exp_f32 v24, v24
  v_mul_f32 v96, v88, v96
  v_exp_f32 v25, v25
  v_mfma_f32_32x32x16_bf16 v[40:55], a[172:175], a[156:159], v[40:55]
  ds_read_b128 a[168:171], v2 offset:51200
  v_mul_f32 v97, v89, v97
  v_exp_f32 v26, v26
  v_mul_f32 v98, v90, v98
  s_waitcnt lgkmcnt(4)
  v_mfma_f32_32x32x16_bf16 v[40:55], a[176:179], v[104:107], v[40:55]
  ds_read_b128 a[172:175], v2 offset:52224
  v_exp_f32 v27, v27
  v_mul_f32 v99, v91, v99
  v_fma_f32 v24, v24, v108, v108
  v_fma_f32 v25, v25, v108, v108
  v_mfma_f32_32x32x16_bf16 v[56:71], a[180:183], a[0:3], 0
  ds_read_b128 a[176:179], v2 offset:53248
  v_fma_f32 v26, v26, v108, v108
  v_fma_f32 v27, v27, v108, v108
  v_rcp_f32 v24, v24
  v_mfma_f32_32x32x16_bf16 v[56:71], a[184:187], a[4:7], v[56:71]
  ds_read_b128 a[180:183], v2 offset:54272
  v_rcp_f32 v25, v25
  v_rcp_f32 v26, v26
  s_waitcnt lgkmcnt(4)
  v_mfma_f32_32x32x16_bf16 v[56:71], a[188:191], a[8:11], v[56:71]
  ds_read_b128 a[184:187], v2 offset:55296
  buffer_load_dwordx4 v1, s[20:23], s34 offen offset:2048 sc1 lds
  v_rcp_f32 v27, v27
  v_mfma_f32_32x32x16_bf16 v[56:71], a[160:163], a[12:15], v[56:71]
  ds_read_b128 a[188:191], v2 offset:56320
  v_mul_f32 v96, v96, v24
  v_mul_f32 v97, v97, v25
  v_mul_f32 v98, v98, v26
  v_mul_f32 v99, v99, v27
  v_cvt_pk_bf16_f32 v32, v96, v97
  v_mfma_f32_32x32x16_bf16 v[56:71], a[164:167], a[16:19], v[56:71]
  ds_read_b128 a[160:163], v2 offset:57344
  v_cvt_pk_bf16_f32 v33, v98, v99
  v_mul_f32 v24, v92, v92
  v_mul_f32 v25, v93, v93
  v_mul_f32 v26, v94, v94
  s_waitcnt lgkmcnt(4)
  v_mfma_f32_32x32x16_bf16 v[56:71], a[168:171], a[20:23], v[56:71]
  ds_read_b128 a[164:167], v2 offset:58368
  v_mul_f32 v27, v95, v95
  v_fma_f32 v24, v24, v110, v111
  v_fma_f32 v25, v25, v110, v111
  v_fma_f32 v26, v26, v110, v111
  v_fma_f32 v27, v27, v110, v111
  v_mfma_f32_32x32x16_bf16 v[56:71], a[172:175], a[24:27], v[56:71]
  ds_read_b128 a[168:171], v2 offset:59392
  v_mul_f32 v24, v24, v92
  v_mul_f32 v25, v25, v93
  v_mul_f32 v26, v26, v94
  v_mul_f32 v27, v27, v95
  v_mfma_f32_32x32x16_bf16 v[56:71], a[176:179], a[28:31], v[56:71]
  ds_read_b128 a[172:175], v2 offset:60416
  v_exp_f32 v24, v24
  v_mul_f32 v100, v92, v100
  s_waitcnt lgkmcnt(4)
  v_mfma_f32_32x32x16_bf16 v[56:71], a[180:183], a[32:35], v[56:71]
  ds_read_b128 a[176:179], v2 offset:61440
  buffer_load_dwordx4 v1, s[20:23], s34 offen offset:3072 sc1 lds
  v_exp_f32 v25, v25
  v_mfma_f32_32x32x16_bf16 v[56:71], a[184:187], a[36:39], v[56:71]
  ds_read_b128 a[180:183], v2 offset:62464
  v_mul_f32 v101, v93, v101
  v_exp_f32 v26, v26
  v_mul_f32 v102, v94, v102
  v_mfma_f32_32x32x16_bf16 v[56:71], a[188:191], a[40:43], v[56:71]
  ds_read_b128 a[184:187], v2 offset:63488
  v_exp_f32 v27, v27
  v_mul_f32 v103, v95, v103
  v_fma_f32 v24, v24, v108, v108
  s_waitcnt lgkmcnt(4)
  v_mfma_f32_32x32x16_bf16 v[56:71], a[160:163], a[44:47], v[56:71]
  ds_read_b128 a[188:191], v2 offset:64512
  v_fma_f32 v25, v25, v108, v108
  v_fma_f32 v26, v26, v108, v108
  v_fma_f32 v27, v27, v108, v108
  s_waitcnt vmcnt(10)
  s_barrier
  v_mfma_f32_32x32x16_bf16 v[56:71], a[164:167], a[48:51], v[56:71]
  ds_read_b128 a[160:163], v3 offset:0
  v_rcp_f32 v24, v24
  v_rcp_f32 v25, v25
  v_mfma_f32_32x32x16_bf16 v[56:71], a[168:171], a[52:55], v[56:71]
  ds_read_b128 a[164:167], v3 offset:1024
  v_rcp_f32 v26, v26
  v_rcp_f32 v27, v27
  s_waitcnt lgkmcnt(4)
  v_mfma_f32_32x32x16_bf16 v[56:71], a[172:175], a[56:59], v[56:71]
  ds_read_b128 a[168:171], v3 offset:2048
  v_mul_f32 v100, v100, v24
  v_mul_f32 v101, v101, v25
  v_mul_f32 v102, v102, v26
  v_mul_f32 v103, v103, v27
  v_cvt_pk_bf16_f32 v34, v100, v101
  v_mfma_f32_32x32x16_bf16 v[56:71], a[176:179], a[60:63], v[56:71]
  ds_read_b128 a[172:175], v3 offset:3072
  v_cvt_pk_bf16_f32 v35, v102, v103
  buffer_store_dwordx4 v[32:35], v9, s[8:11], s60 offen offset:1536 sc1
  v_mul_f32 v24, v40, v40
  v_mfma_f32_32x32x16_bf16 v[56:71], a[180:183], a[64:67], v[56:71]
  ds_read_b128 a[176:179], v3 offset:4096
  v_mul_f32 v25, v41, v41
  v_mul_f32 v26, v42, v42
  v_mul_f32 v27, v43, v43
  v_fma_f32 v24, v24, v110, v111
  s_waitcnt lgkmcnt(4)
  v_mfma_f32_32x32x16_bf16 v[56:71], a[184:187], a[68:71], v[56:71]
  ds_read_b128 a[180:183], v3 offset:5120
  v_fma_f32 v25, v25, v110, v111
  v_fma_f32 v26, v26, v110, v111
  v_fma_f32 v27, v27, v110, v111
  v_mul_f32 v24, v24, v40
  v_mul_f32 v25, v25, v41
  v_mfma_f32_32x32x16_bf16 v[56:71], a[188:191], a[72:75], v[56:71]
  ds_read_b128 a[184:187], v3 offset:6144
  v_mul_f32 v26, v26, v42
  v_mul_f32 v27, v27, v43
  v_exp_f32 v24, v24
  v_mul_f32 v48, v40, v48
  v_mfma_f32_32x32x16_bf16 v[56:71], a[160:163], a[76:79], v[56:71]
  ds_read_b128 a[188:191], v3 offset:7168
  v_exp_f32 v25, v25
  v_mul_f32 v49, v41, v49
  s_waitcnt lgkmcnt(4)
  v_mfma_f32_32x32x16_bf16 v[56:71], a[164:167], a[80:83], v[56:71]
  ds_read_b128 a[160:163], v3 offset:8192
  v_exp_f32 v26, v26
  v_mul_f32 v50, v42, v50
  v_exp_f32 v27, v27
  v_mfma_f32_32x32x16_bf16 v[56:71], a[168:171], a[84:87], v[56:71]
  ds_read_b128 a[164:167], v3 offset:9216
  v_mul_f32 v51, v43, v51
  v_fma_f32 v24, v24, v108, v108
  v_fma_f32 v25, v25, v108, v108
  v_fma_f32 v26, v26, v108, v108
  v_fma_f32 v27, v27, v108, v108
  v_mfma_f32_32x32x16_bf16 v[56:71], a[172:175], a[88:91], v[56:71]
  ds_read_b128 a[168:171], v3 offset:10240
  v_rcp_f32 v24, v24
  v_rcp_f32 v25, v25
  s_waitcnt lgkmcnt(4)
  v_mfma_f32_32x32x16_bf16 v[56:71], a[176:179], a[92:95], v[56:71]
  ds_read_b128 a[172:175], v3 offset:11264
  v_rcp_f32 v26, v26
  v_rcp_f32 v27, v27
  v_mul_f32 v48, v48, v24
  v_mfma_f32_32x32x16_bf16 v[56:71], a[180:183], a[96:99], v[56:71]
  ds_read_b128 a[176:179], v3 offset:12288
  v_mul_f32 v49, v49, v25
  v_mul_f32 v50, v50, v26
  v_mul_f32 v51, v51, v27
  v_cvt_pk_bf16_f32 v28, v48, v49
  v_cvt_pk_bf16_f32 v29, v50, v51
  v_mfma_f32_32x32x16_bf16 v[56:71], a[184:187], a[100:103], v[56:71]
  ds_read_b128 a[180:183], v3 offset:13312
  v_mul_f32 v24, v44, v44
  v_mul_f32 v25, v45, v45
  v_mul_f32 v26, v46, v46
  v_mul_f32 v27, v47, v47
  s_waitcnt lgkmcnt(4)
  v_mfma_f32_32x32x16_bf16 v[56:71], a[188:191], a[104:107], v[56:71]
  ds_read_b128 a[184:187], v3 offset:14336
  v_fma_f32 v24, v24, v110, v111
  v_fma_f32 v25, v25, v110, v111
  v_fma_f32 v26, v26, v110, v111
  v_fma_f32 v27, v27, v110, v111
  v_mul_f32 v24, v24, v44
  v_mfma_f32_32x32x16_bf16 v[56:71], a[160:163], a[108:111], v[56:71]
  ds_read_b128 a[188:191], v3 offset:15360
  v_mul_f32 v25, v25, v45
  v_mul_f32 v26, v26, v46
  v_mul_f32 v27, v27, v47
  v_exp_f32 v24, v24
  v_mfma_f32_32x32x16_bf16 v[56:71], a[164:167], a[112:115], v[56:71]
  ds_read_b128 a[160:163], v3 offset:16384
  v_mul_f32 v52, v44, v52
  v_exp_f32 v25, v25
  v_mul_f32 v53, v45, v53
  s_waitcnt lgkmcnt(4)
  v_mfma_f32_32x32x16_bf16 v[56:71], a[168:171], a[116:119], v[56:71]
  ds_read_b128 a[164:167], v3 offset:17408
  v_exp_f32 v26, v26
  v_mul_f32 v54, v46, v54
  v_exp_f32 v27, v27
  v_mfma_f32_32x32x16_bf16 v[56:71], a[172:175], a[120:123], v[56:71]
  ds_read_b128 a[168:171], v3 offset:18432
  v_mul_f32 v55, v47, v55
  v_fma_f32 v24, v24, v108, v108
  v_fma_f32 v25, v25, v108, v108
  v_fma_f32 v26, v26, v108, v108
  v_fma_f32 v27, v27, v108, v108
  v_mfma_f32_32x32x16_bf16 v[56:71], a[176:179], a[124:127], v[56:71]
  ds_read_b128 a[172:175], v3 offset:19456
  v_rcp_f32 v24, v24
  v_rcp_f32 v25, v25
  s_waitcnt lgkmcnt(4)
  v_mfma_f32_32x32x16_bf16 v[56:71], a[180:183], a[128:131], v[56:71]
  ds_read_b128 a[176:179], v3 offset:20480
  v_rcp_f32 v26, v26
  v_rcp_f32 v27, v27
  v_mul_f32 v52, v52, v24
  v_mfma_f32_32x32x16_bf16 v[56:71], a[184:187], a[132:135], v[56:71]
  ds_read_b128 a[180:183], v3 offset:21504
  v_mul_f32 v53, v53, v25
  v_mul_f32 v54, v54, v26
  v_mul_f32 v55, v55, v27
  v_cvt_pk_bf16_f32 v30, v52, v53
  v_cvt_pk_bf16_f32 v31, v54, v55
  v_mfma_f32_32x32x16_bf16 v[56:71], a[188:191], a[136:139], v[56:71]
  ds_read_b128 a[184:187], v3 offset:22528
  buffer_store_dwordx4 v[28:31], v9, s[8:11], s60 offen offset:2048 sc1
  s_waitcnt lgkmcnt(4)
  v_mfma_f32_32x32x16_bf16 v[56:71], a[160:163], a[140:143], v[56:71]
  ds_read_b128 a[188:191], v3 offset:23552
  v_mfma_f32_32x32x16_bf16 v[56:71], a[164:167], a[144:147], v[56:71]
  ds_read_b128 a[160:163], v3 offset:24576
  v_mfma_f32_32x32x16_bf16 v[56:71], a[168:171], a[148:151], v[56:71]
  ds_read_b128 a[164:167], v3 offset:25600
  s_waitcnt lgkmcnt(4)
  v_mfma_f32_32x32x16_bf16 v[56:71], a[172:175], a[152:155], v[56:71]
  ds_read_b128 a[168:171], v3 offset:26624
  v_mfma_f32_32x32x16_bf16 v[56:71], a[176:179], a[156:159], v[56:71]
  ds_read_b128 a[172:175], v3 offset:27648
  v_mfma_f32_32x32x16_bf16 v[56:71], a[180:183], v[104:107], v[56:71]
  ds_read_b128 a[176:179], v3 offset:28672
  s_waitcnt lgkmcnt(4)
  v_mfma_f32_32x32x16_bf16 v[72:87], a[184:187], a[0:3], 0
  ds_read_b128 a[180:183], v3 offset:29696
  v_mfma_f32_32x32x16_bf16 v[72:87], a[188:191], a[4:7], v[72:87]
  ds_read_b128 a[184:187], v3 offset:30720
  s_add_u32 s77, s56, 53248
  buffer_load_dwordx4 a[0:3], v1, s[8:11], s77 offen offset:0 sc1
  v_mfma_f32_32x32x16_bf16 v[72:87], a[160:163], a[8:11], v[72:87]
  ds_read_b128 a[188:191], v3 offset:31744
  s_nop 1
  v_mul_f32 v24, v56, v56
  v_mul_f32 v25, v57, v57
  s_waitcnt vmcnt(3)
  s_barrier
  s_waitcnt lgkmcnt(4)
  v_mfma_f32_32x32x16_bf16 v[72:87], a[164:167], a[12:15], v[72:87]
  ds_read_b128 a[160:163], v1 offset:0
  buffer_load_dwordx4 a[4:7], v1, s[8:11], s77 offen offset:1024 sc1
  v_mul_f32 v26, v58, v58
  v_mul_f32 v27, v59, v59
  v_mfma_f32_32x32x16_bf16 v[72:87], a[168:171], a[16:19], v[72:87]
  ds_read_b128 a[164:167], v1 offset:1024
  v_fma_f32 v24, v24, v110, v111
  v_fma_f32 v25, v25, v110, v111
  v_fma_f32 v26, v26, v110, v111
  v_fma_f32 v27, v27, v110, v111
  v_mul_f32 v24, v24, v56
  v_mfma_f32_32x32x16_bf16 v[72:87], a[172:175], a[20:23], v[72:87]
  ds_read_b128 a[168:171], v1 offset:2048
  buffer_load_dwordx4 a[8:11], v1, s[8:11], s77 offen offset:2048 sc1
  v_mul_f32 v25, v25, v57
  s_waitcnt lgkmcnt(4)
  v_mfma_f32_32x32x16_bf16 v[72:87], a[176:179], a[24:27], v[72:87]
  ds_read_b128 a[172:175], v1 offset:3072
  v_mul_f32 v26, v26, v58
  v_mul_f32 v27, v27, v59
  v_exp_f32 v24, v24
  v_mul_f32 v64, v56, v64
  v_mfma_f32_32x32x16_bf16 v[72:87], a[180:183], a[28:31], v[72:87]
  ds_read_b128 a[176:179], v1 offset:4096
  buffer_load_dwordx4 a[12:15], v1, s[8:11], s77 offen offset:3072 sc1
  v_exp_f32 v25, v25
  v_mfma_f32_32x32x16_bf16 v[72:87], a[184:187], a[32:35], v[72:87]
  ds_read_b128 a[180:183], v1 offset:5120
  v_mul_f32 v65, v57, v65
  v_exp_f32 v26, v26
  v_mul_f32 v66, v58, v66
  s_waitcnt lgkmcnt(4)
  v_mfma_f32_32x32x16_bf16 v[72:87], a[188:191], a[36:39], v[72:87]
  ds_read_b128 a[184:187], v1 offset:6144
  s_add_u32 s77, s56, 57344
  buffer_load_dwordx4 a[16:19], v1, s[8:11], s77 offen offset:0 sc1
  v_mfma_f32_32x32x16_bf16 v[72:87], a[160:163], a[40:43], v[72:87]
  ds_read_b128 a[188:191], v1 offset:7168
  v_exp_f32 v27, v27
  v_mul_f32 v67, v59, v67
  v_fma_f32 v24, v24, v108, v108
  v_fma_f32 v25, v25, v108, v108
  v_mfma_f32_32x32x16_bf16 v[72:87], a[164:167], a[44:47], v[72:87]
  ds_read_b128 a[160:163], v1 offset:8192
  buffer_load_dwordx4 a[20:23], v1, s[8:11], s77 offen offset:1024 sc1
  v_fma_f32 v26, v26, v108, v108
  s_waitcnt lgkmcnt(4)
  v_mfma_f32_32x32x16_bf16 v[72:87], a[168:171], a[48:51], v[72:87]
  ds_read_b128 a[164:167], v1 offset:9216
  v_fma_f32 v27, v27, v108, v108
  v_rcp_f32 v24, v24
  v_rcp_f32 v25, v25
  v_mfma_f32_32x32x16_bf16 v[72:87], a[172:175], a[52:55], v[72:87]
  ds_read_b128 a[168:171], v1 offset:10240
  buffer_load_dwordx4 a[24:27], v1, s[8:11], s77 offen offset:2048 sc1
  v_rcp_f32 v26, v26
  v_mfma_f32_32x32x16_bf16 v[72:87], a[176:179], a[56:59], v[72:87]
  ds_read_b128 a[172:175], v1 offset:11264
  v_rcp_f32 v27, v27
  v_mul_f32 v64, v64, v24
  v_mul_f32 v65, v65, v25
  s_waitcnt lgkmcnt(4)
  v_mfma_f32_32x32x16_bf16 v[72:87], a[180:183], a[60:63], v[72:87]
  ds_read_b128 a[176:179], v1 offset:12288
  buffer_load_dwordx4 a[28:31], v1, s[8:11], s77 offen offset:3072 sc1
  v_mfma_f32_32x32x16_bf16 v[72:87], a[184:187], a[64:67], v[72:87]
  ds_read_b128 a[180:183], v1 offset:13312
  s_waitcnt vmcnt(8)
  s_add_u32 s3, s42, 12464128
  s_mov_b64 exec, 1
  s_cmp_lg_u32 s16, 0
  s_cbranch_scc1 HS11_2
  buffer_store_dword v20, v1, s[8:11], s3 offen
HB11_2:
  s_mov_b64 exec, -1
  v_mul_f32 v66, v66, v26
  v_mfma_f32_32x32x16_bf16 v[72:87], a[188:191], a[68:71], v[72:87]
  ds_read_b128 a[184:187], v1 offset:14336
  s_add_u32 s77, s56, 61440
  buffer_load_dwordx4 a[32:35], v1, s[8:11], s77 offen offset:0 sc1
  s_waitcnt lgkmcnt(4)
  v_mfma_f32_32x32x16_bf16 v[72:87], a[160:163], a[72:75], v[72:87]
  ds_read_b128 a[188:191], v1 offset:15360
  v_mul_f32 v67, v67, v27
  v_cvt_pk_bf16_f32 v32, v64, v65
  v_cvt_pk_bf16_f32 v33, v66, v67
  v_mul_f32 v24, v60, v60
  v_mul_f32 v25, v61, v61
  v_mfma_f32_32x32x16_bf16 v[72:87], a[164:167], a[76:79], v[72:87]
  ds_read_b128 a[160:163], v1 offset:16384
  buffer_load_dwordx4 a[36:39], v1, s[8:11], s77 offen offset:1024 sc1
  v_mul_f32 v26, v62, v62
  v_mul_f32 v27, v63, v63
  v_mfma_f32_32x32x16_bf16 v[72:87], a[168:171], a[80:83], v[72:87]
  ds_read_b128 a[164:167], v1 offset:17408
  v_fma_f32 v24, v24, v110, v111
  v_fma_f32 v25, v25, v110, v111
  v_fma_f32 v26, v26, v110, v111
  v_fma_f32 v27, v27, v110, v111
  s_waitcnt lgkmcnt(4)
  v_mfma_f32_32x32x16_bf16 v[72:87], a[172:175], a[84:87], v[72:87]
  ds_read_b128 a[168:171], v1 offset:18432
  buffer_load_dwordx4 a[40:43], v1, s[8:11], s77 offen offset:2048 sc1
  v_mul_f32 v24, v24, v60
  v_mul_f32 v25, v25, v61
  v_mfma_f32_32x32x16_bf16 v[72:87], a[176:179], a[88:91], v[72:87]
  ds_read_b128 a[172:175], v1 offset:19456
  v_mul_f32 v26, v26, v62
  v_mul_f32 v27, v27, v63
  v_exp_f32 v24, v24
  v_mul_f32 v68, v60, v68
  v_mfma_f32_32x32x16_bf16 v[72:87], a[180:183], a[92:95], v[72:87]
  ds_read_b128 a[176:179], v1 offset:20480
  buffer_load_dwordx4 a[44:47], v1, s[8:11], s77 offen offset:3072 sc1
  s_waitcnt lgkmcnt(4)
  v_mfma_f32_32x32x16_bf16 v[72:87], a[184:187], a[96:99], v[72:87]
  ds_read_b128 a[180:183], v1 offset:21504
  v_exp_f32 v25, v25
  v_mul_f32 v69, v61, v69
  v_exp_f32 v26, v26
  v_mfma_f32_32x32x16_bf16 v[72:87], a[188:191], a[100:103], v[72:87]
  ds_read_b128 a[184:187], v1 offset:22528
  s_add_u32 s77, s56, 65536
  buffer_load_dwordx4 a[48:51], v1, s[8:11], s77 offen offset:0 sc1
  v_mul_f32 v70, v62, v70
  v_mfma_f32_32x32x16_bf16 v[72:87], a[160:163], a[104:107], v[72:87]
  ds_read_b128 a[188:191], v1 offset:23552
  v_exp_f32 v27, v27
  v_mul_f32 v71, v63, v71
  v_fma_f32 v24, v24, v108, v108
  s_waitcnt lgkmcnt(4)
  v_mfma_f32_32x32x16_bf16 v[72:87], a[164:167], a[108:111], v[72:87]
  ds_read_b128 a[160:163], v1 offset:24576
  buffer_load_dwordx4 a[52:55], v4, s[8:11], s77 offen offset:1024 sc1
  v_fma_f32 v25, v25, v108, v108
  v_fma_f32 v26, v26, v108, v108
  v_mfma_f32_32x32x16_bf16 v[72:87], a[168:171], a[112:115], v[72:87]
  ds_read_b128 a[164:167], v1 offset:25600
  v_fma_f32 v27, v27, v108, v108
  v_rcp_f32 v24, v24
  v_rcp_f32 v25, v25
  v_mfma_f32_32x32x16_bf16 v[72:87], a[172:175], a[116:119], v[72:87]
  ds_read_b128 a[168:171], v1 offset:26624
  buffer_load_dwordx4 a[56:59], v4, s[8:11], s77 offen offset:2048 sc1
  s_waitcnt lgkmcnt(4)
  v_mfma_f32_32x32x16_bf16 v[72:87], a[176:179], a[120:123], v[72:87]
  ds_read_b128 a[172:175], v1 offset:27648
  v_rcp_f32 v26, v26
  v_rcp_f32 v27, v27
  v_mul_f32 v68, v68, v24
  v_mfma_f32_32x32x16_bf16 v[72:87], a[180:183], a[124:127], v[72:87]
  ds_read_b128 a[176:179], v1 offset:28672
  buffer_load_dwordx4 a[60:63], v4, s[8:11], s77 offen offset:3072 sc1
  v_mul_f32 v69, v69, v25
  v_mul_f32 v70, v70, v26
  v_mfma_f32_32x32x16_bf16 v[72:87], a[184:187], a[128:131], v[72:87]
  ds_read_b128 a[180:183], v1 offset:29696
  v_mul_f32 v71, v71, v27
  v_cvt_pk_bf16_f32 v34, v68, v69
  v_cvt_pk_bf16_f32 v35, v70, v71
  s_waitcnt lgkmcnt(4)
  v_mfma_f32_32x32x16_bf16 v[72:87], a[188:191], a[132:135], v[72:87]
  ds_read_b128 a[184:187], v1 offset:30720
  s_add_u32 s77, s56, 69632
  buffer_load_dwordx4 a[64:67], v4, s[8:11], s77 offen offset:0 sc1
  v_mfma_f32_32x32x16_bf16 v[72:87], a[160:163], a[136:139], v[72:87]
  buffer_store_dwordx4 v[32:35], v9, s[8:11], s61 offen offset:0 sc1
  v_mfma_f32_32x32x16_bf16 v[72:87], a[164:167], a[140:143], v[72:87]
  buffer_load_dwordx4 a[68:71], v4, s[8:11], s77 offen offset:1024 sc1
  s_waitcnt lgkmcnt(2)
  v_mfma_f32_32x32x16_bf16 v[72:87], a[168:171], a[144:147], v[72:87]
  v_mfma_f32_32x32x16_bf16 v[72:87], a[172:175], a[148:151], v[72:87]
  v_mfma_f32_32x32x16_bf16 v[72:87], a[176:179], a[152:155], v[72:87]
  s_waitcnt lgkmcnt(0)
  v_mfma_f32_32x32x16_bf16 v[72:87], a[180:183], a[156:159], v[72:87]
  v_mfma_f32_32x32x16_bf16 v[72:87], a[184:187], v[104:107], v[72:87]
  s_add_u32 s70, s45, 12464128
  s_mov_b64 exec, 0xff
  buffer_load_dword v21, v5, s[8:11], s70 offen sc1
  s_mov_b64 exec, -1
  s_barrier
  s_nop 6
  v_pk_mul_f32 v[24:25], v[72:73], v[72:73]
  v_pk_mul_f32 v[26:27], v[74:75], v[74:75]
  v_pk_fma_f32 v[24:25], v[24:25], v[110:111], v[110:111] op_sel:[0,0,1] op_sel_hi:[1,0,1]
  v_pk_fma_f32 v[26:27], v[26:27], v[110:111], v[110:111] op_sel:[0,0,1] op_sel_hi:[1,0,1]
  v_pk_mul_f32 v[24:25], v[24:25], v[72:73]
  v_pk_mul_f32 v[26:27], v[26:27], v[74:75]
  v_exp_f32 v24, v24
  v_exp_f32 v25, v25
  v_exp_f32 v26, v26
  v_exp_f32 v27, v27
  v_pk_mul_f32 v[80:81], v[72:73], v[80:81]
  v_pk_mul_f32 v[82:83], v[74:75], v[82:83]
  v_pk_fma_f32 v[24:25], v[24:25], v[108:109], v[108:109] op_sel:[0,0,0] op_sel_hi:[1,0,0]
  v_pk_fma_f32 v[26:27], v[26:27], v[108:109], v[108:109] op_sel:[0,0,0] op_sel_hi:[1,0,0]
  v_rcp_f32 v24, v24
  v_rcp_f32 v25, v25
  v_rcp_f32 v26, v26
  v_rcp_f32 v27, v27
  v_pk_mul_f32 v[80:81], v[80:81], v[24:25]
  v_pk_mul_f32 v[82:83], v[82:83], v[26:27]
  v_cvt_pk_bf16_f32 v28, v80, v81
  v_cvt_pk_bf16_f32 v29, v82, v83
  s_waitcnt vmcnt(0)
  v_cmp_ne_u32 vcc, v20, v21
  s_nop 3
  s_and_b64 vcc, vcc, 0xff
  s_cbranch_vccnz PHE_SPIN_2
PHE_OK_2:
  buffer_load_dwordx4 a[72:75], v1, s[8:11], s50 offen offset:0 sc1
  buffer_load_dwordx4 a[76:79], v1, s[8:11], s50 offen offset:1024 sc1
  buffer_load_dwordx4 a[80:83], v1, s[8:11], s50 offen offset:2048 sc1
  buffer_load_dwordx4 a[84:87], v1, s[8:11], s50 offen offset:3072 sc1
  s_add_u32 s54, s50, 4096
  buffer_load_dwordx4 a[88:91], v1, s[8:11], s54 offen offset:0 sc1
  buffer_load_dwordx4 a[92:95], v1, s[8:11], s54 offen offset:1024 sc1
  v_pk_mul_f32 v[24:25], v[76:77], v[76:77]
  v_pk_mul_f32 v[26:27], v[78:79], v[78:79]
  v_pk_fma_f32 v[24:25], v[24:25], v[110:111], v[110:111] op_sel:[0,0,1] op_sel_hi:[1,0,1]
  v_pk_fma_f32 v[26:27], v[26:27], v[110:111], v[110:111] op_sel:[0,0,1] op_sel_hi:[1,0,1]
  v_pk_mul_f32 v[24:25], v[24:25], v[76:77]
  v_pk_mul_f32 v[26:27], v[26:27], v[78:79]
  v_exp_f32 v24, v24
  v_exp_f32 v25, v25
  v_exp_f32 v26, v26
  v_exp_f32 v27, v27
  v_pk_mul_f32 v[84:85], v[76:77], v[84:85]
  v_pk_mul_f32 v[86:87], v[78:79], v[86:87]
  v_pk_fma_f32 v[24:25], v[24:25], v[108:109], v[108:109] op_sel:[0,0,0] op_sel_hi:[1,0,0]
  v_pk_fma_f32 v[26:27], v[26:27], v[108:109], v[108:109] op_sel:[0,0,0] op_sel_hi:[1,0,0]
  v_rcp_f32 v24, v24
  v_rcp_f32 v25, v25
  v_rcp_f32 v26, v26
  v_rcp_f32 v27, v27
  v_pk_mul_f32 v[84:85], v[84:85], v[24:25]
  v_pk_mul_f32 v[86:87], v[86:87], v[26:27]
  v_cvt_pk_bf16_f32 v30, v84, v85
  v_cvt_pk_bf16_f32 v31, v86, v87
  buffer_store_dwordx4 v[28:31], v9, s[8:11], s61 offen offset:512 sc1
  s_add_u32 s3, s12, 1
  s_and_b32 s3, s3, 3
  s_mul_i32 s3, s3, 15360
  s_add_u32 s3, s3, 102400
  v_add_u32 v106, s3, v1
  s_add_u32 s3, s12, 2
  s_and_b32 s3, s3, 3
  s_mul_i32 s3, s3, 15360
  s_add_u32 s3, s3, 107520
  v_add_u32 v107, s3, v1
  s_add_u32 s3, s12, 3
  s_and_b32 s3, s3, 3
  s_mul_i32 s3, s3, 15360
  s_add_u32 s3, s3, 112640
  v_add_u32 v108, s3, v1
  s_mul_i32 s3, s12, 15360
  s_add_u32 s3, s3, 102400
  v_add_u32 v109, s3, v1
  v_lshlrev_b32 v84, 16, v10
  v_and_b32 v85, 0xffff0000, v10
  v_lshlrev_b32 v86, 16, v11
  v_and_b32 v87, 0xffff0000, v11
  v_lshlrev_b32 v88, 16, v12
  v_and_b32 v89, 0xffff0000, v12
  v_lshlrev_b32 v90, 16, v13
  v_and_b32 v91, 0xffff0000, v13
  v_lshlrev_b32 v92, 16, v14
  v_and_b32 v93, 0xffff0000, v14
  v_lshlrev_b32 v94, 16, v15
  v_and_b32 v95, 0xffff0000, v15
  v_lshlrev_b32 v96, 16, v16
  v_and_b32 v97, 0xffff0000, v16
  v_lshlrev_b32 v98, 16, v17
  v_and_b32 v99, 0xffff0000, v17
  v_lshlrev_b32 v100, 16, v18
  v_and_b32 v101, 0xffff0000, v18
  v_lshlrev_b32 v102, 16, v19
  v_and_b32 v103, 0xffff0000, v19
  s_waitcnt vmcnt(6)
  v_mfma_f32_16x16x32_bf16 v[24:27], v[192:195], a[72:75], 0
  buffer_load_dwordx4 a[96:99], v1, s[8:11], s54 offen offset:2048 sc1
  v_mfma_f32_16x16x32_bf16 v[28:31], v[196:199], a[72:75], 0
  buffer_load_dwordx4 a[100:103], v1, s[8:11], s54 offen offset:3072 sc1
  v_mfma_f32_16x16x32_bf16 v[32:35], v[200:203], a[72:75], 0
  s_add_u32 s54, s50, 8192
  buffer_load_dwordx4 a[104:107], v1, s[8:11], s54 offen offset:0 sc1
  v_mfma_f32_16x16x32_bf16 v[36:39], v[204:207], a[72:75], 0
  v_mfma_f32_16x16x32_bf16 v[40:43], v[208:211], a[72:75], 0
  s_waitcnt vmcnt(8)
  v_mfma_f32_16x16x32_bf16 v[24:27], v[212:215], a[76:79], v[24:27]
  buffer_load_dwordx4 a[108:111], v4, s[8:11], s54 offen offset:1024 sc1
  v_mfma_f32_16x16x32_bf16 v[28:31], v[216:219], a[76:79], v[28:31]
  v_mfma_f32_16x16x32_bf16 v[32:35], v[220:223], a[76:79], v[32:35]
  v_mfma_f32_16x16x32_bf16 v[36:39], v[224:227], a[76:79], v[36:39]
  v_mfma_f32_16x16x32_bf16 v[40:43], v[228:231], a[76:79], v[40:43]
  s_waitcnt vmcnt(8)
  v_mfma_f32_16x16x32_bf16 v[24:27], v[232:235], a[80:83], v[24:27]
  buffer_load_dwordx4 a[112:115], v1, s[8:11], s51 offen offset:0 sc1
  v_mfma_f32_16x16x32_bf16 v[28:31], v[236:239], a[80:83], v[28:31]
  v_mfma_f32_16x16x32_bf16 v[32:35], v[240:243], a[80:83], v[32:35]
  v_mfma_f32_16x16x32_bf16 v[36:39], v[244:247], a[80:83], v[36:39]
  v_mfma_f32_16x16x32_bf16 v[40:43], v[248:251], a[80:83], v[40:43]
  s_waitcnt vmcnt(8)
  v_mfma_f32_16x16x32_bf16 v[24:27], v[252:255], a[84:87], v[24:27]
  s_waitcnt vmcnt(5)
  s_add_u32 s3, s42, 12468224
  s_mov_b64 exec, 1
  s_cmp_lg_u32 s16, 0
  s_cbranch_scc1 HS12_2
  buffer_store_dword v20, v1, s[8:11], s3 offen
HB12_2:
  s_mov_b64 exec, -1
  buffer_load_dwordx4 a[116:119], v1, s[8:11], s51 offen offset:1024 sc1
  v_mfma_f32_16x16x32_bf16 v[28:31], a[192:195], a[84:87], v[28:31]
  v_mfma_f32_16x16x32_bf16 v[32:35], a[196:199], a[84:87], v[32:35]
  v_mfma_f32_16x16x32_bf16 v[36:39], a[200:203], a[84:87], v[36:39]
  v_mfma_f32_16x16x32_bf16 v[40:43], a[204:207], a[84:87], v[40:43]
  v_mfma_f32_16x16x32_bf16 v[24:27], a[208:211], a[88:91], v[24:27]
  buffer_load_dwordx4 a[120:123], v1, s[8:11], s51 offen offset:2048 sc1
  v_mfma_f32_16x16x32_bf16 v[28:31], a[212:215], a[88:91], v[28:31]
  v_mfma_f32_16x16x32_bf16 v[32:35], a[216:219], a[88:91], v[32:35]
  v_mfma_f32_16x16x32_bf16 v[36:39], a[220:223], a[88:91], v[36:39]
  v_mfma_f32_16x16x32_bf16 v[40:43], a[224:227], a[88:91], v[40:43]
  v_mfma_f32_16x16x32_bf16 v[24:27], a[228:231], a[92:95], v[24:27]
  buffer_load_dwordx4 a[124:127], v1, s[8:11], s51 offen offset:3072 sc1
  v_mfma_f32_16x16x32_bf16 v[28:31], a[232:235], a[92:95], v[28:31]
  v_mfma_f32_16x16x32_bf16 v[32:35], a[236:239], a[92:95], v[32:35]
  v_mfma_f32_16x16x32_bf16 v[36:39], a[240:243], a[92:95], v[36:39]
  v_mfma_f32_16x16x32_bf16 v[40:43], a[244:247], a[92:95], v[40:43]
  s_waitcnt vmcnt(8)
  v_mfma_f32_16x16x32_bf16 v[24:27], a[248:251], a[96:99], v[24:27]
  s_add_u32 s54, s51, 4096
  buffer_load_dwordx4 a[128:131], v1, s[8:11], s54 offen offset:0 sc1
  v_mfma_f32_16x16x32_bf16 v[28:31], a[252:255], a[96:99], v[28:31]
  v_mfma_f32_16x16x32_bf16 v[32:35], v[160:163], a[96:99], v[32:35]
  v_mfma_f32_16x16x32_bf16 v[36:39], v[164:167], a[96:99], v[36:39]
  v_mfma_f32_16x16x32_bf16 v[40:43], v[168:171], a[96:99], v[40:43]
  s_waitcnt vmcnt(8)
  v_mfma_f32_16x16x32_bf16 v[24:27], v[172:175], a[100:103], v[24:27]
  buffer_load_dwordx4 a[132:135], v1, s[8:11], s54 offen offset:1024 sc1
  v_mfma_f32_16x16x32_bf16 v[28:31], v[176:179], a[100:103], v[28:31]
  v_mfma_f32_16x16x32_bf16 v[32:35], v[180:183], a[100:103], v[32:35]
  v_mfma_f32_16x16x32_bf16 v[36:39], v[184:187], a[100:103], v[36:39]
  v_mfma_f32_16x16x32_bf16 v[40:43], v[188:191], a[100:103], v[40:43]
  s_waitcnt vmcnt(8)
  v_mfma_f32_16x16x32_bf16 v[24:27], v[112:115], a[104:107], v[24:27]
  buffer_load_dwordx4 a[136:139], v1, s[8:11], s54 offen offset:2048 sc1
  v_mfma_f32_16x16x32_bf16 v[28:31], v[116:119], a[104:107], v[28:31]
  v_mfma_f32_16x16x32_bf16 v[32:35], v[120:123], a[104:107], v[32:35]
  v_mfma_f32_16x16x32_bf16 v[36:39], v[124:127], a[104:107], v[36:39]
  v_mfma_f32_16x16x32_bf16 v[40:43], v[128:131], a[104:107], v[40:43]
  s_waitcnt vmcnt(8)
  v_mfma_f32_16x16x32_bf16 v[24:27], v[132:135], a[108:111], v[24:27]
  buffer_load_dwordx4 a[140:143], v1, s[8:11], s54 offen offset:3072 sc1
  v_mfma_f32_16x16x32_bf16 v[28:31], v[136:139], a[108:111], v[28:31]
  v_mfma_f32_16x16x32_bf16 v[32:35], v[140:143], a[108:111], v[32:35]
  v_mfma_f32_16x16x32_bf16 v[36:39], v[144:147], a[108:111], v[36:39]
  v_mfma_f32_16x16x32_bf16 v[40:43], v[148:151], a[108:111], v[40:43]
  s_waitcnt vmcnt(8)
  v_mfma_f32_16x16x32_bf16 v[44:47], v[192:195], a[112:115], 0
  s_add_u32 s54, s51, 8192
  buffer_load_dwordx4 a[144:147], v1, s[8:11], s54 offen offset:0 sc1
  v_mfma_f32_16x16x32_bf16 v[48:51], v[196:199], a[112:115], 0
  v_mfma_f32_16x16x32_bf16 v[52:55], v[200:203], a[112:115], 0
  v_mfma_f32_16x16x32_bf16 v[56:59], v[204:207], a[112:115], 0
  v_mfma_f32_16x16x32_bf16 v[60:63], v[208:211], a[112:115], 0
  s_waitcnt vmcnt(7)
  v_mfma_f32_16x16x32_bf16 v[44:47], v[212:215], a[116:119], v[44:47]
  buffer_load_dwordx4 a[148:151], v4, s[8:11], s54 offen offset:1024 sc1
  v_mfma_f32_16x16x32_bf16 v[48:51], v[216:219], a[116:119], v[48:51]
  v_mfma_f32_16x16x32_bf16 v[52:55], v[220:223], a[116:119], v[52:55]
  v_mfma_f32_16x16x32_bf16 v[56:59], v[224:227], a[116:119], v[56:59]
  v_mfma_f32_16x16x32_bf16 v[60:63], v[228:231], a[116:119], v[60:63]
  s_waitcnt vmcnt(7)
  v_mfma_f32_16x16x32_bf16 v[44:47], v[232:235], a[120:123], v[44:47]
  buffer_load_dwordx4 a[152:155], v1, s[8:11], s52 offen offset:0 sc1
  v_mfma_f32_16x16x32_bf16 v[48:51], v[236:239], a[120:123], v[48:51]
  v_mfma_f32_16x16x32_bf16 v[52:55], v[240:243], a[120:123], v[52:55]
  v_mfma_f32_16x16x32_bf16 v[56:59], v[244:247], a[120:123], v[56:59]
  v_mfma_f32_16x16x32_bf16 v[60:63], v[248:251], a[120:123], v[60:63]
  s_waitcnt vmcnt(7)
  v_mfma_f32_16x16x32_bf16 v[44:47], v[252:255], a[124:127], v[44:47]
  buffer_load_dwordx4 a[156:159], v1, s[8:11], s52 offen offset:1024 sc1
  v_mfma_f32_16x16x32_bf16 v[48:51], a[192:195], a[124:127], v[48:51]
  v_mfma_f32_16x16x32_bf16 v[52:55], a[196:199], a[124:127], v[52:55]
  v_mfma_f32_16x16x32_bf16 v[56:59], a[200:203], a[124:127], v[56:59]
  v_mfma_f32_16x16x32_bf16 v[60:63], a[204:207], a[124:127], v[60:63]
  s_waitcnt vmcnt(7)
  v_mfma_f32_16x16x32_bf16 v[44:47], a[208:211], a[128:131], v[44:47]
  buffer_load_dwordx4 a[160:163], v1, s[8:11], s52 offen offset:2048 sc1
  v_mfma_f32_16x16x32_bf16 v[48:51], a[212:215], a[128:131], v[48:51]
  v_mfma_f32_16x16x32_bf16 v[52:55], a[216:219], a[128:131], v[52:55]
  v_mfma_f32_16x16x32_bf16 v[56:59], a[220:223], a[128:131], v[56:59]
  v_mfma_f32_16x16x32_bf16 v[60:63], a[224:227], a[128:131], v[60:63]
  s_waitcnt vmcnt(7)
  v_mfma_f32_16x16x32_bf16 v[44:47], a[228:231], a[132:135], v[44:47]
  buffer_load_dwordx4 a[164:167], v1, s[8:11], s52 offen offset:3072 sc1
  v_mfma_f32_16x16x32_bf16 v[48:51], a[232:235], a[132:135], v[48:51]
  v_mfma_f32_16x16x32_bf16 v[52:55], a[236:239], a[132:135], v[52:55]
  v_mfma_f32_16x16x32_bf16 v[56:59], a[240:243], a[132:135], v[56:59]
  v_mfma_f32_16x16x32_bf16 v[60:63], a[244:247], a[132:135], v[60:63]
  s_waitcnt vmcnt(7)
  v_mfma_f32_16x16x32_bf16 v[44:47], a[248:251], a[136:139], v[44:47]
  s_add_u32 s54, s52, 4096
  buffer_load_dwordx4 a[168:171], v1, s[8:11], s54 offen offset:0 sc1
  v_mfma_f32_16x16x32_bf16 v[48:51], a[252:255], a[136:139], v[48:51]
  v_mfma_f32_16x16x32_bf16 v[52:55], v[160:163], a[136:139], v[52:55]
  v_mfma_f32_16x16x32_bf16 v[56:59], v[164:167], a[136:139], v[56:59]
  v_mfma_f32_16x16x32_bf16 v[60:63], v[168:171], a[136:139], v[60:63]
  s_waitcnt vmcnt(7)
  v_mfma_f32_16x16x32_bf16 v[44:47], v[172:175], a[140:143], v[44:47]
  buffer_load_dwordx4 a[172:175], v1, s[8:11], s54 offen offset:1024 sc1
  v_mfma_f32_16x16x32_bf16 v[48:51], v[176:179], a[140:143], v[48:51]
  v_mfma_f32_16x16x32_bf16 v[52:55], v[180:183], a[140:143], v[52:55]
  v_mfma_f32_16x16x32_bf16 v[56:59], v[184:187], a[140:143], v[56:59]
  v_mfma_f32_16x16x32_bf16 v[60:63], v[188:191], a[140:143], v[60:63]
  s_waitcnt vmcnt(7)
  v_mfma_f32_16x16x32_bf16 v[44:47], v[112:115], a[144:147], v[44:47]
  buffer_load_dwordx4 a[176:179], v1, s[8:11], s54 offen offset:2048 sc1
  v_mfma_f32_16x16x32_bf16 v[48:51], v[116:119], a[144:147], v[48:51]
  v_mfma_f32_16x16x32_bf16 v[52:55], v[120:123], a[144:147], v[52:55]
  s_add_u32 s70, s45, 12468224
  s_mov_b64 exec, 0xff
  buffer_load_dword v21, v5, s[8:11], s70 offen sc1
  s_mov_b64 exec, -1
  v_mfma_f32_16x16x32_bf16 v[56:59], v[124:127], a[144:147], v[56:59]
  v_mfma_f32_16x16x32_bf16 v[60:63], v[128:131], a[144:147], v[60:63]
  s_waitcnt vmcnt(8)
  v_mfma_f32_16x16x32_bf16 v[44:47], v[132:135], a[148:151], v[44:47]
  buffer_load_dwordx4 a[180:183], v1, s[8:11], s54 offen offset:3072 sc1
  v_mfma_f32_16x16x32_bf16 v[48:51], v[136:139], a[148:151], v[48:51]
  v_mfma_f32_16x16x32_bf16 v[52:55], v[140:143], a[148:151], v[52:55]
  v_mfma_f32_16x16x32_bf16 v[56:59], v[144:147], a[148:151], v[56:59]
  v_mfma_f32_16x16x32_bf16 v[60:63], v[148:151], a[148:151], v[60:63]
  s_waitcnt vmcnt(8)
  v_mfma_f32_16x16x32_bf16 v[64:67], v[192:195], a[152:155], 0
  s_add_u32 s54, s52, 8192
  buffer_load_dwordx4 a[184:187], v1, s[8:11], s54 offen offset:0 sc1
  v_mfma_f32_16x16x32_bf16 v[68:71], v[196:199], a[152:155], 0
  v_mfma_f32_16x16x32_bf16 v[72:75], v[200:203], a[152:155], 0
  v_mfma_f32_16x16x32_bf16 v[76:79], v[204:207], a[152:155], 0
  v_mfma_f32_16x16x32_bf16 v[80:83], v[208:211], a[152:155], 0
  s_waitcnt vmcnt(8)
  v_mfma_f32_16x16x32_bf16 v[64:67], v[212:215], a[156:159], v[64:67]
  buffer_load_dwordx4 a[188:191], v4, s[8:11], s54 offen offset:1024 sc1
  v_mfma_f32_16x16x32_bf16 v[68:71], v[216:219], a[156:159], v[68:71]
  v_mfma_f32_16x16x32_bf16 v[72:75], v[220:223], a[156:159], v[72:75]
  v_mfma_f32_16x16x32_bf16 v[76:79], v[224:227], a[156:159], v[76:79]
  v_mfma_f32_16x16x32_bf16 v[80:83], v[228:231], a[156:159], v[80:83]
  s_waitcnt vmcnt(8)
  v_mfma_f32_16x16x32_bf16 v[64:67], v[232:235], a[160:163], v[64:67]
  v_mfma_f32_16x16x32_bf16 v[68:71], v[236:239], a[160:163], v[68:71]
  v_mfma_f32_16x16x32_bf16 v[72:75], v[240:243], a[160:163], v[72:75]
  v_mfma_f32_16x16x32_bf16 v[76:79], v[244:247], a[160:163], v[76:79]
  v_mfma_f32_16x16x32_bf16 v[80:83], v[248:251], a[160:163], v[80:83]
  s_waitcnt vmcnt(7)
  v_mfma_f32_16x16x32_bf16 v[64:67], v[252:255], a[164:167], v[64:67]
  v_mfma_f32_16x16x32_bf16 v[68:71], a[192:195], a[164:167], v[68:71]
  s_waitcnt vmcnt(3)
  v_cmp_ne_u32 vcc, v20, v21
  s_nop 3
  s_and_b64 vcc, vcc, 0xff
  s_cbranch_vccnz PHL_SPIN_2
PHL_OK_2:
  s_add_u32 s54, s50, 8192
  buffer_load_dwordx4 a[72:75], v1, s[8:11], s54 offen offset:2048 sc1
  v_mfma_f32_16x16x32_bf16 v[72:75], a[196:199], a[164:167], v[72:75]
  buffer_load_dwordx4 a[76:79], v1, s[8:11], s54 offen offset:3072 sc1
  v_mfma_f32_16x16x32_bf16 v[76:79], a[200:203], a[164:167], v[76:79]
  v_mfma_f32_16x16x32_bf16 v[80:83], a[204:207], a[164:167], v[80:83]
  v_mfma_f32_16x16x32_bf16 v[64:67], a[208:211], a[168:171], v[64:67]
  s_add_u32 s54, s50, 12288
  buffer_load_dwordx4 a[80:83], v1, s[8:11], s54 offen offset:0 sc1
  v_mfma_f32_16x16x32_bf16 v[68:71], a[212:215], a[168:171], v[68:71]
  v_mfma_f32_16x16x32_bf16 v[72:75], a[216:219], a[168:171], v[72:75]
  v_mfma_f32_16x16x32_bf16 v[76:79], a[220:223], a[168:171], v[76:79]
  v_mfma_f32_16x16x32_bf16 v[80:83], a[224:227], a[168:171], v[80:83]
  v_mfma_f32_16x16x32_bf16 v[64:67], a[228:231], a[172:175], v[64:67]
  buffer_load_dwordx4 a[84:87], v4, s[8:11], s54 offen offset:1024 sc1
  v_mfma_f32_16x16x32_bf16 v[68:71], a[232:235], a[172:175], v[68:71]
  v_mfma_f32_16x16x32_bf16 v[72:75], a[236:239], a[172:175], v[72:75]
  v_mfma_f32_16x16x32_bf16 v[76:79], a[240:243], a[172:175], v[76:79]
  v_mfma_f32_16x16x32_bf16 v[80:83], a[244:247], a[172:175], v[80:83]
  v_mfma_f32_16x16x32_bf16 v[64:67], a[248:251], a[176:179], v[64:67]
  s_add_u32 s54, s51, 8192
  buffer_load_dwordx4 a[88:91], v1, s[8:11], s54 offen offset:2048 sc1
  v_mfma_f32_16x16x32_bf16 v[68:71], a[252:255], a[176:179], v[68:71]
  v_mfma_f32_16x16x32_bf16 v[72:75], v[160:163], a[176:179], v[72:75]
  v_mfma_f32_16x16x32_bf16 v[76:79], v[164:167], a[176:179], v[76:79]
  v_mfma_f32_16x16x32_bf16 v[80:83], v[168:171], a[176:179], v[80:83]
  s_waitcnt vmcnt(7)
  v_mfma_f32_16x16x32_bf16 v[64:67], v[172:175], a[180:183], v[64:67]
  buffer_load_dwordx4 a[92:95], v1, s[8:11], s54 offen offset:3072 sc1
  v_mfma_f32_16x16x32_bf16 v[68:71], v[176:179], a[180:183], v[68:71]
  v_mfma_f32_16x16x32_bf16 v[72:75], v[180:183], a[180:183], v[72:75]
  v_mfma_f32_16x16x32_bf16 v[76:79], v[184:187], a[180:183], v[76:79]
  v_mfma_f32_16x16x32_bf16 v[80:83], v[188:191], a[180:183], v[80:83]
  s_waitcnt vmcnt(7)
  v_mfma_f32_16x16x32_bf16 v[64:67], v[112:115], a[184:187], v[64:67]
  s_add_u32 s54, s51, 12288
  buffer_load_dwordx4 a[96:99], v1, s[8:11], s54 offen offset:0 sc1
  v_mfma_f32_16x16x32_bf16 v[68:71], v[116:119], a[184:187], v[68:71]
  v_mfma_f32_16x16x32_bf16 v[72:75], v[120:123], a[184:187], v[72:75]
  v_mfma_f32_16x16x32_bf16 v[76:79], v[124:127], a[184:187], v[76:79]
  v_mfma_f32_16x16x32_bf16 v[80:83], v[128:131], a[184:187], v[80:83]
  s_waitcnt vmcnt(7)
  v_mfma_f32_16x16x32_bf16 v[64:67], v[132:135], a[188:191], v[64:67]
  buffer_load_dwordx4 a[100:103], v4, s[8:11], s54 offen offset:1024 sc1
  v_mfma_f32_16x16x32_bf16 v[68:71], v[136:139], a[188:191], v[68:71]
  v_mfma_f32_16x16x32_bf16 v[72:75], v[140:143], a[188:191], v[72:75]
  v_mfma_f32_16x16x32_bf16 v[76:79], v[144:147], a[188:191], v[76:79]
  v_mfma_f32_16x16x32_bf16 v[80:83], v[148:151], a[188:191], v[80:83]
  s_waitcnt vmcnt(7)
  v_mfma_f32_16x16x32_bf16 v[24:27], v[152:155], a[72:75], v[24:27]
  s_add_u32 s54, s52, 8192
  buffer_load_dwordx4 a[104:107], v1, s[8:11], s54 offen offset:2048 sc1
  v_mfma_f32_16x16x32_bf16 v[28:31], v[156:159], a[72:75], v[28:31]
  v_mfma_f32_16x16x32_bf16 v[32:35], a[0:3], a[72:75], v[32:35]
  v_mfma_f32_16x16x32_bf16 v[36:39], a[4:7], a[72:75], v[36:39]
  v_mfma_f32_16x16x32_bf16 v[40:43], a[8:11], a[72:75], v[40:43]
  s_waitcnt vmcnt(7)
  v_mfma_f32_16x16x32_bf16 v[24:27], a[12:15], a[76:79], v[24:27]
  buffer_load_dwordx4 a[108:111], v1, s[8:11], s54 offen offset:3072 sc1
  v_mfma_f32_16x16x32_bf16 v[28:31], a[16:19], a[76:79], v[28:31]
  v_mfma_f32_16x16x32_bf16 v[32:35], a[20:23], a[76:79], v[32:35]
  v_mfma_f32_16x16x32_bf16 v[36:39], a[24:27], a[76:79], v[36:39]
  v_mfma_f32_16x16x32_bf16 v[40:43], a[28:31], a[76:79], v[40:43]
  s_waitcnt vmcnt(7)
  v_mfma_f32_16x16x32_bf16 v[24:27], a[32:35], a[80:83], v[24:27]
  s_add_u32 s54, s52, 12288
  buffer_load_dwordx4 a[112:115], v1, s[8:11], s54 offen offset:0 sc1
  v_mfma_f32_16x16x32_bf16 v[28:31], a[36:39], a[80:83], v[28:31]
  v_mfma_f32_16x16x32_bf16 v[32:35], a[40:43], a[80:83], v[32:35]
  v_mfma_f32_16x16x32_bf16 v[36:39], a[44:47], a[80:83], v[36:39]
  v_mfma_f32_16x16x32_bf16 v[40:43], a[48:51], a[80:83], v[40:43]
  s_waitcnt vmcnt(7)
  v_mfma_f32_16x16x32_bf16 v[24:27], a[52:55], a[84:87], v[24:27]
  buffer_load_dwordx4 a[116:119], v4, s[8:11], s54 offen offset:1024 sc1
  v_mfma_f32_16x16x32_bf16 v[28:31], a[56:59], a[84:87], v[28:31]
  v_mfma_f32_16x16x32_bf16 v[32:35], a[60:63], a[84:87], v[32:35]
  v_mfma_f32_16x16x32_bf16 v[36:39], a[64:67], a[84:87], v[36:39]
  v_mfma_f32_16x16x32_bf16 v[40:43], a[68:71], a[84:87], v[40:43]
  s_waitcnt vmcnt(7)
  v_mfma_f32_16x16x32_bf16 v[44:47], v[152:155], a[88:91], v[44:47]
  buffer_load_dwordx4 a[120:123], v1, s[8:11], s53 offen offset:0 sc1
  v_mfma_f32_16x16x32_bf16 v[48:51], v[156:159], a[88:91], v[48:51]
  v_mfma_f32_16x16x32_bf16 v[52:55], a[0:3], a[88:91], v[52:55]
  ds_write_b128 v106, v[24:27] offset:0
  v_mfma_f32_16x16x32_bf16 v[56:59], a[4:7], a[88:91], v[56:59]
  v_mfma_f32_16x16x32_bf16 v[60:63], a[8:11], a[88:91], v[60:63]
  ds_write_b128 v106, v[28:31] offset:1024
  s_waitcnt vmcnt(7)
  v_mfma_f32_16x16x32_bf16 v[44:47], a[12:15], a[92:95], v[44:47]
  buffer_load_dwordx4 a[124:127], v1, s[8:11], s53 offen offset:1024 sc1
  v_mfma_f32_16x16x32_bf16 v[48:51], a[16:19], a[92:95], v[48:51]
  ds_write_b128 v106, v[32:35] offset:2048
  v_mfma_f32_16x16x32_bf16 v[52:55], a[20:23], a[92:95], v[52:55]
  v_mfma_f32_16x16x32_bf16 v[56:59], a[24:27], a[92:95], v[56:59]
  ds_write_b128 v106, v[36:39] offset:3072
  v_mfma_f32_16x16x32_bf16 v[60:63], a[28:31], a[92:95], v[60:63]
  s_waitcnt vmcnt(7)
  v_mfma_f32_16x16x32_bf16 v[44:47], a[32:35], a[96:99], v[44:47]
  buffer_load_dwordx4 a[128:131], v1, s[8:11], s53 offen offset:2048 sc1
  v_mfma_f32_16x16x32_bf16 v[48:51], a[36:39], a[96:99], v[48:51]
  ds_write_b128 v106, v[40:43] offset:4096
  v_mfma_f32_16x16x32_bf16 v[52:55], a[40:43], a[96:99], v[52:55]
  v_mfma_f32_16x16x32_bf16 v[56:59], a[44:47], a[96:99], v[56:59]
  v_mfma_f32_16x16x32_bf16 v[60:63], a[48:51], a[96:99], v[60:63]
  s_waitcnt vmcnt(7)
  v_mfma_f32_16x16x32_bf16 v[44:47], a[52:55], a[100:103], v[44:47]
  buffer_load_dwordx4 a[132:135], v1, s[8:11], s53 offen offset:3072 sc1
  v_mfma_f32_16x16x32_bf16 v[48:51], a[56:59], a[100:103], v[48:51]
  v_mfma_f32_16x16x32_bf16 v[52:55], a[60:63], a[100:103], v[52:55]
  v_mfma_f32_16x16x32_bf16 v[56:59], a[64:67], a[100:103], v[56:59]
  v_mfma_f32_16x16x32_bf16 v[60:63], a[68:71], a[100:103], v[60:63]
  s_waitcnt vmcnt(7)
  v_mfma_f32_16x16x32_bf16 v[64:67], v[152:155], a[104:107], v[64:67]
  s_add_u32 s54, s53, 4096
  buffer_load_dwordx4 a[136:139], v1, s[8:11], s54 offen offset:0 sc1
  v_mfma_f32_16x16x32_bf16 v[68:71], v[156:159], a[104:107], v[68:71]
  v_mfma_f32_16x16x32_bf16 v[72:75], a[0:3], a[104:107], v[72:75]
  ds_write_b128 v107, v[44:47] offset:0
  v_mfma_f32_16x16x32_bf16 v[76:79], a[4:7], a[104:107], v[76:79]
  v_mfma_f32_16x16x32_bf16 v[80:83], a[8:11], a[104:107], v[80:83]
  ds_write_b128 v107, v[48:51] offset:1024
  s_waitcnt vmcnt(7)
  v_mfma_f32_16x16x32_bf16 v[64:67], a[12:15], a[108:111], v[64:67]
  buffer_load_dwordx4 a[140:143], v1, s[8:11], s54 offen offset:1024 sc1
  v_mfma_f32_16x16x32_bf16 v[68:71], a[16:19], a[108:111], v[68:71]
  ds_write_b128 v107, v[52:55] offset:2048
  v_mfma_f32_16x16x32_bf16 v[72:75], a[20:23], a[108:111], v[72:75]
  v_mfma_f32_16x16x32_bf16 v[76:79], a[24:27], a[108:111], v[76:79]
  ds_write_b128 v107, v[56:59] offset:3072
  v_mfma_f32_16x16x32_bf16 v[80:83], a[28:31], a[108:111], v[80:83]
  s_waitcnt vmcnt(7)
  v_mfma_f32_16x16x32_bf16 v[64:67], a[32:35], a[112:115], v[64:67]
  buffer_load_dwordx4 a[144:147], v1, s[8:11], s54 offen offset:2048 sc1
  v_mfma_f32_16x16x32_bf16 v[68:71], a[36:39], a[112:115], v[68:71]
  ds_write_b128 v107, v[60:63] offset:4096
  v_mfma_f32_16x16x32_bf16 v[72:75], a[40:43], a[112:115], v[72:75]
  v_mfma_f32_16x16x32_bf16 v[76:79], a[44:47], a[112:115], v[76:79]
  v_mfma_f32_16x16x32_bf16 v[80:83], a[48:51], a[112:115], v[80:83]
  s_waitcnt vmcnt(7)
  v_mfma_f32_16x16x32_bf16 v[64:67], a[52:55], a[116:119], v[64:67]
  buffer_load_dwordx4 a[148:151], v1, s[8:11], s54 offen offset:3072 sc1
  v_mfma_f32_16x16x32_bf16 v[68:71], a[56:59], a[116:119], v[68:71]
  v_mfma_f32_16x16x32_bf16 v[72:75], a[60:63], a[116:119], v[72:75]
  v_mfma_f32_16x16x32_bf16 v[76:79], a[64:67], a[116:119], v[76:79]
  v_mfma_f32_16x16x32_bf16 v[80:83], a[68:71], a[116:119], v[80:83]
  s_waitcnt vmcnt(7)
  v_mfma_f32_16x16x32_bf16 v[24:27], v[192:195], a[120:123], 0
  s_add_u32 s54, s53, 8192
  buffer_load_dwordx4 a[152:155], v1, s[8:11], s54 offen offset:0 sc1
  v_mfma_f32_16x16x32_bf16 v[28:31], v[196:199], a[120:123], 0
  v_mfma_f32_16x16x32_bf16 v[32:35], v[200:203], a[120:123], 0
  ds_write_b128 v108, v[64:67] offset:0
  v_mfma_f32_16x16x32_bf16 v[36:39], v[204:207], a[120:123], 0
  v_mfma_f32_16x16x32_bf16 v[40:43], v[208:211], a[120:123], 0
  ds_write_b128 v108, v[68:71] offset:1024
  s_waitcnt vmcnt(7)
  v_mfma_f32_16x16x32_bf16 v[24:27], v[212:215], a[124:127], v[24:27]
  buffer_load_dwordx4 a[156:159], v4, s[8:11], s54 offen offset:1024 sc1
  v_mfma_f32_16x16x32_bf16 v[28:31], v[216:219], a[124:127], v[28:31]
  ds_write_b128 v108, v[72:75] offset:2048
  v_mfma_f32_16x16x32_bf16 v[32:35], v[220:223], a[124:127], v[32:35]
  v_mfma_f32_16x16x32_bf16 v[36:39], v[224:227], a[124:127], v[36:39]
  ds_write_b128 v108, v[76:79] offset:3072
  v_mfma_f32_16x16x32_bf16 v[40:43], v[228:231], a[124:127], v[40:43]
  s_waitcnt vmcnt(7)
  v_mfma_f32_16x16x32_bf16 v[24:27], v[232:235], a[128:131], v[24:27]
  buffer_load_dwordx4 a[160:163], v1, s[8:11], s54 offen offset:2048 sc1
  v_mfma_f32_16x16x32_bf16 v[28:31], v[236:239], a[128:131], v[28:31]
  ds_write_b128 v108, v[80:83] offset:4096
  v_mfma_f32_16x16x32_bf16 v[32:35], v[240:243], a[128:131], v[32:35]
  v_mfma_f32_16x16x32_bf16 v[36:39], v[244:247], a[128:131], v[36:39]
  v_mfma_f32_16x16x32_bf16 v[40:43], v[248:251], a[128:131], v[40:43]
  s_waitcnt vmcnt(7)
  v_mfma_f32_16x16x32_bf16 v[24:27], v[252:255], a[132:135], v[24:27]
  buffer_load_dwordx4 a[164:167], v1, s[8:11], s54 offen offset:3072 sc1
  v_mfma_f32_16x16x32_bf16 v[28:31], a[192:195], a[132:135], v[28:31]
  v_mfma_f32_16x16x32_bf16 v[32:35], a[196:199], a[132:135], v[32:35]
  v_mfma_f32_16x16x32_bf16 v[36:39], a[200:203], a[132:135], v[36:39]
  v_mfma_f32_16x16x32_bf16 v[40:43], a[204:207], a[132:135], v[40:43]
  s_waitcnt vmcnt(7)
  v_mfma_f32_16x16x32_bf16 v[24:27], a[208:211], a[136:139], v[24:27]
  s_add_u32 s54, s53, 12288
  buffer_load_dwordx4 a[168:171], v1, s[8:11], s54 offen offset:0 sc1
  v_mfma_f32_16x16x32_bf16 v[28:31], a[212:215], a[136:139], v[28:31]
  v_mfma_f32_16x16x32_bf16 v[32:35], a[216:219], a[136:139], v[32:35]
  s_waitcnt lgkmcnt(0)
  s_barrier
  v_mfma_f32_16x16x32_bf16 v[36:39], a[220:223], a[136:139], v[36:39]
  ds_read_b128 v[44:47], v109 offset:0
  ds_read_b128 v[48:51], v109 offset:1024
  v_mfma_f32_16x16x32_bf16 v[40:43], a[224:227], a[136:139], v[40:43]
  ds_read_b128 v[52:55], v109 offset:2048
  ds_read_b128 v[56:59], v109 offset:3072
  s_waitcnt vmcnt(7)
  v_mfma_f32_16x16x32_bf16 v[24:27], a[228:231], a[140:143], v[24:27]
  buffer_load_dwordx4 a[172:175], v4, s[8:11], s54 offen offset:1024 sc1
  v_mfma_f32_16x16x32_bf16 v[28:31], a[232:235], a[140:143], v[28:31]
  ds_read_b128 v[60:63], v109 offset:4096
  ds_read_b128 v[64:67], v109 offset:5120
  v_mfma_f32_16x16x32_bf16 v[32:35], a[236:239], a[140:143], v[32:35]
  ds_read_b128 v[68:71], v109 offset:6144
  ds_read_b128 v[72:75], v109 offset:7168
  v_mfma_f32_16x16x32_bf16 v[36:39], a[240:243], a[140:143], v[36:39]
  ds_read_b128 v[76:79], v109 offset:8192
  ds_read_b128 v[80:83], v109 offset:9216
  v_mfma_f32_16x16x32_bf16 v[40:43], a[244:247], a[140:143], v[40:43]
  s_waitcnt vmcnt(7)
  v_mfma_f32_16x16x32_bf16 v[24:27], a[248:251], a[144:147], v[24:27]
  v_mfma_f32_16x16x32_bf16 v[28:31], a[252:255], a[144:147], v[28:31]
  v_mfma_f32_16x16x32_bf16 v[32:35], v[160:163], a[144:147], v[32:35]
  v_mfma_f32_16x16x32_bf16 v[36:39], v[164:167], a[144:147], v[36:39]
  v_mfma_f32_16x16x32_bf16 v[40:43], v[168:171], a[144:147], v[40:43]
  s_waitcnt vmcnt(6)
  v_mfma_f32_16x16x32_bf16 v[24:27], v[172:175], a[148:151], v[24:27]
  v_mfma_f32_16x16x32_bf16 v[28:31], v[176:179], a[148:151], v[28:31]
  s_waitcnt lgkmcnt(9)
  v_add_f32 v84, v84, v44
  v_add_f32 v85, v85, v45
  v_mfma_f32_16x16x32_bf16 v[32:35], v[180:183], a[148:151], v[32:35]
  v_add_f32 v86, v86, v46
  v_add_f32 v87, v87, v47
  v_mfma_f32_16x16x32_bf16 v[36:39], v[184:187], a[148:151], v[36:39]
  s_waitcnt lgkmcnt(8)
  v_add_f32 v88, v88, v48
  v_add_f32 v89, v89, v49
  v_mfma_f32_16x16x32_bf16 v[40:43], v[188:191], a[148:151], v[40:43]
  v_add_f32 v90, v90, v50
  v_add_f32 v91, v91, v51
  s_waitcnt vmcnt(5)
  v_mfma_f32_16x16x32_bf16 v[24:27], v[112:115], a[152:155], v[24:27]
  s_waitcnt lgkmcnt(7)
  v_add_f32 v92, v92, v52
  v_add_f32 v93, v93, v53
  v_mfma_f32_16x16x32_bf16 v[28:31], v[116:119], a[152:155], v[28:31]
  v_add_f32 v94, v94, v54
  v_add_f32 v95, v95, v55
  v_mfma_f32_16x16x32_bf16 v[32:35], v[120:123], a[152:155], v[32:35]
  s_waitcnt lgkmcnt(6)
  v_add_f32 v96, v96, v56
  v_add_f32 v97, v97, v57
  v_mfma_f32_16x16x32_bf16 v[36:39], v[124:127], a[152:155], v[36:39]
  v_add_f32 v98, v98, v58
  v_add_f32 v99, v99, v59
  v_mfma_f32_16x16x32_bf16 v[40:43], v[128:131], a[152:155], v[40:43]
  s_waitcnt lgkmcnt(5)
  v_add_f32 v100, v100, v60
  v_add_f32 v101, v101, v61
  s_waitcnt vmcnt(4)
  v_mfma_f32_16x16x32_bf16 v[24:27], v[132:135], a[156:159], v[24:27]
  v_add_f32 v102, v102, v62
  v_add_f32 v103, v103, v63
  v_mfma_f32_16x16x32_bf16 v[28:31], v[136:139], a[156:159], v[28:31]
  ds_read_b128 v[44:47], v109 offset:10240
  ds_read_b128 v[48:51], v109 offset:11264
  v_mfma_f32_16x16x32_bf16 v[32:35], v[140:143], a[156:159], v[32:35]
  ds_read_b128 v[52:55], v109 offset:12288
  ds_read_b128 v[56:59], v109 offset:13312
  v_mfma_f32_16x16x32_bf16 v[36:39], v[144:147], a[156:159], v[36:39]
  ds_read_b128 v[60:63], v109 offset:14336
  s_waitcnt lgkmcnt(9)
  v_add_f32 v84, v84, v64
  v_mfma_f32_16x16x32_bf16 v[40:43], v[148:151], a[156:159], v[40:43]
  v_add_f32 v85, v85, v65
  v_add_f32 v86, v86, v66
  s_waitcnt vmcnt(3)
  v_mfma_f32_16x16x32_bf16 v[24:27], v[152:155], a[160:163], v[24:27]
  v_add_f32 v87, v87, v67
  s_waitcnt lgkmcnt(8)
  v_add_f32 v88, v88, v68
  v_mfma_f32_16x16x32_bf16 v[28:31], v[156:159], a[160:163], v[28:31]
  v_add_f32 v89, v89, v69
  v_add_f32 v90, v90, v70
  v_mfma_f32_16x16x32_bf16 v[32:35], a[0:3], a[160:163], v[32:35]
  v_add_f32 v91, v91, v71
  s_waitcnt lgkmcnt(7)
  v_add_f32 v92, v92, v72
  v_mfma_f32_16x16x32_bf16 v[36:39], a[4:7], a[160:163], v[36:39]
  v_add_f32 v93, v93, v73
  v_add_f32 v94, v94, v74
  v_mfma_f32_16x16x32_bf16 v[40:43], a[8:11], a[160:163], v[40:43]
  v_add_f32 v95, v95, v75
  s_waitcnt lgkmcnt(6)
  v_add_f32 v96, v96, v76
  s_waitcnt vmcnt(2)
  v_mfma_f32_16x16x32_bf16 v[24:27], a[12:15], a[164:167], v[24:27]
  v_add_f32 v97, v97, v77
  v_add_f32 v98, v98, v78
  v_mfma_f32_16x16x32_bf16 v[28:31], a[16:19], a[164:167], v[28:31]
  v_add_f32 v99, v99, v79
  s_waitcnt lgkmcnt(5)
  v_add_f32 v100, v100, v80
  v_mfma_f32_16x16x32_bf16 v[32:35], a[20:23], a[164:167], v[32:35]
  v_add_f32 v101, v101, v81
  v_add_f32 v102, v102, v82
  v_mfma_f32_16x16x32_bf16 v[36:39], a[24:27], a[164:167], v[36:39]
  v_add_f32 v103, v103, v83
  v_mfma_f32_16x16x32_bf16 v[40:43], a[28:31], a[164:167], v[40:43]
  s_waitcnt vmcnt(1)
  v_mfma_f32_16x16x32_bf16 v[24:27], a[32:35], a[168:171], v[24:27]
  v_mfma_f32_16x16x32_bf16 v[28:31], a[36:39], a[168:171], v[28:31]
  v_mfma_f32_16x16x32_bf16 v[32:35], a[40:43], a[168:171], v[32:35]
  v_mfma_f32_16x16x32_bf16 v[36:39], a[44:47], a[168:171], v[36:39]
  v_mfma_f32_16x16x32_bf16 v[40:43], a[48:51], a[168:171], v[40:43]
  s_waitcnt vmcnt(0)
  v_mfma_f32_16x16x32_bf16 v[24:27], a[52:55], a[172:175], v[24:27]
  s_waitcnt lgkmcnt(4)
  v_add_f32 v84, v84, v44
  v_add_f32 v85, v85, v45
  v_mfma_f32_16x16x32_bf16 v[28:31], a[56:59], a[172:175], v[28:31]
  v_add_f32 v86, v86, v46
  v_add_f32 v87, v87, v47
  v_mfma_f32_16x16x32_bf16 v[32:35], a[60:63], a[172:175], v[32:35]
  s_waitcnt lgkmcnt(3)
  v_add_f32 v88, v88, v48
  v_add_f32 v89, v89, v49
  v_mfma_f32_16x16x32_bf16 v[36:39], a[64:67], a[172:175], v[36:39]
  v_add_f32 v90, v90, v50
  v_add_f32 v91, v91, v51
  v_mfma_f32_16x16x32_bf16 v[40:43], a[68:71], a[172:175], v[40:43]
  s_waitcnt lgkmcnt(2)
  v_add_f32 v92, v92, v52
  v_add_f32 v93, v93, v53
  v_pk_add_f32 v[94:95], v[94:95], v[54:55]
  s_waitcnt lgkmcnt(1)
  v_pk_add_f32 v[96:97], v[96:97], v[56:57]
  v_pk_add_f32 v[98:99], v[98:99], v[58:59]
  s_waitcnt lgkmcnt(0)
  v_pk_add_f32 v[100:101], v[100:101], v[60:61]
  v_pk_add_f32 v[102:103], v[102:103], v[62:63]
  v_pk_add_f32 v[84:85], v[84:85], v[24:25]
  v_pk_add_f32 v[86:87], v[86:87], v[26:27]
  v_pk_add_f32 v[88:89], v[88:89], v[28:29]
  v_pk_add_f32 v[90:91], v[90:91], v[30:31]
  v_pk_add_f32 v[92:93], v[92:93], v[32:33]
  v_pk_add_f32 v[94:95], v[94:95], v[34:35]
  v_pk_add_f32 v[96:97], v[96:97], v[36:37]
  v_pk_add_f32 v[98:99], v[98:99], v[38:39]
  v_pk_add_f32 v[100:101], v[100:101], v[40:41]
  v_pk_add_f32 v[102:103], v[102:103], v[42:43]
  v_cvt_pk_bf16_f32 v10, v84, v85
  v_cvt_pk_bf16_f32 v11, v86, v87
  v_cvt_pk_bf16_f32 v12, v88, v89
  v_cvt_pk_bf16_f32 v13, v90, v91
  v_cvt_pk_bf16_f32 v14, v92, v93
  v_cvt_pk_bf16_f32 v15, v94, v95
  v_cvt_pk_bf16_f32 v16, v96, v97
  v_cvt_pk_bf16_f32 v17, v98, v99
  v_cvt_pk_bf16_f32 v18, v100, v101
  v_cvt_pk_bf16_f32 v19, v102, v103
  v_mov_b32 v44, v10
  v_mov_b32 v45, v11
  v_mov_b32 v46, v12
  v_mov_b32 v47, v13
  v_mov_b32 v48, v14
  v_mov_b32 v49, v15
  v_mov_b32 v50, v16
  v_mov_b32 v51, v17
  v_permlane32_swap_b32 v44, v46
  v_permlane32_swap_b32 v45, v47
  v_permlane32_swap_b32 v48, v50
  v_permlane32_swap_b32 v49, v51
  v_and_b32 v64, 15, v0
  v_mul_u32_u24 v64, 1280, v64
  v_bfe_u32 v65, v0, 4, 1
  v_lshl_add_u32 v64, v65, 4, v64
  v_lshrrev_b32 v65, 5, v0
  v_lshl_add_u32 v7, v65, 5, v64
  v_lshl_add_u32 v6, v65, 3, v64
  buffer_store_dwordx4 v[44:47], v7, s[4:7], s62 offen
  buffer_store_dwordx4 v[48:51], v7, s[4:7], s62 offen offset:64
  buffer_store_dwordx2 v[18:19], v6, s[4:7], s62 offen offset:128
M_END:
  s_endpgm
PW1_SPIN:
  s_mov_b32 s63, 0x4000
  s_mov_b64 exec, 0x1f
PW1_AGAIN:
  s_sleep 1
  buffer_load_dword v21, v24, s[8:11], s70 offen sc1
  s_waitcnt vmcnt(0)
  v_cmp_ne_u32 vcc, v20, v21
  s_sub_u32 s63, s63, 1
  s_cselect_b64 s[64:65], 0, -1
  s_nop 1
  s_and_b64 vcc, vcc, s[64:65]
  s_cbranch_vccnz PW1_AGAIN
  s_mov_b64 exec, -1
  s_branch PW1_OK
PXI_SPIN:
  s_mov_b32 s63, 0x4000
PXI_AGAIN:
  s_sleep 1
  buffer_load_dwordx4 v[24:27], v8, s[8:11], s70 offen offset:0 sc1
  buffer_load_dwordx4 v[28:31], v8, s[8:11], s70 offen offset:512 sc1
  buffer_load_dwordx4 v[32:35], v8, s[8:11], s70 offen offset:1024 sc1
  buffer_load_dwordx4 v[36:39], v8, s[8:11], s70 offen offset:1536 sc1
  s_waitcnt vmcnt(1)
  v_max3_u32 v40, v26, v30, v34
  v_min3_u32 v41, v26, v30, v34
  s_waitcnt vmcnt(0)
  v_max_u32 v40, v40, v38
  v_min_u32 v41, v41, v38
  v_cmp_ne_u32 vcc, v20, v40
  v_cmp_ne_u32 s[64:65], v20, v41
  s_nop 3
  s_or_b64 vcc, vcc, s[64:65]
  s_sub_u32 s63, s63, 1
  s_cselect_b64 s[64:65], 0, -1
  s_and_b64 vcc, vcc, s[64:65]
  s_cbranch_vccnz PXI_AGAIN
  s_branch PXI_OK
RL_SPIN:
  s_mov_b32 s63, 0x4000
RL_AGAIN:
  s_sleep 4
  buffer_load_dword v35, v34, s[8:11], s70 offen sc1
  s_waitcnt vmcnt(0)
  v_cmp_ne_u32 vcc, s19, v35
  s_sub_u32 s63, s63, 1
  s_cselect_b64 s[64:65], 0, -1
  s_nop 1
  s_and_b64 vcc, vcc, s[64:65]
  s_cbranch_vccnz RL_AGAIN
  s_branch RL_OK
EP_SET:
  s_add_u32 s91, s19, 7
  v_mov_b32 v35, s91
  s_mov_b32 s91, 12582912
  s_mov_b64 exec, 1
  buffer_store_dword v35, v1, s[8:11], s91 offen sc1
  s_mov_b64 exec, -1
  s_branch EP_BACK
P1_RETRY:
  s_mov_b32 s63, 4096
P1_AGAIN:
  s_mov_b32 s3, s39
  buffer_load_dwordx4 a[100:103], v29, s[8:11], s3 offen sc1
  s_addk_i32 s3, 4096
  buffer_load_dwordx4 a[104:107], v29, s[8:11], s3 offen sc1
  s_addk_i32 s3, 4096
  buffer_load_dwordx4 a[108:111], v29, s[8:11], s3 offen sc1
  s_addk_i32 s3, 4096
  buffer_load_dwordx4 a[112:115], v29, s[8:11], s3 offen sc1
  s_addk_i32 s3, 4096
  buffer_load_dwordx4 a[116:119], v29, s[8:11], s3 offen sc1
  s_addk_i32 s3, 4096
  buffer_load_dwordx4 a[120:123], v29, s[8:11], s3 offen sc1
  s_addk_i32 s3, 4096
  buffer_load_dwordx4 a[124:127], v29, s[8:11], s3 offen sc1
  s_addk_i32 s3, 4096
  buffer_load_dwordx4 a[128:131], v29, s[8:11], s3 offen sc1
  s_addk_i32 s3, 4096
  buffer_load_dwordx4 a[132:135], v29, s[8:11], s3 offen sc1
  s_addk_i32 s3, 4096
  buffer_load_dwordx4 a[136:139], v29, s[8:11], s3 offen sc1
  s_addk_i32 s3, 4096
  buffer_load_dwordx4 a[140:143], v29, s[8:11], s3 offen sc1
  s_addk_i32 s3, 4096
  buffer_load_dwordx4 a[144:147], v29, s[8:11], s3 offen sc1
  s_addk_i32 s3, 4096
  buffer_load_dwordx4 a[148:151], v29, s[8:11], s3 offen sc1
  s_addk_i32 s3, 4096
  buffer_load_dwordx4 a[152:155], v29, s[8:11], s3 offen sc1
  s_addk_i32 s3, 4096
  buffer_load_dwordx4 a[156:159], v29, s[8:11], s3 offen sc1
  s_addk_i32 s3, 4096
  buffer_load_dwordx4 a[160:163], v29, s[8:11], s3 offen sc1
  s_addk_i32 s3, 4096
  s_waitcnt vmcnt(15)
  v_mfma_f32_32x32x16_bf16 v[40:55], v[36:39], a[100:103], 0
  s_waitcnt vmcnt(14)
  v_mfma_f32_32x32x16_bf16 v[40:55], v[36:39], a[104:107], v[40:55]
  s_waitcnt vmcnt(13)
  v_mfma_f32_32x32x16_bf16 v[40:55], v[36:39], a[108:111], v[40:55]
  s_waitcnt vmcnt(12)
  v_mfma_f32_32x32x16_bf16 v[40:55], v[36:39], a[112:115], v[40:55]
  s_waitcnt vmcnt(11)
  v_mfma_f32_32x32x16_bf16 v[40:55], v[36:39], a[116:119], v[40:55]
  s_waitcnt vmcnt(10)
  v_mfma_f32_32x32x16_bf16 v[40:55], v[36:39], a[120:123], v[40:55]
  s_waitcnt vmcnt(9)
  v_mfma_f32_32x32x16_bf16 v[40:55], v[36:39], a[124:127], v[40:55]
  s_waitcnt vmcnt(8)
  v_mfma_f32_32x32x16_bf16 v[40:55], v[36:39], a[128:131], v[40:55]
  s_waitcnt vmcnt(7)
  v_mfma_f32_32x32x16_bf16 v[40:55], v[36:39], a[132:135], v[40:55]
  s_waitcnt vmcnt(6)
  v_mfma_f32_32x32x16_bf16 v[40:55], v[36:39], a[136:139], v[40:55]
  s_waitcnt vmcnt(5)
  v_mfma_f32_32x32x16_bf16 v[40:55], v[36:39], a[140:143], v[40:55]
  s_waitcnt vmcnt(4)
  v_mfma_f32_32x32x16_bf16 v[40:55], v[36:39], a[144:147], v[40:55]
  s_waitcnt vmcnt(3)
  v_mfma_f32_32x32x16_bf16 v[40:55], v[36:39], a[148:151], v[40:55]
  s_waitcnt vmcnt(2)
  v_mfma_f32_32x32x16_bf16 v[40:55], v[36:39], a[152:155], v[40:55]
  s_waitcnt vmcnt(1)
  v_mfma_f32_32x32x16_bf16 v[40:55], v[36:39], a[156:159], v[40:55]
  s_waitcnt vmcnt(0)
  v_mfma_f32_32x32x16_bf16 v[40:55], v[36:39], a[160:163], v[40:55]
  s_nop 11
  v_cmp_u_f32 vcc, v40, v40
  s_sub_u32 s63, s63, 1
  s_cselect_b64 s[64:65], 0, -1
  s_nop 1
  s_and_b64 vcc, vcc, s[64:65]
  s_cbranch_vccnz P1_AGAIN
  s_branch P1_SUMMED
HS0:
  buffer_store_dword v20, v1, s[8:11], s3 offen sc1
  s_branch HB0
PO_SPIN:
  s_mov_b32 s63, 0x4000
  s_mov_b64 exec, 0xff
PO_AGAIN:
  s_sleep 1
  buffer_load_dword v21, v5, s[8:11], s70 offen sc1
  s_waitcnt vmcnt(0)
  v_cmp_ne_u32 vcc, v20, v21
  s_sub_u32 s63, s63, 1
  s_cselect_b64 s[64:65], 0, -1
  s_nop 1
  s_and_b64 vcc, vcc, s[64:65]
  s_cbranch_vccnz PO_AGAIN
  s_mov_b64 exec, -1
  s_branch PO_OK
HS1:
  buffer_store_dwordx4 v[24:27], v7, s[8:11], s3 offen sc1
  buffer_store_dwordx4 v[28:31], v7, s[8:11], s3 offen offset:2048 sc1
  s_addk_i32 s3, 4096
  buffer_store_dwordx2 v[18:19], v6, s[8:11], s3 offen sc1
  s_branch HB1
HS2:
  buffer_store_dwordx4 v[92:95], v1, s[8:11], s3 offen sc1
  s_branch HB2
PXM_SPIN:
  s_mov_b32 s63, 0x4000
PXM_AGAIN:
  s_sleep 1
  buffer_load_dwordx4 v[24:27], v8, s[8:11], s70 offen offset:0 sc1
  buffer_load_dwordx4 v[28:31], v8, s[8:11], s70 offen offset:512 sc1
  buffer_load_dwordx4 v[32:35], v8, s[8:11], s70 offen offset:1024 sc1
  buffer_load_dwordx4 v[36:39], v8, s[8:11], s70 offen offset:1536 sc1
  s_waitcnt vmcnt(1)
  v_max3_u32 v40, v26, v30, v34
  v_min3_u32 v41, v26, v30, v34
  s_waitcnt vmcnt(0)
  v_max_u32 v40, v40, v38
  v_min_u32 v41, v41, v38
  v_cmp_ne_u32 vcc, v20, v40
  v_cmp_ne_u32 s[64:65], v20, v41
  s_nop 3
  s_or_b64 vcc, vcc, s[64:65]
  s_sub_u32 s63, s63, 1
  s_cselect_b64 s[64:65], 0, -1
  s_and_b64 vcc, vcc, s[64:65]
  s_cbranch_vccnz PXM_AGAIN
  s_branch PXM_OK
HS3:
  buffer_store_dword v20, v1, s[8:11], s3 offen sc1
  s_branch HB3
PHE_SPIN:
  s_mov_b32 s63, 0x4000
  s_mov_b64 exec, 0xff
PHE_AGAIN:
  s_sleep 1
  buffer_load_dword v21, v5, s[8:11], s70 offen sc1
  s_waitcnt vmcnt(0)
  v_cmp_ne_u32 vcc, v20, v21
  s_sub_u32 s63, s63, 1
  s_cselect_b64 s[64:65], 0, -1
  s_nop 1
  s_and_b64 vcc, vcc, s[64:65]
  s_cbranch_vccnz PHE_AGAIN
  s_mov_b64 exec, -1
  s_branch PHE_OK
HS4:
  buffer_store_dword v20, v1, s[8:11], s3 offen sc1
  s_branch HB4
PHL_SPIN:
  s_mov_b32 s63, 0x4000
  s_mov_b64 exec, 0xff
PHL_AGAIN:
  s_sleep 1
  buffer_load_dword v21, v5, s[8:11], s70 offen sc1
  s_waitcnt vmcnt(0)
  v_cmp_ne_u32 vcc, v20, v21
  s_sub_u32 s63, s63, 1
  s_cselect_b64 s[64:65], 0, -1
  s_nop 1
  s_and_b64 vcc, vcc, s[64:65]
  s_cbranch_vccnz PHL_AGAIN
  s_mov_b64 exec, -1
  s_branch PHL_OK
HS5:
  buffer_store_dwordx4 v[44:47], v7, s[8:11], s3 offen sc1
  buffer_store_dwordx4 v[48:51], v7, s[8:11], s3 offen offset:2048 sc1
  s_addk_i32 s3, 4096
  buffer_store_dwordx2 v[18:19], v6, s[8:11], s3 offen sc1
  s_branch HB5
HS6:
  buffer_store_dwordx4 v[64:67], v1, s[8:11], s3 offen sc1
  s_branch HB6
PXI_SPIN_2:
  s_mov_b32 s63, 0x4000
PXI_AGAIN_2:
  s_sleep 1
  buffer_load_dwordx4 v[24:27], v8, s[8:11], s70 offen offset:0 sc1
  buffer_load_dwordx4 v[28:31], v8, s[8:11], s70 offen offset:512 sc1
  buffer_load_dwordx4 v[32:35], v8, s[8:11], s70 offen offset:1024 sc1
  buffer_load_dwordx4 v[36:39], v8, s[8:11], s70 offen offset:1536 sc1
  s_waitcnt vmcnt(1)
  v_max3_u32 v40, v26, v30, v34
  v_min3_u32 v41, v26, v30, v34
  s_waitcnt vmcnt(0)
  v_max_u32 v40, v40, v38
  v_min_u32 v41, v41, v38
  v_cmp_ne_u32 vcc, v20, v40
  v_cmp_ne_u32 s[64:65], v20, v41
  s_nop 3
  s_or_b64 vcc, vcc, s[64:65]
  s_sub_u32 s63, s63, 1
  s_cselect_b64 s[64:65], 0, -1
  s_and_b64 vcc, vcc, s[64:65]
  s_cbranch_vccnz PXI_AGAIN_2
  s_branch PXI_OK_2
P1_RETRY_2:
  s_mov_b32 s63, 4096
P1_AGAIN_2:
  s_mov_b32 s3, s39
  buffer_load_dwordx4 a[100:103], v29, s[8:11], s3 offen sc1
  s_addk_i32 s3, 4096
  buffer_load_dwordx4 a[104:107], v29, s[8:11], s3 offen sc1
  s_addk_i32 s3, 4096
  buffer_load_dwordx4 a[108:111], v29, s[8:11], s3 offen sc1
  s_addk_i32 s3, 4096
  buffer_load_dwordx4 a[112:115], v29, s[8:11], s3 offen sc1
  s_addk_i32 s3, 4096
  buffer_load_dwordx4 a[116:119], v29, s[8:11], s3 offen sc1
  s_addk_i32 s3, 4096
  buffer_load_dwordx4 a[120:123], v29, s[8:11], s3 offen sc1
  s_addk_i32 s3, 4096
  buffer_load_dwordx4 a[124:127], v29, s[8:11], s3 offen sc1
  s_addk_i32 s3, 4096
  buffer_load_dwordx4 a[128:131], v29, s[8:11], s3 offen sc1
  s_addk_i32 s3, 4096
  buffer_load_dwordx4 a[132:135], v29, s[8:11], s3 offen sc1
  s_addk_i32 s3, 4096
  buffer_load_dwordx4 a[136:139], v29, s[8:11], s3 offen sc1
  s_addk_i32 s3, 4096
  buffer_load_dwordx4 a[140:143], v29, s[8:11], s3 offen sc1
  s_addk_i32 s3, 4096
  buffer_load_dwordx4 a[144:147], v29, s[8:11], s3 offen sc1
  s_addk_i32 s3, 4096
  buffer_load_dwordx4 a[148:151], v29, s[8:11], s3 offen sc1
  s_addk_i32 s3, 4096
  buffer_load_dwordx4 a[152:155], v29, s[8:11], s3 offen sc1
  s_addk_i32 s3, 4096
  buffer_load_dwordx4 a[156:159], v29, s[8:11], s3 offen sc1
  s_addk_i32 s3, 4096
  buffer_load_dwordx4 a[160:163], v29, s[8:11], s3 offen sc1
  s_addk_i32 s3, 4096
  s_waitcnt vmcnt(15)
  v_mfma_f32_32x32x16_bf16 v[40:55], v[36:39], a[100:103], 0
  s_waitcnt vmcnt(14)
  v_mfma_f32_32x32x16_bf16 v[40:55], v[36:39], a[104:107], v[40:55]
  s_waitcnt vmcnt(13)
  v_mfma_f32_32x32x16_bf16 v[40:55], v[36:39], a[108:111], v[40:55]
  s_waitcnt vmcnt(12)
  v_mfma_f32_32x32x16_bf16 v[40:55], v[36:39], a[112:115], v[40:55]
  s_waitcnt vmcnt(11)
  v_mfma_f32_32x32x16_bf16 v[40:55], v[36:39], a[116:119], v[40:55]
  s_waitcnt vmcnt(10)
  v_mfma_f32_32x32x16_bf16 v[40:55], v[36:39], a[120:123], v[40:55]
  s_waitcnt vmcnt(9)
  v_mfma_f32_32x32x16_bf16 v[40:55], v[36:39], a[124:127], v[40:55]
  s_waitcnt vmcnt(8)
  v_mfma_f32_32x32x16_bf16 v[40:55], v[36:39], a[128:131], v[40:55]
  s_waitcnt vmcnt(7)
  v_mfma_f32_32x32x16_bf16 v[40:55], v[36:39], a[132:135], v[40:55]
  s_waitcnt vmcnt(6)
  v_mfma_f32_32x32x16_bf16 v[40:55], v[36:39], a[136:139], v[40:55]
  s_waitcnt vmcnt(5)
  v_mfma_f32_32x32x16_bf16 v[40:55], v[36:39], a[140:143], v[40:55]
  s_waitcnt vmcnt(4)
  v_mfma_f32_32x32x16_bf16 v[40:55], v[36:39], a[144:147], v[40:55]
  s_waitcnt vmcnt(3)
  v_mfma_f32_32x32x16_bf16 v[40:55], v[36:39], a[148:151], v[40:55]
  s_waitcnt vmcnt(2)
  v_mfma_f32_32x32x16_bf16 v[40:55], v[36:39], a[152:155], v[40:55]
  s_waitcnt vmcnt(1)
  v_mfma_f32_32x32x16_bf16 v[40:55], v[36:39], a[156:159], v[40:55]
  s_waitcnt vmcnt(0)
  v_mfma_f32_32x32x16_bf16 v[40:55], v[36:39], a[160:163], v[40:55]
  s_nop 11
  v_cmp_u_f32 vcc, v40, v40
  s_sub_u32 s63, s63, 1
  s_cselect_b64 s[64:65], 0, -1
  s_nop 1
  s_and_b64 vcc, vcc, s[64:65]
  s_cbranch_vccnz P1_AGAIN_2
  s_branch P1_SUMMED_2
HS7_2:
  buffer_store_dwordx2 v[148:149], v31, s[8:11], s41 offen sc1
  buffer_store_dwordx4 v[140:143], v30, s[8:11], s40 offen sc1
  buffer_store_dwordx4 v[144:147], v30, s[8:11], s40 offen offset:256 sc1
  s_branch HB7_2
HS8_2:
  buffer_store_dword v20, v1, s[8:11], s3 offen sc1
  s_branch HB8_2
PO_SPIN_2:
  s_mov_b32 s63, 0x4000
  s_mov_b64 exec, 0xff
PO_AGAIN_2:
  s_sleep 1
  buffer_load_dword v21, v5, s[8:11], s70 offen sc1
  s_waitcnt vmcnt(0)
  v_cmp_ne_u32 vcc, v20, v21
  s_sub_u32 s63, s63, 1
  s_cselect_b64 s[64:65], 0, -1
  s_nop 1
  s_and_b64 vcc, vcc, s[64:65]
  s_cbranch_vccnz PO_AGAIN_2
  s_mov_b64 exec, -1
  s_branch PO_OK_2
HS9_2:
  buffer_store_dwordx4 v[24:27], v7, s[8:11], s3 offen sc1
  buffer_store_dwordx4 v[28:31], v7, s[8:11], s3 offen offset:2048 sc1
  s_addk_i32 s3, 4096
  buffer_store_dwordx2 v[18:19], v6, s[8:11], s3 offen sc1
  s_branch HB9_2
HS10_2:
  buffer_store_dwordx4 v[92:95], v1, s[8:11], s3 offen sc1
  s_branch HB10_2
PXM_SPIN_2:
  s_mov_b32 s63, 0x4000
PXM_AGAIN_2:
  s_sleep 1
  buffer_load_dwordx4 v[24:27], v8, s[8:11], s70 offen offset:0 sc1
  buffer_load_dwordx4 v[28:31], v8, s[8:11], s70 offen offset:512 sc1
  buffer_load_dwordx4 v[32:35], v8, s[8:11], s70 offen offset:1024 sc1
  buffer_load_dwordx4 v[36:39], v8, s[8:11], s70 offen offset:1536 sc1
  s_waitcnt vmcnt(1)
  v_max3_u32 v40, v26, v30, v34
  v_min3_u32 v41, v26, v30, v34
  s_waitcnt vmcnt(0)
  v_max_u32 v40, v40, v38
  v_min_u32 v41, v41, v38
  v_cmp_ne_u32 vcc, v20, v40
  v_cmp_ne_u32 s[64:65], v20, v41
  s_nop 3
  s_or_b64 vcc, vcc, s[64:65]
  s_sub_u32 s63, s63, 1
  s_cselect_b64 s[64:65], 0, -1
  s_and_b64 vcc, vcc, s[64:65]
  s_cbranch_vccnz PXM_AGAIN_2
  s_branch PXM_OK_2
HS11_2:
  buffer_store_dword v20, v1, s[8:11], s3 offen sc1
  s_branch HB11_2
PHE_SPIN_2:
  s_mov_b32 s63, 0x4000
  s_mov_b64 exec, 0xff
PHE_AGAIN_2:
  s_sleep 1
  buffer_load_dword v21, v5, s[8:11], s70 offen sc1
  s_waitcnt vmcnt(0)
  v_cmp_ne_u32 vcc, v20, v21
  s_sub_u32 s63, s63, 1
  s_cselect_b64 s[64:65], 0, -1
  s_nop 1
  s_and_b64 vcc, vcc, s[64:65]
  s_cbranch_vccnz PHE_AGAIN_2
  s_mov_b64 exec, -1
  s_branch PHE_OK_2
HS12_2:
  buffer_store_dword v20, v1, s[8:11], s3 offen sc1
  s_branch HB12_2
PHL_SPIN_2:
  s_mov_b32 s63, 0x4000
  s_mov_b64 exec, 0xff
PHL_AGAIN_2:
  s_sleep 1
  buffer_load_dword v21, v5, s[8:11], s70 offen sc1
  s_waitcnt vmcnt(0)
  v_cmp_ne_u32 vcc, v20, v21
  s_sub_u32 s63, s63, 1
  s_cselect_b64 s[64:65], 0, -1
  s_nop 1
  s_and_b64 vcc, vcc, s[64:65]
  s_cbranch_vccnz PHL_AGAIN_2
  s_mov_b64 exec, -1
  s_branch PHL_OK_2
M_LAST:
  s_endpgm
.section .rodata,"a"
.p2align 6
.amdhsa_kernel interleave_layers__linear_kernel_hedgehog__geglu_ffn__prompt_kernel
  .amdhsa_next_free_vgpr 512
  .amdhsa_next_free_sgpr 102
  .amdhsa_accum_offset 256
  .amdhsa_group_segment_fixed_size 0
  .amdhsa_kernarg_size 88
  .amdhsa_user_sgpr_count 2
  .amdhsa_user_sgpr_kernarg_segment_ptr 1
  .amdhsa_system_sgpr_workgroup_id_x 1
  .amdhsa_float_denorm_mode_32 3
.end_amdhsa_kernel
```
